```python
import torch

def _softmax(x, axis=-1):
    return torch.softmax(x, dim=axis)
def _gelu(x):
    return torch.nn.functional.gelu(x, approximate="tanh")
def _silu(x):
    return torch.nn.functional.silu(x)
def _sigmoid(x):
    return torch.sigmoid(x)
def _layernorm(x, axis=-1, eps=1e-5):
    m = x.mean(dim=axis, keepdim=True)
    v = x.var(dim=axis, keepdim=True, unbiased=False)
    return (x - m) / torch.sqrt(v + eps)
def _scatter_add(tgt, idx, src, axis=0):
    return tgt.clone().index_add_(axis, idx, src)
def _segment_sum(src, seg, n):
    out = torch.zeros((n,) + src.shape[1:], dtype=src.dtype)
    return out.index_add_(0, seg, src)
def _pad(x, pw):
    flat = tuple(v for pair in reversed(pw) for v in pair)
    return torch.nn.functional.pad(x, flat)

kernel_name = 'parallel_sum__ssm_conv_s5__glu_gated_swiglu__prompt'

def setup_inputs():

    _w = (lambda a: (lambda t: t.to(torch.bfloat16) if t.is_floating_point() else t)(torch.as_tensor(a)))
    def _A_setup():
        B, S, D = 1, 2048, 640
        P = D
        Lambda_re = -0.5 * (lambda _x: torch.exp(torch.as_tensor(_x)))((lambda *s: torch.randn(*s, dtype=torch.bfloat16) * 0.2)(P))
        Lambda_im = (lambda *s: torch.randn(*s, dtype=torch.bfloat16) * 0.8)(P) * 1.0
        B_re = (lambda *s: torch.randn(*s, dtype=torch.bfloat16) * 0.2)(P, D) * (D ** -0.5)
        B_im = (lambda *s: torch.randn(*s, dtype=torch.bfloat16) * 0.2)(P, D) * (D ** -0.5)
        C_re = (lambda *s: torch.randn(*s, dtype=torch.bfloat16) * 0.2)(D, P) * (P ** -0.5)
        C_im = (lambda *s: torch.randn(*s, dtype=torch.bfloat16) * 0.2)(D, P) * (P ** -0.5)
        log_dt = (lambda *s: torch.randn(*s, dtype=torch.bfloat16) * 0.2)(P) * 0.3 - 2.0
        Dskip = (lambda *s: torch.randn(*s, dtype=torch.bfloat16) * 0.05)(D)
        return {
            "x": _w((lambda *s: torch.randn(*s, dtype=torch.bfloat16) * 0.05)(B, S, D)),
            "Lambda_re": _w(Lambda_re),
            "Lambda_im": _w(Lambda_im),
            "B_re": _w(B_re),
            "B_im": _w(B_im),
            "C_re": _w(C_re),
            "C_im": _w(C_im),
            "log_dt": _w(log_dt),
            "Dskip": _w(Dskip),
        }
    _A_in = _A_setup()

    def _B_setup():
        B, S, D, F = 1, 2048, 640, 1536
        return {
            "x": _w((lambda *s: torch.randn(*s, dtype=torch.bfloat16) * 0.05)(B, S, D)),
            "w1": _w((lambda *s: torch.randn(*s, dtype=torch.bfloat16) * 0.4)(D, F) * (2.0 / D) ** 0.5),
            "w3": _w((lambda *s: torch.randn(*s, dtype=torch.bfloat16) * 0.4)(D, F) * (2.0 / D) ** 0.5),
            "w2": _w((lambda *s: torch.randn(*s, dtype=torch.bfloat16) * 0.4)(F, D) * (2.0 / F) ** 0.5),
        }
    _B_in = _B_setup()

    return {
        "A_x": _A_in["x"],
        "A_Lambda_re": _A_in["Lambda_re"],
        "A_Lambda_im": _A_in["Lambda_im"],
        "A_B_re": _A_in["B_re"],
        "A_B_im": _A_in["B_im"],
        "A_C_re": _A_in["C_re"],
        "A_C_im": _A_in["C_im"],
        "A_log_dt": _A_in["log_dt"],
        "A_Dskip": _A_in["Dskip"],
        "B_x": _B_in["x"],
        "B_w1": _B_in["w1"],
        "B_w3": _B_in["w3"],
        "B_w2": _B_in["w2"],
    }

def reference(A_x, A_Lambda_re, A_Lambda_im, A_B_re, A_B_im, A_C_re, A_C_im, A_log_dt, A_Dskip, B_x, B_w1, B_w3, B_w2):
    def _A_ref(x, Lambda_re, Lambda_im, B_re, B_im, C_re, C_im, log_dt, Dskip):
        Bsz, L, H = x.shape
        Lam = Lambda_re + 1j * Lambda_im
        Bmat = B_re + 1j * B_im
        Cmat = C_re + 1j * C_im
        dt = torch.exp(log_dt)
        Lam_bar = torch.exp(dt * Lam)
        B_bar = ((Lam_bar - 1.0) / Lam)[:, None] * Bmat
        Bu = torch.einsum("bld,pd->blp", x + 0j, B_bar)
        h = torch.zeros_like(Bu[:, 0, :])
        hs = []
        for t in range(L):
            h = Lam_bar[None, :] * h + Bu[:, t, :]
            hs.append(h)
        hseq = torch.stack(hs, 1)
        y = 2.0 * torch.einsum("blp,dp->bld", hseq, Cmat).real + x * Dskip[None, None, :]
        return y

    def _B_ref(x, w1, w3, w2):
        gate = torch.einsum("bsd,df->bsf", x, w1)
        up = torch.einsum("bsd,df->bsf", x, w3)
        h = _silu(gate) * up
        out = torch.einsum("bsf,fd->bsd", h, w2)
        return out

    x = A_x
    xn = _layernorm(x, axis=-1)
    return x + _A_ref(xn, A_Lambda_re, A_Lambda_im, A_B_re, A_B_im, A_C_re, A_C_im, A_log_dt, A_Dskip) + _B_ref(xn, B_w1, B_w3, B_w2)
```

```asm
; @launch grid=(256,1,1) block=(256,1,1) lds=163840
.amdgcn_target "amdgcn-amd-amdhsa--gfx950"
.text
.globl parallel_sum__ssm_conv_s5__glu_gated_swiglu__prompt_kernel
.p2align 8
.type parallel_sum__ssm_conv_s5__glu_gated_swiglu__prompt_kernel,@function
parallel_sum__ssm_conv_s5__glu_gated_swiglu__prompt_kernel:
  s_cmp_ge_u32 s2, 256
  s_cbranch_scc1 K_end
  s_load_dwordx16 s[64:79], s[0:1], 0
  s_load_dwordx16 s[80:95], s[0:1], 64
  v_and_b32 v1, 63, v0
  v_lshrrev_b32 v32, 6, v0
  v_lshlrev_b32 v38, 4, v1
  v_readfirstlane_b32 s42, v32
  s_and_b32 s40, s2, 1
  s_lshl_b32 s40, s40, 3
  s_bfe_u32 s44, s2, 196611
  s_add_u32 s40, s40, s44
  s_bfe_u32 s41, s2, 131073
  s_lshl_b32 s41, s41, 2
  s_lshr_b32 s44, s2, 6
  s_add_u32 s41, s41, s44
  s_lshr_b32 s43, s41, 1
  s_getpc_b64 s[4:5]
K_pc:
  s_mov_b32 s6, K_X-K_pc
  s_bitcmp1_b32 s41, 0
  s_cselect_b32 s6, K_Y-K_pc, s6
  s_and_b32 s7, s43, 1
  s_lshl_b32 s7, s7, 3
  s_and_b32 s8, s40, 7
  s_add_u32 s7, s7, s8
  s_lshl_b32 s7, s7, 11
  s_add_u32 s6, s6, s7
  v_lshrrev_b32 v37, 4, v0
  v_lshlrev_b32 v37, 7, v37
  v_add_u32 v37, s6, v37
  v_min_u32 v37, K_end-K_pc, v37
  global_load_dword v250, v37, s[4:5]
  s_mul_i32 s99, s40, 3
  s_mul_i32 s44, s44, 1
  s_add_u32 s99, s99, s44
  s_mul_i32 s45, s99, 205
  s_lshr_b32 s45, s45, 11
  s_mul_i32 s45, s45, 10
  s_sub_u32 s99, s99, s45
  s_lshl_b32 s96, s99, 7
  s_mov_b32 s97, s99
  s_mov_b32 s52, 0xffff0000
  s_lshl_b32 s53, s40, 4
  s_add_u32 s53, s53, s41
  s_lshl_b32 s53, s53, 7
  s_add_u32 s53, s53, 15908864
  s_lshl_b32 s44, s40, 7
  s_lshl_b32 s45, s42, 5
  s_add_u32 s45, s44, s45
  s_mul_i32 s48, s45, 1280
  s_add_u32 s49, s48, 9216
  s_add_u32 s50, s48, 18432
  s_add_u32 s51, s48, 27648
  s_lshl_b32 s54, s42, 12
  s_lshl_b32 s45, s41, 3
  s_add_u32 s44, s44, s45
  s_lshl_b32 s45, s42, 1
  s_add_u32 s44, s44, s45
  s_mul_i32 s100, s44, 1280
  s_lshl_b32 s101, s44, 4
  s_add_u32 s101, s101, 15138816
  v_lshrrev_b32 v32, 3, v1
  v_and_b32 v33, 7, v1
  v_lshrrev_b32 v34, 5, v1
  v_mul_u32_u24 v34, 1280, v34
  v_and_b32 v35, 31, v1
  v_lshl_add_u32 v36, v35, 3, v34
  v_lshrrev_b32 v34, 4, v1
  v_xor_b32 v34, v33, v34
  v_lshlrev_b32 v34, 4, v34
  v_mul_u32_u24 v35, 1280, v32
  v_add_u32 v2, v34, v35
  v_xor_b32 v3, 64, v2
  v_mov_b32 v210, 0
  v_mov_b32 v34, 2130706432
  v_cmp_eq_u32 vcc, 0, v0
  s_nop 1
  v_cndmask_b32 v208, v34, v0, vcc
  s_cmp_eq_u32 s2, 0
  s_cselect_b32 s44, 0, 2130706432
  v_or_b32 v209, s44, v208
  s_bitcmp1_b32 s41, 0
  s_cbranch_scc0 K_X
  s_mul_i32 s58, s42, 5120
  s_and_b32 s44, s42, 1
  s_lshl_b32 s45, s44, 2
  s_lshr_b32 s46, s42, 1
  s_xor_b32 s45, s45, s46
  s_lshl_b32 s45, s45, 4
  v_xor_b32 v12, s45, v2
  s_mul_i32 s45, s43, 80
  s_lshl_b32 s44, s44, 3
  s_add_u32 s44, s44, s45
  s_mul_i32 s59, s44, 1280
  s_add_u32 s60, s59, 19456
  s_add_u32 s61, s59, 38912
  s_add_u32 s62, s59, 58368
  s_add_u32 s63, s59, 81920
  s_memrealtime s[2:3]
  s_waitcnt lgkmcnt(0)
  s_mov_b32 s4, s64
  s_mov_b32 s5, s65
  s_mov_b32 s6, 2621440
  s_mov_b32 s7, 0x20000
  s_cmp_ge_u32 s42, 2
  s_cselect_b32 s16, s72, s70
  s_cselect_b32 s17, s73, s71
  s_mov_b32 s18, 819200
  s_mov_b32 s19, 0x20000
  v_add_u32 v4, s96, v2
  v_add_u32 v5, s96, v3
  s_add_u32 m0, s54, 0
  s_nop 0
  buffer_load_dwordx4 v4, s[4:7], s48 offen offset:0 lds
  s_lshl_b32 s55, s97, 7
  v_add_u32 v13, s55, v12
  s_add_u32 m0, s58, 57344
  s_nop 0
  buffer_load_dwordx4 v13, s[16:19], s59 offen offset:0 lds
  buffer_load_dwordx4 v13, s[16:19], s60 offen offset:1024 lds
  s_add_u32 m0, s54, 0
  s_nop 0
  buffer_load_dwordx4 v5, s[4:7], s49 offen offset:1024 lds
  buffer_load_dwordx4 v4, s[4:7], s50 offen offset:2048 lds
  buffer_load_dwordx4 v5, s[4:7], s51 offen offset:3072 lds
  s_add_u32 s96, s96, 128
  s_cmp_eq_u32 s96, 1280
  s_cselect_b32 s96, 0, s96
  s_add_u32 m0, s58, 57344
  s_nop 0
  buffer_load_dwordx4 v13, s[16:19], s61 offen offset:2048 lds
  buffer_load_dwordx4 v13, s[16:19], s62 offen offset:3072 lds
  s_add_u32 m0, s58, 61440
  s_nop 0
  buffer_load_dwordx4 v13, s[16:19], s63 offen lds
  s_add_u32 s97, s97, 1
  s_cmp_eq_u32 s97, 10
  s_cselect_b32 s97, 0, s97
  s_mov_b32 s32, s92
  s_mov_b32 s33, s93
  s_mov_b32 s34, 256
  s_mov_b32 s35, 0x20000
  s_or_b32 s47, s2, 1
  v_mov_b32 v211, s47
  buffer_store_dword v211, v209, s[32:35], 0 offen sc1
  s_and_b32 s28, s41, 7
  s_lshl_b32 s28, s28, 1
  s_and_b32 s29, s40, 1
  s_add_u32 s28, s28, s29
  s_lshl_b32 s28, s28, 2
  s_add_u32 s28, s28, s42
  s_lshl_b32 s28, s28, 21
  s_min_u32 s29, s28, 23298044
  s_load_dword s30, s[94:95], s29
  s_min_u32 s29, s28, 5242876
  s_load_dword s31, s[90:91], s29
  s_add_u32 s28, s28, 134217728
  s_branch K_Y
K_X:
  v_bfe_u32 v34, v1, 4, 1
  v_lshlrev_b32 v34, 1, v34
  v_xor_b32 v34, v33, v34
  v_lshlrev_b32 v34, 4, v34
  v_mul_u32_u24 v35, 3072, v32
  v_add_u32 v10, v34, v35
  v_xor_b32 v11, 64, v10
  s_mul_i32 s98, s42, 49152
  s_mul_i32 s44, s43, 384
  s_add_u32 s98, s98, s44
  s_memrealtime s[2:3]
  s_waitcnt lgkmcnt(0)
  s_mov_b32 s4, s64
  s_mov_b32 s5, s65
  s_mov_b32 s6, 2621440
  s_mov_b32 s7, 0x20000
  s_mov_b32 s8, s84
  s_mov_b32 s9, s85
  s_mov_b32 s10, 1966080
  s_mov_b32 s11, 0x20000
  s_sub_u32 s12, s86, 1024
  s_subb_u32 s13, s87, 0
  s_mov_b32 s14, 1967104
  s_mov_b32 s15, 0x20000
  v_add_u32 v4, s96, v2
  v_add_u32 v5, s96, v3
  s_add_u32 m0, s54, 0
  s_nop 0
  buffer_load_dwordx4 v4, s[4:7], s48 offen offset:0 lds
  s_mul_i32 s55, s97, 196608
  s_add_u32 s55, s55, s98
  s_add_u32 s56, s55, 22528
  s_add_u32 m0, s54, 81920
  s_nop 0
  buffer_load_dwordx4 v10, s[8:11], s55 offen lds
  buffer_load_dwordx4 v11, s[12:15], s55 offen offset:1024 lds
  s_add_u32 m0, s54, 0
  s_nop 0
  buffer_load_dwordx4 v5, s[4:7], s49 offen offset:1024 lds
  buffer_load_dwordx4 v4, s[4:7], s50 offen offset:2048 lds
  buffer_load_dwordx4 v5, s[4:7], s51 offen offset:3072 lds
  s_add_u32 s96, s96, 128
  s_cmp_eq_u32 s96, 1280
  s_cselect_b32 s96, 0, s96
  s_add_u32 m0, s54, 81920
  s_nop 0
  buffer_load_dwordx4 v10, s[8:11], s56 offen offset:2048 lds
  buffer_load_dwordx4 v11, s[12:15], s56 offen offset:3072 lds
  s_add_u32 s97, s97, 1
  s_cmp_eq_u32 s97, 10
  s_cselect_b32 s97, 0, s97
  s_mov_b32 s32, s92
  s_mov_b32 s33, s93
  s_mov_b32 s34, 256
  s_mov_b32 s35, 0x20000
  s_or_b32 s47, s2, 1
  v_mov_b32 v211, s47
  buffer_store_dword v211, v209, s[32:35], 0 offen sc1
  s_and_b32 s28, s41, 7
  s_lshl_b32 s28, s28, 1
  s_and_b32 s29, s40, 1
  s_add_u32 s28, s28, s29
  s_lshl_b32 s28, s28, 2
  s_add_u32 s28, s28, s42
  s_lshl_b32 s28, s28, 21
  s_min_u32 s29, s28, 23298044
  s_load_dword s30, s[94:95], s29
  s_min_u32 s29, s28, 5242876
  s_load_dword s31, s[90:91], s29
  s_add_u32 s28, s28, 134217728
  buffer_load_dwordx2 v[216:217], v36, s[4:7], s100 offen offset:0
  buffer_load_dwordx2 v[218:219], v36, s[4:7], s100 offen offset:256
  buffer_load_dwordx2 v[220:221], v36, s[4:7], s100 offen offset:512
  buffer_load_dwordx2 v[222:223], v36, s[4:7], s100 offen offset:768
  buffer_load_dwordx2 v[224:225], v36, s[4:7], s100 offen offset:1024
  v_bfe_u32 v34, v1, 2, 1
  v_lshlrev_b32 v34, 4, v34
  v_bfe_u32 v35, v1, 3, 2
  v_lshl_add_u32 v34, v35, 2, v34
  v_and_b32 v35, 3, v1
  v_add_u32 v34, v34, v35
  v_lshlrev_b32 v212, 4, v34
  v_bfe_u32 v35, v34, 1, 3
  v_lshrrev_b32 v6, 5, v1
  v_xor_b32 v35, v35, v6
  v_lshlrev_b32 v35, 4, v35
  v_lshl_add_u32 v35, v34, 7, v35
  v_add_u32 v6, s54, v35
  v_xor_b32 v7, 32, v6
  v_xor_b32 v8, 64, v6
  v_xor_b32 v9, 96, v6
  v_bfe_u32 v34, v1, 2, 1
  v_lshlrev_b32 v34, 10, v34
  v_bfe_u32 v35, v1, 3, 3
  v_lshl_add_u32 v34, v35, 6, v34
  v_and_b32 v35, 3, v1
  v_lshl_add_u32 v23, v35, 4, v34
  v_mov_b32 v24, 0x3f803f80
  v_mov_b32 v25, 0x3f803f80
  v_mov_b32 v26, 0x3f803f80
  v_mov_b32 v27, 0x3f803f80
  s_mov_b32 s20, s94
  s_mov_b32 s21, s95
  s_mov_b32 s22, 23298048
  s_mov_b32 s23, 0x20000
  s_lshl_b32 s44, s40, 1
  s_lshr_b32 s45, s42, 1
  s_add_u32 s44, s44, s45
  s_mul_i32 s44, s44, 88
  s_mul_i32 s45, s43, 11
  s_add_u32 s44, s44, s45
  s_lshl_b32 s57, s44, 12
  s_and_b32 s45, s42, 1
  s_lshl_b32 s45, s45, 11
  s_add_u32 s57, s57, s45
  v_bfe_u32 v32, v1, 4, 1
  v_lshrrev_b32 v33, 5, v1
  v_lshlrev_b32 v33, 11, v33
  v_lshl_add_u32 v33, v32, 10, v33
  v_bfe_u32 v34, v1, 2, 2
  v_lshl_add_u32 v33, v34, 7, v33
  v_and_b32 v35, 3, v1
  v_lshl_add_u32 v33, v35, 3, v33
  v_bfe_u32 v34, v1, 3, 1
  v_lshl_add_u32 v34, v32, 1, v34
  v_lshl_add_u32 v33, v34, 5, v33
  v_add_u32 v18, 81920, v33
  v_xor_b32 v19, 32, v18
  v_xor_b32 v20, 64, v18
  v_xor_b32 v21, 96, v18
  s_lshl_b32 s44, s43, 4
  s_add_u32 s44, s44, s40
  s_lshl_b32 s44, s44, 2
  s_add_u32 s16, s44, s42
  s_lshl_b32 s58, s42, 13
  s_min_u32 s44, s16, 479
  s_mul_i32 s18, s44, 6554
  s_lshr_b32 s18, s18, 16
  s_mul_i32 s46, s18, 10
  s_sub_u32 s17, s44, s46
  s_mov_b32 s24, s88
  s_mov_b32 s25, s89
  s_mov_b32 s26, 1966080
  s_mov_b32 s27, 0x20000
  v_lshrrev_b32 v32, 3, v1
  v_and_b32 v33, 7, v1
  v_lshrrev_b32 v34, 4, v1
  v_lshlrev_b32 v34, 1, v34
  v_xor_b32 v34, v33, v34
  v_lshlrev_b32 v34, 4, v34
  v_mul_u32_u24 v35, 1280, v32
  v_add_u32 v14, v34, v35
  s_mul_i32 s60, s18, 40960
  s_lshl_b32 s47, s17, 7
  s_add_u32 s60, s60, s47
  s_min_u32 s44, s16, 399
  s_mul_i32 s19, s44, 6554
  s_lshr_b32 s19, s19, 16
  s_mul_i32 s46, s19, 10
  s_sub_u32 s16, s44, s46
  s_mov_b32 s28, s74
  s_mov_b32 s29, s75
  s_waitcnt lgkmcnt(0)
  s_mov_b32 s30, 819200
  s_mov_b32 s31, 0x20000
  s_sub_u32 s36, s76, 2048
  s_subb_u32 s37, s77, 0
  s_mov_b32 s38, 821248
  s_mov_b32 s39, 0x20000
  s_mul_i32 s61, s19, 20480
  s_lshl_b32 s47, s16, 7
  s_add_u32 s61, s61, s47
  s_add_u32 s62, s61, 9216
  v_lshlrev_b32 v152, 1, v1
  v_add_u32 v152, s47, v152
  global_load_ushort v153, v152, s[66:67]
  global_load_ushort v154, v152, s[68:69]
  global_load_ushort v155, v152, s[78:79]
  v_add_u32 v4, s96, v2
  v_add_u32 v5, s96, v3
  s_add_u32 m0, s54, 16384
  s_nop 0
  buffer_load_dwordx4 v4, s[4:7], s48 offen offset:0 lds
  buffer_load_dwordx4 v5, s[4:7], s49 offen offset:1024 lds
  buffer_load_dwordx4 v4, s[4:7], s50 offen offset:2048 lds
  buffer_load_dwordx4 v5, s[4:7], s51 offen offset:3072 lds
  s_add_u32 s96, s96, 128
  s_cmp_eq_u32 s96, 1280
  s_cselect_b32 s96, 0, s96
  s_mul_i32 s55, s97, 196608
  s_add_u32 s55, s55, s98
  s_add_u32 s56, s55, 22528
  s_add_u32 m0, s54, 98304
  s_nop 0
  buffer_load_dwordx4 v10, s[8:11], s55 offen lds
  buffer_load_dwordx4 v11, s[12:15], s55 offen offset:1024 lds
  buffer_load_dwordx4 v10, s[8:11], s56 offen offset:2048 lds
  buffer_load_dwordx4 v11, s[12:15], s56 offen offset:3072 lds
  s_add_u32 s97, s97, 1
  s_cmp_eq_u32 s97, 10
  s_cselect_b32 s97, 0, s97
  buffer_load_dword v211, v210, s[32:35], 0 offen sc1
  s_waitcnt vmcnt(20)
  ds_read_b128 a[0:3], v6 offset:0
  ds_read_b128 a[4:7], v7 offset:0
  ds_read_b128 a[8:11], v8 offset:0
  ds_read_b128 a[12:15], v9 offset:0
  s_waitcnt vmcnt(18)
  s_barrier
  ds_read_b64_tr_b16 a[160:161], v18 offset:0
  ds_read_b64_tr_b16 a[162:163], v18 offset:512
  ds_read_b64_tr_b16 a[164:165], v19 offset:0
  ds_read_b64_tr_b16 a[166:167], v19 offset:512
  ds_read_b64_tr_b16 a[168:169], v20 offset:0
  ds_read_b64_tr_b16 a[170:171], v20 offset:512
  ds_read_b64_tr_b16 a[172:173], v21 offset:0
  ds_read_b64_tr_b16 a[174:175], v21 offset:512
  ds_read_b64_tr_b16 a[180:181], v18 offset:4096
  ds_read_b64_tr_b16 a[182:183], v18 offset:4608
  ds_read_b64_tr_b16 a[184:185], v19 offset:4096
  s_waitcnt lgkmcnt(10)
  ds_read_b64_tr_b16 a[186:187], v19 offset:4608
  ds_read_b64_tr_b16 a[188:189], v20 offset:4096
  ds_read_b64_tr_b16 a[190:191], v20 offset:4608
  ds_read_b64_tr_b16 a[192:193], v21 offset:4096
  ds_read_b64_tr_b16 a[194:195], v21 offset:4608
  s_waitcnt lgkmcnt(8)
  v_mfma_f32_32x32x16_bf16 v[40:55], a[160:163], a[0:3], 0
  ds_read_b64_tr_b16 a[196:197], v18 offset:8192
  ds_read_b64_tr_b16 a[198:199], v18 offset:8704
  v_add_u32 v4, s96, v2
  v_add_u32 v5, s96, v3
  s_add_u32 m0, s54, 32768
  s_nop 0
  buffer_load_dwordx4 v4, s[4:7], s48 offen offset:0 lds
  s_lshl_b32 s44, s42, 5
  v_xor_b32 v22, s44, v18
  v_mfma_f32_32x32x16_bf16 v[56:71], a[164:167], a[0:3], 0
  ds_read_b64_tr_b16 a[200:201], v19 offset:8192
  ds_read_b64_tr_b16 a[202:203], v19 offset:8704
  buffer_load_dwordx4 v5, s[4:7], s49 offen offset:1024 lds
  ds_read_b64_tr_b16 a[240:241], v22 offset:0
  ds_read_b64_tr_b16 a[242:243], v22 offset:512
  ds_read_b64_tr_b16 a[244:245], v22 offset:4096
  v_mfma_f32_32x32x16_bf16 v[72:87], a[168:171], a[0:3], 0
  s_waitcnt lgkmcnt(10)
  ds_read_b64_tr_b16 a[204:205], v20 offset:8192
  ds_read_b64_tr_b16 a[206:207], v20 offset:8704
  buffer_load_dwordx4 v4, s[4:7], s50 offen offset:2048 lds
  ds_read_b64_tr_b16 a[246:247], v22 offset:4608
  ds_read_b64_tr_b16 a[248:249], v22 offset:8192
  v_mfma_f32_32x32x16_bf16 v[88:103], a[172:175], a[0:3], 0
  s_waitcnt lgkmcnt(11)
  ds_read_b64_tr_b16 a[208:209], v21 offset:8192
  ds_read_b64_tr_b16 a[210:211], v21 offset:8704
  buffer_load_dwordx4 v5, s[4:7], s51 offen offset:3072 lds
  s_add_u32 s96, s96, 128
  s_cmp_eq_u32 s96, 1280
  s_cselect_b32 s96, 0, s96
  ds_read_b64_tr_b16 a[250:251], v22 offset:8704
  ds_read_b64_tr_b16 a[252:253], v22 offset:12288
  s_waitcnt lgkmcnt(10)
  ds_read_b64_tr_b16 a[254:255], v22 offset:12800
  v_mfma_f32_32x32x16_bf16 v[40:55], a[180:183], a[4:7], v[40:55]
  ds_read_b64_tr_b16 a[160:161], v18 offset:12288
  ds_read_b64_tr_b16 a[162:163], v18 offset:12800
  s_waitcnt vmcnt(9)
  ds_read_b128 a[16:19], v6 offset:16384
  ds_read_b128 a[20:23], v7 offset:16384
  s_waitcnt lgkmcnt(10)
  ds_read_b128 a[24:27], v8 offset:16384
  ds_read_b128 a[28:31], v9 offset:16384
  s_mul_i32 s55, s97, 196608
  s_add_u32 s55, s55, s98
  s_add_u32 s56, s55, 22528
  s_add_u32 m0, s54, 114688
  s_nop 0
  buffer_load_dwordx4 v10, s[8:11], s55 offen lds
  v_mov_b32 v201, 0
  v_mov_b32 v200, 0
  v_mfma_f32_32x32x16_bf16 v[56:71], a[184:187], a[4:7], v[56:71]
  ds_read_b64_tr_b16 a[164:165], v19 offset:12288
  ds_read_b64_tr_b16 a[166:167], v19 offset:12800
  buffer_load_dwordx4 v11, s[12:15], s55 offen offset:1024 lds
  v_dot2c_f32_bf16 v201, v24, v216
  v_dot2c_f32_bf16 v200, v216, v216
  v_dot2c_f32_bf16 v201, v24, v217
  v_mfma_f32_32x32x16_bf16 v[72:87], a[188:191], a[4:7], v[72:87]
  ds_read_b64_tr_b16 a[168:169], v20 offset:12288
  s_waitcnt lgkmcnt(10)
  ds_read_b64_tr_b16 a[170:171], v20 offset:12800
  buffer_load_dwordx4 v10, s[8:11], s56 offen offset:2048 lds
  v_dot2c_f32_bf16 v200, v217, v217
  v_dot2c_f32_bf16 v201, v24, v218
  v_mfma_f32_32x32x16_bf16 v[88:103], a[192:195], a[4:7], v[88:103]
  ds_read_b64_tr_b16 a[172:173], v21 offset:12288
  ds_read_b64_tr_b16 a[174:175], v21 offset:12800
  buffer_load_dwordx4 v11, s[12:15], s56 offen offset:3072 lds
  s_add_u32 s97, s97, 1
  s_cmp_eq_u32 s97, 10
  s_cselect_b32 s97, 0, s97
  v_dot2c_f32_bf16 v200, v218, v218
  v_dot2c_f32_bf16 v201, v24, v219
  v_mfma_f32_32x32x16_bf16 v[40:55], a[196:199], a[8:11], v[40:55]
  s_waitcnt vmcnt(9)
  s_barrier
  ds_read_b64_tr_b16 a[180:181], v18 offset:16384
  ds_read_b64_tr_b16 a[182:183], v18 offset:16896
  s_add_u32 m0, s58, 49152
  s_nop 0
  buffer_load_dwordx4 v14, s[24:27], s60 offen offset:0 lds
  v_dot2c_f32_bf16 v200, v219, v219
  v_dot2c_f32_bf16 v201, v24, v220
  v_dot2c_f32_bf16 v200, v220, v220
  v_mfma_f32_32x32x16_bf16 v[56:71], a[200:203], a[8:11], v[56:71]
  s_waitcnt lgkmcnt(10)
  ds_read_b64_tr_b16 a[184:185], v19 offset:16384
  ds_read_b64_tr_b16 a[186:187], v19 offset:16896
  s_add_u32 s60, s60, 9216
  buffer_load_dwordx4 v14, s[24:27], s60 offen offset:1024 lds
  v_dot2c_f32_bf16 v201, v24, v221
  v_dot2c_f32_bf16 v200, v221, v221
  v_mfma_f32_32x32x16_bf16 v[72:87], a[204:207], a[8:11], v[72:87]
  ds_read_b64_tr_b16 a[188:189], v20 offset:16384
  ds_read_b64_tr_b16 a[190:191], v20 offset:16896
  s_add_u32 s60, s60, 9216
  buffer_load_dwordx4 v14, s[24:27], s60 offen offset:2048 lds
  v_dot2c_f32_bf16 v201, v24, v222
  v_dot2c_f32_bf16 v200, v222, v222
  v_dot2c_f32_bf16 v201, v24, v223
  v_mfma_f32_32x32x16_bf16 v[88:103], a[208:211], a[8:11], v[88:103]
  s_waitcnt lgkmcnt(6)
  ds_read_b64_tr_b16 a[192:193], v21 offset:16384
  ds_read_b64_tr_b16 a[194:195], v21 offset:16896
  s_add_u32 s60, s60, 9216
  buffer_load_dwordx4 v14, s[24:27], s60 offen offset:3072 lds
  v_dot2c_f32_bf16 v200, v223, v223
  v_dot2c_f32_bf16 v201, v24, v224
  v_mfma_f32_32x32x16_bf16 v[40:55], a[160:163], a[12:15], v[40:55]
  ds_read_b64_tr_b16 a[196:197], v18 offset:20480
  ds_read_b64_tr_b16 a[198:199], v18 offset:20992
  s_add_u32 m0, s58, 53248
  s_nop 0
  buffer_load_dwordx4 v2, s[28:31], s61 offen offset:0 lds
  v_dot2c_f32_bf16 v200, v224, v224
  v_dot2c_f32_bf16 v201, v24, v225
  v_mfma_f32_32x32x16_bf16 v[56:71], a[164:167], a[12:15], v[56:71]
  ds_read_b64_tr_b16 a[200:201], v19 offset:20480
  ds_read_b64_tr_b16 a[202:203], v19 offset:20992
  buffer_load_dwordx4 v3, s[28:31], s62 offen offset:1024 lds
  v_dot2c_f32_bf16 v200, v225, v225
  s_nop 2
  v_add_f32_dpp v201, v201, v201 quad_perm:[1,0,3,2] row_mask:0xf bank_mask:0xf
  v_mfma_f32_32x32x16_bf16 v[72:87], a[168:171], a[12:15], v[72:87]
  ds_read_b64_tr_b16 a[204:205], v20 offset:20480
  ds_read_b64_tr_b16 a[206:207], v20 offset:20992
  buffer_load_dwordx4 v2, s[36:39], s61 offen offset:2048 lds
  v_add_f32_dpp v200, v200, v200 quad_perm:[1,0,3,2] row_mask:0xf bank_mask:0xf
  v_add_f32_dpp v201, v201, v201 quad_perm:[2,3,0,1] row_mask:0xf bank_mask:0xf
  v_mfma_f32_32x32x16_bf16 v[88:103], a[172:175], a[12:15], v[88:103]
  s_waitcnt lgkmcnt(6)
  ds_read_b64_tr_b16 a[208:209], v21 offset:20480
  ds_read_b64_tr_b16 a[210:211], v21 offset:20992
  buffer_load_dwordx4 v3, s[36:39], s62 offen offset:3072 lds
  v_add_f32_dpp v200, v200, v200 quad_perm:[2,3,0,1] row_mask:0xf bank_mask:0xf
  v_add_f32_dpp v201, v201, v201 row_half_mirror row_mask:0xf bank_mask:0xf
  s_nop 0
  v_add_f32_dpp v200, v200, v200 row_half_mirror row_mask:0xf bank_mask:0xf
  v_mfma_f32_32x32x16_bf16 v[40:55], a[180:183], a[16:19], v[40:55]
  ds_read_b64_tr_b16 a[160:161], v18 offset:24576
  ds_read_b64_tr_b16 a[162:163], v18 offset:25088
  v_add_u32 v4, s96, v2
  v_add_u32 v5, s96, v3
  s_add_u32 m0, s54, 0
  s_nop 0
  buffer_load_dwordx4 v4, s[4:7], s48 offen offset:0 lds
  v_add_f32_dpp v201, v201, v201 row_mirror row_mask:0xf bank_mask:0xf
  v_add_f32_dpp v200, v200, v200 row_mirror row_mask:0xf bank_mask:0xf
  v_mfma_f32_32x32x16_bf16 v[56:71], a[184:187], a[16:19], v[56:71]
  ds_read_b64_tr_b16 a[164:165], v19 offset:24576
  ds_read_b64_tr_b16 a[166:167], v19 offset:25088
  buffer_load_dwordx4 v5, s[4:7], s49 offen offset:1024 lds
  v_add_f32_dpp v201, v201, v201 row_bcast:15 row_mask:0xa bank_mask:0xf
  v_add_f32_dpp v200, v200, v200 row_bcast:15 row_mask:0xa bank_mask:0xf
  v_mfma_f32_32x32x16_bf16 v[72:87], a[188:191], a[16:19], v[72:87]
  ds_read_b64_tr_b16 a[168:169], v20 offset:24576
  ds_read_b64_tr_b16 a[170:171], v20 offset:25088
  buffer_load_dwordx4 v4, s[4:7], s50 offen offset:2048 lds
  v_mul_f32 v201, 986500301, v201
  v_mul_f32 v200, 986500301, v200
  v_fma_f32 v200, -v201, v201, v200
  v_mfma_f32_32x32x16_bf16 v[88:103], a[192:195], a[16:19], v[88:103]
  s_waitcnt lgkmcnt(6)
  ds_read_b64_tr_b16 a[172:173], v21 offset:24576
  ds_read_b64_tr_b16 a[174:175], v21 offset:25088
  buffer_load_dwordx4 v5, s[4:7], s51 offen offset:3072 lds
  s_add_u32 s96, s96, 128
  s_cmp_eq_u32 s96, 1280
  s_cselect_b32 s96, 0, s96
  v_max_f32 v200, 0, v200
  v_sub_f32 v201, 0, v201
  v_mfma_f32_32x32x16_bf16 v[40:55], a[196:199], a[20:23], v[40:55]
  ds_read_b64_tr_b16 a[180:181], v18 offset:28672
  ds_read_b64_tr_b16 a[182:183], v18 offset:29184
  s_waitcnt vmcnt(16)
  ds_read_b128 a[32:35], v6 offset:32768
  ds_read_b128 a[36:39], v7 offset:32768
  ds_read_b128 a[40:43], v8 offset:32768
  ds_read_b128 a[44:47], v9 offset:32768
  s_mul_i32 s55, s97, 196608
  s_add_u32 s55, s55, s98
  s_add_u32 s56, s55, 22528
  s_add_u32 m0, s54, 131072
  s_nop 0
  buffer_load_dwordx4 v10, s[8:11], s55 offen lds
  v_cvt_pk_bf16_f32 v201, v201, v201
  v_cvt_pk_bf16_f32 v200, v200, v200
  v_and_b32 v200, s52, v200
  v_mfma_f32_32x32x16_bf16 v[56:71], a[200:203], a[20:23], v[56:71]
  ds_read_b64_tr_b16 a[184:185], v19 offset:28672
  s_waitcnt lgkmcnt(10)
  ds_read_b64_tr_b16 a[186:187], v19 offset:29184
  buffer_load_dwordx4 v11, s[12:15], s55 offen offset:1024 lds
  v_add_f32 v200, 925353388, v200
  v_cvt_pk_bf16_f32 v200, v200, v200
  v_mfma_f32_32x32x16_bf16 v[72:87], a[204:207], a[20:23], v[72:87]
  ds_read_b64_tr_b16 a[188:189], v20 offset:28672
  ds_read_b64_tr_b16 a[190:191], v20 offset:29184
  buffer_load_dwordx4 v10, s[8:11], s56 offen offset:2048 lds
  v_and_b32 v200, s52, v200
  v_sqrt_f32 v200, v200
  v_mfma_f32_32x32x16_bf16 v[88:103], a[208:211], a[20:23], v[88:103]
  s_waitcnt lgkmcnt(10)
  ds_read_b64_tr_b16 a[192:193], v21 offset:28672
  ds_read_b64_tr_b16 a[194:195], v21 offset:29184
  buffer_load_dwordx4 v11, s[12:15], s56 offen offset:3072 lds
  s_add_u32 s97, s97, 1
  s_cmp_eq_u32 s97, 10
  s_cselect_b32 s97, 0, s97
  v_cvt_pk_bf16_f32 v200, v200, v200
  v_and_b32 v200, s52, v200
  v_mfma_f32_32x32x16_bf16 v[40:55], a[160:163], a[24:27], v[40:55]
  s_waitcnt vmcnt(16)
  s_barrier
  ds_read_b64_tr_b16 a[196:197], v18 offset:32768
  ds_read_b64_tr_b16 a[198:199], v18 offset:33280
  v_rcp_f32 v200, v200
  v_mfma_f32_32x32x16_bf16 v[56:71], a[164:167], a[24:27], v[56:71]
  ds_read_b64_tr_b16 a[200:201], v19 offset:32768
  s_waitcnt lgkmcnt(10)
  ds_read_b64_tr_b16 a[202:203], v19 offset:33280
  v_add_u32 v4, s96, v2
  v_add_u32 v5, s96, v3
  s_add_u32 m0, s54, 16384
  s_nop 0
  buffer_load_dwordx4 v4, s[4:7], s48 offen offset:0 lds
  v_and_b32 v216, 31, v1
  v_cmp_eq_u32 vcc, 16, v216
  v_lshrrev_b32 v216, 1, v1
  v_mfma_f32_32x32x16_bf16 v[72:87], a[168:171], a[24:27], v[72:87]
  ds_read_b64_tr_b16 a[204:205], v20 offset:32768
  ds_read_b64_tr_b16 a[206:207], v20 offset:33280
  v_and_b32 v216, 16, v216
  v_mov_b32 v217, 2130706432
  v_mfma_f32_32x32x16_bf16 v[88:103], a[172:175], a[24:27], v[88:103]
  s_waitcnt lgkmcnt(6)
  ds_read_b64_tr_b16 a[208:209], v21 offset:32768
  ds_read_b64_tr_b16 a[210:211], v21 offset:33280
  buffer_load_dwordx4 v5, s[4:7], s49 offen offset:1024 lds
  v_cndmask_b32 v216, v217, v216, vcc
  v_cmp_eq_u32 vcc, 0, v211
  s_nop 3
  s_cbranch_vccnz X_poll3_slow
X_poll3_ret:
  v_mfma_f32_32x32x16_bf16 v[40:55], a[180:183], a[28:31], v[40:55]
  ds_read_b64_tr_b16 a[160:161], v18 offset:36864
  ds_read_b64_tr_b16 a[162:163], v18 offset:37376
  v_readfirstlane_b32 s92, v211
  s_mul_i32 s44, s43, 3
  v_mfma_f32_32x32x16_bf16 v[56:71], a[184:187], a[28:31], v[56:71]
  ds_read_b64_tr_b16 a[164:165], v19 offset:36864
  ds_read_b64_tr_b16 a[166:167], v19 offset:37376
  buffer_load_dwordx4 v4, s[4:7], s50 offen offset:2048 lds
  s_mul_i32 s83, s44, 12800
  s_add_u32 s83, s83, 15499264
  s_mul_i32 s44, s99, 1280
  v_mfma_f32_32x32x16_bf16 v[72:87], a[188:191], a[28:31], v[72:87]
  ds_read_b64_tr_b16 a[168:169], v20 offset:36864
  ds_read_b64_tr_b16 a[170:171], v20 offset:37376
  s_add_u32 s82, s83, s44
  s_lshl_b32 s44, s42, 8
  v_mfma_f32_32x32x16_bf16 v[88:103], a[192:195], a[28:31], v[88:103]
  s_waitcnt lgkmcnt(6)
  ds_read_b64_tr_b16 a[172:173], v21 offset:36864
  ds_read_b64_tr_b16 a[174:175], v21 offset:37376
  buffer_load_dwordx4 v5, s[4:7], s51 offen offset:3072 lds
  s_add_u32 s96, s96, 128
  s_cmp_eq_u32 s96, 1280
  s_cselect_b32 s96, 0, s96
  s_add_u32 s82, s82, s44
  s_add_u32 s83, s83, s44
  v_mfma_f32_32x32x16_bf16 v[40:55], a[196:199], a[32:35], v[40:55]
  ds_read_b64_tr_b16 a[180:181], v18 offset:40960
  ds_read_b64_tr_b16 a[182:183], v18 offset:41472
  s_mul_i32 s55, s97, 196608
  s_add_u32 s55, s55, s98
  s_add_u32 s56, s55, 22528
  s_add_u32 m0, s54, 147456
  s_nop 0
  buffer_load_dwordx4 v10, s[8:11], s55 offen lds
  s_cmp_lt_u32 s40, 10
  s_cselect_b32 s44, 32, 0
  v_cmp_gt_u32 vcc, s44, v1
  v_mfma_f32_32x32x16_bf16 v[56:71], a[200:203], a[32:35], v[56:71]
  ds_read_b64_tr_b16 a[184:185], v19 offset:40960
  ds_read_b64_tr_b16 a[186:187], v19 offset:41472
  buffer_load_dwordx4 v11, s[12:15], s55 offen offset:1024 lds
  v_lshlrev_b32 v36, 3, v1
  v_mov_b32 v37, 2130706432
  v_mfma_f32_32x32x16_bf16 v[72:87], a[204:207], a[32:35], v[72:87]
  ds_read_b64_tr_b16 a[188:189], v20 offset:40960
  ds_read_b64_tr_b16 a[190:191], v20 offset:41472
  buffer_load_dwordx4 v10, s[8:11], s56 offen offset:2048 lds
  v_cndmask_b32 v36, v37, v36, vcc
  v_mfma_f32_32x32x16_bf16 v[120:135], v[24:27], a[240:243], 0
  v_mfma_f32_32x32x16_bf16 v[120:135], v[24:27], a[244:247], v[120:135]
  v_mfma_f32_32x32x16_bf16 v[88:103], a[208:211], a[32:35], v[88:103]
  s_waitcnt lgkmcnt(6)
  ds_read_b64_tr_b16 a[192:193], v21 offset:40960
  ds_read_b64_tr_b16 a[194:195], v21 offset:41472
  buffer_load_dwordx4 v11, s[12:15], s56 offen offset:3072 lds
  s_add_u32 s97, s97, 1
  s_cmp_eq_u32 s97, 10
  s_cselect_b32 s97, 0, s97
  v_mfma_f32_32x32x16_bf16 v[120:135], v[24:27], a[248:251], v[120:135]
  v_mfma_f32_32x32x16_bf16 v[120:135], v[24:27], a[252:255], v[120:135]
  v_mfma_f32_32x32x16_bf16 v[40:55], a[160:163], a[36:39], v[40:55]
  ds_read_b64_tr_b16 a[196:197], v18 offset:45056
  ds_read_b64_tr_b16 a[198:199], v18 offset:45568
  s_waitcnt vmcnt(12)
  ds_read_b128 a[48:51], v6 offset:0
  ds_read_b128 a[52:55], v7 offset:0
  ds_read_b128 a[56:59], v8 offset:0
  ds_read_b128 a[60:63], v9 offset:0
  v_mov_b32 v202, s92
  v_mov_b32 v203, s92
  v_mfma_f32_32x32x16_bf16 v[56:71], a[164:167], a[36:39], v[56:71]
  ds_read_b64_tr_b16 a[200:201], v19 offset:45056
  s_waitcnt lgkmcnt(10)
  ds_read_b64_tr_b16 a[202:203], v19 offset:45568
  s_mul_i32 s55, s97, 196608
  s_add_u32 s55, s55, s98
  s_add_u32 s56, s55, 22528
  s_add_u32 m0, s54, 81920
  s_nop 0
  buffer_load_dwordx4 v10, s[8:11], s55 offen lds
  v_mfma_f32_32x32x16_bf16 v[72:87], a[168:171], a[36:39], v[72:87]
  ds_read_b64_tr_b16 a[204:205], v20 offset:45056
  ds_read_b64_tr_b16 a[206:207], v20 offset:45568
  buffer_store_dwordx4 v[200:203], v216, s[20:23], s101 offen sc1
  v_mov_b32 v121, s92
  v_mfma_f32_32x32x16_bf16 v[88:103], a[172:175], a[36:39], v[88:103]
  s_waitcnt lgkmcnt(10)
  ds_read_b64_tr_b16 a[208:209], v21 offset:45056
  ds_read_b64_tr_b16 a[210:211], v21 offset:45568
  buffer_load_dwordx4 v11, s[12:15], s55 offen offset:1024 lds
  buffer_store_dwordx2 v[120:121], v36, s[20:23], s82 offen sc1
  v_mfma_f32_32x32x16_bf16 v[40:55], a[180:183], a[40:43], v[40:55]
  s_waitcnt vmcnt(12)
  s_barrier
  ds_read_b64_tr_b16 a[160:161], v18 offset:49152
  ds_read_b64_tr_b16 a[162:163], v18 offset:49664
  v_bfe_u32 v32, v1, 2, 3
  v_lshrrev_b32 v33, 5, v1
  v_lshl_add_u32 v33, v33, 4, v32
  v_lshrrev_b32 v32, 1, v32
  v_mfma_f32_32x32x16_bf16 v[56:71], a[184:187], a[40:43], v[56:71]
  ds_read_b64_tr_b16 a[164:165], v19 offset:49152
  s_waitcnt lgkmcnt(10)
  ds_read_b64_tr_b16 a[166:167], v19 offset:49664
  buffer_load_dwordx4 v10, s[8:11], s56 offen offset:2048 lds
  v_lshlrev_b32 v32, 5, v32
  v_lshl_add_u32 v32, v33, 7, v32
  v_mfma_f32_32x32x16_bf16 v[72:87], a[188:191], a[40:43], v[72:87]
  ds_read_b64_tr_b16 a[168:169], v20 offset:49152
  ds_read_b64_tr_b16 a[170:171], v20 offset:49664
  v_and_b32 v33, 3, v1
  v_lshl_add_u32 v32, v33, 3, v32
  v_mfma_f32_32x32x16_bf16 v[88:103], a[192:195], a[40:43], v[88:103]
  s_waitcnt lgkmcnt(6)
  ds_read_b64_tr_b16 a[172:173], v21 offset:49152
  ds_read_b64_tr_b16 a[174:175], v21 offset:49664
  buffer_load_dwordx4 v11, s[12:15], s56 offen offset:3072 lds
  s_add_u32 s97, s97, 1
  s_cmp_eq_u32 s97, 10
  s_cselect_b32 s97, 0, s97
  v_add_u32 v14, s58, v32
  v_xor_b32 v15, 32, v14
  v_mfma_f32_32x32x16_bf16 v[40:55], a[196:199], a[44:47], v[40:55]
  ds_read_b64_tr_b16 a[180:181], v18 offset:53248
  ds_read_b64_tr_b16 a[182:183], v18 offset:53760
  v_add_u32 v4, s96, v2
  v_add_u32 v5, s96, v3
  s_add_u32 m0, s54, 32768
  s_nop 0
  buffer_load_dwordx4 v4, s[4:7], s48 offen offset:0 lds
  v_xor_b32 v16, 64, v14
  v_xor_b32 v17, 96, v14
  v_mfma_f32_32x32x16_bf16 v[56:71], a[200:203], a[44:47], v[56:71]
  ds_read_b64_tr_b16 a[184:185], v19 offset:53248
  ds_read_b64_tr_b16 a[186:187], v19 offset:53760
  buffer_load_dwordx4 v5, s[4:7], s49 offen offset:1024 lds
  s_mul_i32 s44, s18, 43
  s_lshr_b32 s44, s44, 8
  v_mfma_f32_32x32x16_bf16 v[72:87], a[204:207], a[44:47], v[72:87]
  ds_read_b64_tr_b16 a[188:189], v20 offset:53248
  ds_read_b64_tr_b16 a[190:191], v20 offset:53760
  buffer_load_dwordx4 v4, s[4:7], s50 offen offset:2048 lds
  s_mul_i32 s44, s44, 5
  s_add_u32 s44, s44, s18
  v_mfma_f32_32x32x16_bf16 v[88:103], a[208:211], a[44:47], v[88:103]
  s_waitcnt lgkmcnt(6)
  ds_read_b64_tr_b16 a[192:193], v21 offset:53248
  ds_read_b64_tr_b16 a[194:195], v21 offset:53760
  buffer_load_dwordx4 v5, s[4:7], s51 offen offset:3072 lds
  s_add_u32 s96, s96, 128
  s_cmp_eq_u32 s96, 1280
  s_cselect_b32 s96, 0, s96
  s_mul_i32 s18, s44, 5
  ds_read_b64_tr_b16 v[184:185], v14 offset:49152
  v_mfma_f32_32x32x16_bf16 v[40:55], a[160:163], a[48:51], v[40:55]
  ds_read_b64_tr_b16 a[196:197], v18 offset:57344
  ds_read_b64_tr_b16 a[198:199], v18 offset:57856
  ds_read_b64_tr_b16 v[186:187], v14 offset:50176
  ds_read_b64_tr_b16 v[188:189], v15 offset:49152
  ds_read_b64_tr_b16 v[190:191], v15 offset:50176
  ds_read_b64_tr_b16 v[192:193], v16 offset:49152
  s_waitcnt lgkmcnt(10)
  ds_read_b64_tr_b16 v[194:195], v16 offset:50176
  ds_read_b64_tr_b16 v[196:197], v17 offset:49152
  ds_read_b64_tr_b16 v[198:199], v17 offset:50176
  v_mfma_f32_32x32x16_bf16 v[56:71], a[164:167], a[48:51], v[56:71]
  ds_read_b64_tr_b16 a[200:201], v19 offset:57344
  ds_read_b64_tr_b16 a[202:203], v19 offset:57856
  s_mul_i32 s55, s97, 196608
  s_add_u32 s55, s55, s98
  s_add_u32 s56, s55, 22528
  s_add_u32 m0, s54, 98304
  s_nop 0
  buffer_load_dwordx4 v10, s[8:11], s55 offen lds
  s_lshl_b32 s44, s17, 2
  s_mul_i32 s45, s44, 52
  s_lshr_b32 s45, s45, 8
  s_mul_i32 s46, s45, 5
  s_sub_u32 s47, s44, s46
  s_mul_i32 s46, s45, 435
  s_add_u32 s44, s44, s46
  v_mfma_f32_32x32x16_bf16 v[72:87], a[168:171], a[48:51], v[72:87]
  s_waitcnt lgkmcnt(10)
  ds_read_b64_tr_b16 a[204:205], v20 offset:57344
  ds_read_b64_tr_b16 a[206:207], v20 offset:57856
  s_add_u32 s44, s44, s18
  s_lshl_b32 s44, s44, 10
  s_add_u32 s44, s44, 11534336
  s_movk_i32 s59, 1024
  s_waitcnt lgkmcnt(10)
  buffer_store_dwordx4 v[184:187], v38, s[20:23], s44 offen sc1
  s_cmp_eq_u32 s47, 4
  s_cselect_b32 s46, 446464, s59
  v_mfma_f32_32x32x16_bf16 v[88:103], a[172:175], a[48:51], v[88:103]
  ds_read_b64_tr_b16 a[208:209], v21 offset:57344
  ds_read_b64_tr_b16 a[210:211], v21 offset:57856
  buffer_load_dwordx4 v11, s[12:15], s55 offen offset:1024 lds
  s_add_u32 s44, s44, s46
  v_mfma_f32_32x32x16_bf16 v[40:55], a[180:183], a[52:55], v[40:55]
  ds_read_b64_tr_b16 a[160:161], v18 offset:61440
  ds_read_b64_tr_b16 a[162:163], v18 offset:61952
  s_waitcnt vmcnt(17)
  ds_read_b128 a[64:67], v6 offset:16384
  s_waitcnt lgkmcnt(10)
  ds_read_b128 a[68:71], v7 offset:16384
  ds_read_b128 a[72:75], v8 offset:16384
  ds_read_b128 a[76:79], v9 offset:16384
  buffer_store_dwordx4 v[188:191], v38, s[20:23], s44 offen sc1
  s_cmp_eq_u32 s47, 3
  s_cselect_b32 s46, 446464, s59
  s_add_u32 s44, s44, s46
  v_mfma_f32_32x32x16_bf16 v[56:71], a[184:187], a[52:55], v[56:71]
  ds_read_b64_tr_b16 a[164:165], v19 offset:61440
  ds_read_b64_tr_b16 a[166:167], v19 offset:61952
  buffer_load_dwordx4 v10, s[8:11], s56 offen offset:2048 lds
  v_mfma_f32_32x32x16_bf16 v[72:87], a[188:191], a[52:55], v[72:87]
  s_waitcnt lgkmcnt(10)
  ds_read_b64_tr_b16 a[168:169], v20 offset:61440
  ds_read_b64_tr_b16 a[170:171], v20 offset:61952
  buffer_store_dwordx4 v[192:195], v38, s[20:23], s44 offen sc1
  s_cmp_eq_u32 s47, 2
  s_cselect_b32 s46, 446464, s59
  s_add_u32 s44, s44, s46
  v_mfma_f32_32x32x16_bf16 v[88:103], a[192:195], a[52:55], v[88:103]
  s_waitcnt lgkmcnt(10)
  ds_read_b64_tr_b16 a[172:173], v21 offset:61440
  ds_read_b64_tr_b16 a[174:175], v21 offset:61952
  buffer_load_dwordx4 v11, s[12:15], s56 offen offset:3072 lds
  s_add_u32 s97, s97, 1
  s_cmp_eq_u32 s97, 10
  s_cselect_b32 s97, 0, s97
  v_mfma_f32_32x32x16_bf16 v[40:55], a[196:199], a[56:59], v[40:55]
  s_waitcnt vmcnt(17)
  s_barrier
  v_add_u32 v18, 65536, v18
  v_add_u32 v19, 65536, v19
  v_add_u32 v20, 65536, v20
  v_add_u32 v21, 65536, v21
  ds_read_b64_tr_b16 a[180:181], v18 offset:0
  ds_read_b64_tr_b16 a[182:183], v18 offset:512
  s_and_b32 s78, s40, 11
  s_and_b32 s85, s41, 4
  buffer_store_dwordx4 v[196:199], v38, s[20:23], s44 offen sc1
  v_lshlrev_b32 v153, 16, v153
  v_lshlrev_b32 v154, 16, v154
  v_lshlrev_b32 v155, 16, v155
  v_mul_f32 v155, 1069066811, v155
  v_exp_f32 v155, v155
  s_nop 0
  v_cvt_pk_bf16_f32 v155, v155, v155
  v_and_b32 v155, s52, v155
  v_mul_f32 v156, v155, v153
  v_mfma_f32_32x32x16_bf16 v[56:71], a[200:203], a[56:59], v[56:71]
  ds_read_b64_tr_b16 a[184:185], v19 offset:0
  s_waitcnt lgkmcnt(10)
  ds_read_b64_tr_b16 a[186:187], v19 offset:512
  v_add_u32 v4, s96, v2
  v_add_u32 v5, s96, v3
  s_add_u32 m0, s54, 0
  s_nop 0
  buffer_load_dwordx4 v4, s[4:7], s48 offen offset:0 lds
  s_or_b32 s78, s78, s85
  v_mul_f32 v157, v155, v154
  v_mul_f32 v156, 1069066811, v156
  v_mul_f32 v157, 1042479491, v157
  v_exp_f32 v168, v156
  v_fract_f32 v169, v157
  v_cos_f32 v170, v169
  v_mfma_f32_32x32x16_bf16 v[72:87], a[204:207], a[56:59], v[72:87]
  ds_read_b64_tr_b16 a[188:189], v20 offset:0
  ds_read_b64_tr_b16 a[190:191], v20 offset:512
  s_and_b32 s79, s41, 3
  s_lshl_b32 s79, s79, 1
  v_sin_f32 v171, v169
  v_mul_f32 v160, v168, v170
  v_mul_f32 v161, v168, v171
  v_add_f32 v168, -1.0, v160
  v_mul_f32 v169, v153, v153
  v_fmac_f32 v169, v154, v154
  v_rcp_f32 v169, v169
  v_mfma_f32_32x32x16_bf16 v[88:103], a[208:211], a[56:59], v[88:103]
  s_waitcnt lgkmcnt(6)
  ds_read_b64_tr_b16 a[192:193], v21 offset:0
  ds_read_b64_tr_b16 a[194:195], v21 offset:512
  buffer_load_dwordx4 v5, s[4:7], s49 offen offset:1024 lds
  s_bfe_u32 s85, s40, 0x10002
  s_add_u32 s79, s79, s85
  v_mul_f32 v170, v168, v153
  v_fmac_f32 v170, v161, v154
  v_mul_f32 v171, v161, v153
  v_fma_f32 v171, -v168, v154, v171
  v_add_f32 v169, v169, v169
  v_mul_f32 v156, v170, v169
  v_mul_f32 v157, v171, v169
  v_mfma_f32_32x32x16_bf16 v[40:55], a[160:163], a[60:63], v[40:55]
  ds_read_b64_tr_b16 a[196:197], v18 offset:4096
  ds_read_b64_tr_b16 a[198:199], v18 offset:4608
  s_and_b32 s85, s41, 8
  v_sub_f32 v157, 0, v157
  v_sub_f32 v158, 0, v156
  v_lshlrev_b32 v32, 2, v1
  v_add_u32 v32, s58, v32
  ds_write_b32 v32, v156 offset:49152
  ds_write_b32 v32, v157 offset:49408
  ds_write_b32 v32, v158 offset:49664
  v_bfe_u32 v32, v1, 1, 3
  v_mfma_f32_32x32x16_bf16 v[56:71], a[164:167], a[60:63], v[56:71]
  ds_read_b64_tr_b16 a[200:201], v19 offset:4096
  ds_read_b64_tr_b16 a[202:203], v19 offset:4608
  buffer_load_dwordx4 v4, s[4:7], s50 offen offset:2048 lds
  s_add_u32 s79, s79, s85
  s_lshr_b32 s86, s79, 3
  v_bfe_u32 v33, v1, 4, 1
  v_xor_b32 v32, v32, v33
  v_lshlrev_b32 v32, 4, v32
  v_and_b32 v34, 15, v1
  v_lshl_add_u32 v32, v34, 7, v32
  v_add_u32 v14, s58, v32
  v_xor_b32 v15, 32, v14
  v_xor_b32 v16, 64, v14
  v_mfma_f32_32x32x16_bf16 v[72:87], a[168:171], a[60:63], v[72:87]
  s_waitcnt lgkmcnt(10)
  ds_read_b64_tr_b16 a[204:205], v20 offset:4096
  ds_read_b64_tr_b16 a[206:207], v20 offset:4608
  s_lshl_b32 s85, s86, 2
  s_add_u32 s85, s85, s42
  v_xor_b32 v17, 96, v14
  v_lshrrev_b32 v34, 5, v1
  v_lshlrev_b32 v34, 8, v34
  v_lshl_add_u32 v34, v33, 5, v34
  v_add_u32 v22, s58, v34
  s_mul_i32 s45, s19, 52
  s_lshr_b32 s45, s45, 8
  s_mul_i32 s45, s45, 435
  v_mfma_f32_32x32x16_bf16 v[88:103], a[172:175], a[60:63], v[88:103]
  s_waitcnt lgkmcnt(9)
  ds_read_b64_tr_b16 a[208:209], v21 offset:4096
  ds_read_b64_tr_b16 a[210:211], v21 offset:4608
  buffer_load_dwordx4 v5, s[4:7], s51 offen offset:3072 lds
  s_add_u32 s96, s96, 128
  s_cmp_eq_u32 s96, 1280
  s_cselect_b32 s96, 0, s96
  s_and_b32 s87, s79, 7
  s_mul_i32 s87, s87, 5
  s_add_u32 s19, s45, s19
  ds_read_b128 v[136:139], v14 offset:53248
  ds_read_b128 v[140:143], v14 offset:55296
  ds_read_b128 v[152:155], v22 offset:49152
  ds_read_b128 v[160:163], v22 offset:49408
  s_waitcnt lgkmcnt(10)
  ds_read_b128 v[156:159], v22 offset:49168
  ds_read_b128 v[164:167], v22 offset:49424
  v_mfma_f32_32x32x16_bf16 v[40:55], a[180:183], a[64:67], v[40:55]
  ds_read_b64_tr_b16 a[160:161], v18 offset:8192
  ds_read_b64_tr_b16 a[162:163], v18 offset:8704
  s_mov_b32 s69, 15941632
  s_lshl_b32 s44, s16, 2
  s_mul_i32 s45, s44, 52
  s_lshr_b32 s45, s45, 8
  s_mul_i32 s46, s45, 5
  s_sub_u32 s47, s44, s46
  s_mul_i32 s45, s45, 6
  s_add_u32 s44, s44, s45
  s_mul_i32 s44, s44, 5
  v_mfma_f32_32x32x16_bf16 v[56:71], a[184:187], a[64:67], v[56:71]
  ds_read_b64_tr_b16 a[164:165], v19 offset:8192
  s_waitcnt lgkmcnt(10)
  ds_read_b64_tr_b16 a[166:167], v19 offset:8704
  s_mul_i32 s55, s97, 196608
  s_add_u32 s55, s55, s98
  s_add_u32 s56, s55, 22528
  s_add_u32 m0, s54, 114688
  s_nop 0
  buffer_load_dwordx4 v10, s[8:11], s55 offen lds
  s_mul_i32 s88, s85, 6
  s_mul_i32 s85, s85, 5
  s_add_u32 s44, s44, s19
  s_lshl_b32 s44, s44, 10
  s_add_u32 s44, s44, 11565056
  s_movk_i32 s59, 5120
  s_waitcnt lgkmcnt(9)
  v_lshlrev_b32 v144, 16, v136
  v_and_b32 v145, s52, v136
  s_waitcnt lgkmcnt(8)
  v_lshlrev_b32 v146, 16, v140
  v_and_b32 v147, s52, v140
  v_mfma_f32_32x32x16_bf16 v[72:87], a[188:191], a[64:67], v[72:87]
  ds_read_b64_tr_b16 a[168:169], v20 offset:8192
  ds_read_b64_tr_b16 a[170:171], v20 offset:8704
  s_sub_u32 s84, s87, 6
  v_min_u32 v250, 21, v1
  s_waitcnt lgkmcnt(9)
  v_mul_f32 v144, v152, v144
  v_mul_f32 v145, v153, v145
  s_waitcnt lgkmcnt(8)
  v_fmac_f32 v144, v160, v146
  v_fmac_f32 v145, v161, v147
  v_cvt_pk_bf16_f32 v184, v144, v145
  v_lshlrev_b32 v144, 16, v137
  v_and_b32 v145, s52, v137
  v_lshlrev_b32 v146, 16, v141
  v_mfma_f32_32x32x16_bf16 v[88:103], a[192:195], a[64:67], v[88:103]
  ds_read_b64_tr_b16 a[172:173], v21 offset:8192
  ds_read_b64_tr_b16 a[174:175], v21 offset:8704
  buffer_load_dwordx4 v11, s[12:15], s55 offen offset:1024 lds
  v_cmp_gt_u32 s[64:65], 12, v250
  v_and_b32 v147, s52, v141
  v_mul_f32 v144, v154, v144
  v_mul_f32 v145, v155, v145
  v_fmac_f32 v144, v162, v146
  v_fmac_f32 v145, v163, v147
  v_cvt_pk_bf16_f32 v185, v144, v145
  v_lshlrev_b32 v144, 16, v138
  v_and_b32 v145, s52, v138
  v_mfma_f32_32x32x16_bf16 v[40:55], a[196:199], a[68:71], v[40:55]
  ds_read_b64_tr_b16 a[180:181], v18 offset:12288
  ds_read_b64_tr_b16 a[182:183], v18 offset:12800
  s_waitcnt vmcnt(14)
  ds_read_b128 a[80:83], v6 offset:32768
  ds_read_b128 a[84:87], v7 offset:32768
  ds_read_b128 a[88:91], v8 offset:32768
  s_waitcnt lgkmcnt(10)
  ds_read_b128 a[92:95], v9 offset:32768
  v_mov_b32 v248, s84
  v_mov_b32 v249, s88
  v_lshlrev_b32 v146, 16, v142
  v_and_b32 v147, s52, v142
  v_mul_f32 v144, v156, v144
  v_mul_f32 v145, v157, v145
  v_fmac_f32 v144, v164, v146
  v_fmac_f32 v145, v165, v147
  v_cvt_pk_bf16_f32 v186, v144, v145
  v_lshlrev_b32 v144, 16, v139
  v_mfma_f32_32x32x16_bf16 v[56:71], a[200:203], a[68:71], v[56:71]
  ds_read_b64_tr_b16 a[184:185], v19 offset:12288
  ds_read_b64_tr_b16 a[186:187], v19 offset:12800
  buffer_load_dwordx4 v10, s[8:11], s56 offen offset:2048 lds
  v_cndmask_b32 v248, v248, v249, s[64:65]
  v_mov_b32 v249, s85
  v_and_b32 v145, s52, v139
  v_lshlrev_b32 v146, 16, v143
  v_and_b32 v147, s52, v143
  v_mul_f32 v144, v158, v144
  v_mul_f32 v145, v159, v145
  v_fmac_f32 v144, v166, v146
  v_fmac_f32 v145, v167, v147
  v_cvt_pk_bf16_f32 v187, v144, v145
  v_mfma_f32_32x32x16_bf16 v[72:87], a[204:207], a[68:71], v[72:87]
  ds_read_b64_tr_b16 a[188:189], v20 offset:12288
  ds_read_b64_tr_b16 a[190:191], v20 offset:12800
  v_mov_b32 v243, s87
  buffer_store_dwordx4 v[184:187], v38, s[20:23], s44 offen sc1
  s_waitcnt lgkmcnt(10)
  ds_read_b128 v[136:139], v15 offset:53248
  ds_read_b128 v[140:143], v15 offset:55296
  ds_read_b128 v[152:155], v22 offset:49216
  ds_read_b128 v[160:163], v22 offset:49472
  ds_read_b128 v[156:159], v22 offset:49232
  s_waitcnt lgkmcnt(10)
  ds_read_b128 v[164:167], v22 offset:49488
  s_cmp_eq_u32 s47, 4
  s_cselect_b32 s46, 35840, s59
  v_mfma_f32_32x32x16_bf16 v[88:103], a[208:211], a[68:71], v[88:103]
  ds_read_b64_tr_b16 a[192:193], v21 offset:12288
  ds_read_b64_tr_b16 a[194:195], v21 offset:12800
  buffer_load_dwordx4 v11, s[12:15], s56 offen offset:3072 lds
  s_add_u32 s97, s97, 1
  s_cmp_eq_u32 s97, 10
  s_cselect_b32 s97, 0, s97
  v_cndmask_b32 v249, v249, v243, s[64:65]
  v_lshrrev_b32 v243, 1, v250
  s_add_u32 s44, s44, s46
  s_waitcnt lgkmcnt(7)
  v_lshlrev_b32 v144, 16, v136
  v_and_b32 v145, s52, v136
  s_waitcnt lgkmcnt(6)
  v_lshlrev_b32 v146, 16, v140
  v_and_b32 v147, s52, v140
  s_waitcnt lgkmcnt(5)
  v_mul_f32 v144, v152, v144
  v_mul_f32 v145, v153, v145
  v_mfma_f32_32x32x16_bf16 v[40:55], a[160:163], a[72:75], v[40:55]
  s_barrier
  v_add_u32 v18, 4294901760, v18
  v_add_u32 v19, 4294901760, v19
  v_add_u32 v20, 4294901760, v20
  v_add_u32 v21, 4294901760, v21
  ds_read_b64_tr_b16 a[196:197], v18 offset:0
  ds_read_b64_tr_b16 a[198:199], v18 offset:512
  v_add_u32 v248, v248, v243
  v_and_b32 v250, 1, v250
  s_waitcnt lgkmcnt(6)
  v_fmac_f32 v144, v160, v146
  v_fmac_f32 v145, v161, v147
  v_cvt_pk_bf16_f32 v188, v144, v145
  v_lshlrev_b32 v144, 16, v137
  v_and_b32 v145, s52, v137
  v_lshlrev_b32 v146, 16, v141
  v_and_b32 v147, s52, v141
  v_mul_f32 v144, v154, v144
  v_mfma_f32_32x32x16_bf16 v[56:71], a[164:167], a[72:75], v[56:71]
  ds_read_b64_tr_b16 a[200:201], v19 offset:0
  ds_read_b64_tr_b16 a[202:203], v19 offset:512
  v_add_u32 v4, s96, v2
  v_add_u32 v5, s96, v3
  s_add_u32 m0, s54, 16384
  s_nop 0
  buffer_load_dwordx4 v4, s[4:7], s48 offen offset:0 lds
  v_lshl_add_u32 v249, v250, 2, v249
  v_mul_f32 v145, v155, v145
  v_fmac_f32 v144, v162, v146
  v_fmac_f32 v145, v163, v147
  v_cvt_pk_bf16_f32 v189, v144, v145
  v_lshlrev_b32 v144, 16, v138
  v_and_b32 v145, s52, v138
  v_lshlrev_b32 v146, 16, v142
  v_and_b32 v147, s52, v142
  v_mfma_f32_32x32x16_bf16 v[72:87], a[168:171], a[72:75], v[72:87]
  ds_read_b64_tr_b16 a[204:205], v20 offset:0
  ds_read_b64_tr_b16 a[206:207], v20 offset:512
  v_lshrrev_b32 v249, 2, v249
  v_mad_u32_u24 v248, v248, 10, v249
  s_waitcnt lgkmcnt(9)
  v_mul_f32 v144, v156, v144
  v_mul_f32 v145, v157, v145
  s_waitcnt lgkmcnt(8)
  v_fmac_f32 v144, v164, v146
  v_fmac_f32 v145, v165, v147
  v_cvt_pk_bf16_f32 v190, v144, v145
  v_lshlrev_b32 v144, 16, v139
  v_and_b32 v145, s52, v139
  v_mfma_f32_32x32x16_bf16 v[88:103], a[172:175], a[72:75], v[88:103]
  s_waitcnt lgkmcnt(6)
  ds_read_b64_tr_b16 a[208:209], v21 offset:0
  ds_read_b64_tr_b16 a[210:211], v21 offset:512
  buffer_load_dwordx4 v5, s[4:7], s49 offen offset:1024 lds
  v_lshrrev_b32 v248, 2, v248
  v_lshlrev_b32 v248, 7, v248
  v_lshlrev_b32 v146, 16, v143
  v_and_b32 v147, s52, v143
  v_mul_f32 v144, v158, v144
  v_mul_f32 v145, v159, v145
  v_fmac_f32 v144, v166, v146
  v_fmac_f32 v145, v167, v147
  v_cvt_pk_bf16_f32 v191, v144, v145
  v_mfma_f32_32x32x16_bf16 v[40:55], a[180:183], a[76:79], v[40:55]
  ds_read_b64_tr_b16 a[160:161], v18 offset:4096
  ds_read_b64_tr_b16 a[162:163], v18 offset:4608
  s_lshr_b32 s86, s79, 3
  buffer_store_dwordx4 v[188:191], v38, s[20:23], s44 offen sc1
  ds_read_b128 v[136:139], v16 offset:53248
  ds_read_b128 v[140:143], v16 offset:55296
  ds_read_b128 v[152:155], v22 offset:49280
  ds_read_b128 v[160:163], v22 offset:49536
  ds_read_b128 v[156:159], v22 offset:49296
  s_waitcnt lgkmcnt(10)
  ds_read_b128 v[164:167], v22 offset:49552
  s_cmp_eq_u32 s47, 3
  s_cselect_b32 s46, 35840, s59
  s_add_u32 s44, s44, s46
  v_mfma_f32_32x32x16_bf16 v[56:71], a[184:187], a[76:79], v[56:71]
  ds_read_b64_tr_b16 a[164:165], v19 offset:4096
  ds_read_b64_tr_b16 a[166:167], v19 offset:4608
  buffer_load_dwordx4 v4, s[4:7], s50 offen offset:2048 lds
  s_lshl_b32 s85, s86, 2
  s_add_u32 s85, s85, s42
  s_waitcnt lgkmcnt(7)
  v_lshlrev_b32 v144, 16, v136
  v_and_b32 v145, s52, v136
  s_waitcnt lgkmcnt(6)
  v_lshlrev_b32 v146, 16, v140
  v_and_b32 v147, s52, v140
  s_waitcnt lgkmcnt(5)
  v_mul_f32 v144, v152, v144
  v_mul_f32 v145, v153, v145
  s_waitcnt lgkmcnt(4)
  v_fmac_f32 v144, v160, v146
  v_mfma_f32_32x32x16_bf16 v[72:87], a[188:191], a[76:79], v[72:87]
  ds_read_b64_tr_b16 a[168:169], v20 offset:4096
  ds_read_b64_tr_b16 a[170:171], v20 offset:4608
  s_mul_i32 s85, s85, 11
  s_and_b32 s87, s79, 7
  v_fmac_f32 v145, v161, v147
  v_cvt_pk_bf16_f32 v192, v144, v145
  v_lshlrev_b32 v144, 16, v137
  v_and_b32 v145, s52, v137
  v_lshlrev_b32 v146, 16, v141
  v_and_b32 v147, s52, v141
  v_mul_f32 v144, v154, v144
  v_mul_f32 v145, v155, v145
  v_mfma_f32_32x32x16_bf16 v[88:103], a[192:195], a[76:79], v[88:103]
  ds_read_b64_tr_b16 a[172:173], v21 offset:4096
  ds_read_b64_tr_b16 a[174:175], v21 offset:4608
  buffer_load_dwordx4 v5, s[4:7], s51 offen offset:3072 lds
  s_add_u32 s96, s96, 128
  s_cmp_eq_u32 s96, 1280
  s_cselect_b32 s96, 0, s96
  s_mul_i32 s87, s87, 88
  v_fmac_f32 v144, v162, v146
  v_fmac_f32 v145, v163, v147
  v_cvt_pk_bf16_f32 v193, v144, v145
  v_lshlrev_b32 v144, 16, v138
  v_and_b32 v145, s52, v138
  v_lshlrev_b32 v146, 16, v142
  v_and_b32 v147, s52, v142
  s_waitcnt lgkmcnt(7)
  v_mul_f32 v144, v156, v144
  v_mfma_f32_32x32x16_bf16 v[40:55], a[196:199], a[80:83], v[40:55]
  ds_read_b64_tr_b16 a[180:181], v18 offset:8192
  ds_read_b64_tr_b16 a[182:183], v18 offset:8704
  s_add_u32 s87, s87, s85
  s_mul_i32 s66, s87, 5120
  v_mul_f32 v145, v157, v145
  s_waitcnt lgkmcnt(8)
  v_fmac_f32 v144, v164, v146
  v_fmac_f32 v145, v165, v147
  v_cvt_pk_bf16_f32 v194, v144, v145
  v_lshlrev_b32 v144, 16, v139
  v_and_b32 v145, s52, v139
  v_lshlrev_b32 v146, 16, v143
  v_and_b32 v147, s52, v143
  v_mfma_f32_32x32x16_bf16 v[56:71], a[200:203], a[80:83], v[56:71]
  ds_read_b64_tr_b16 a[184:185], v19 offset:8192
  ds_read_b64_tr_b16 a[186:187], v19 offset:8704
  s_mul_i32 s55, s97, 196608
  s_add_u32 s55, s55, s98
  s_add_u32 s56, s55, 22528
  s_add_u32 m0, s54, 131072
  s_nop 0
  buffer_load_dwordx4 v10, s[8:11], s55 offen lds
  s_add_u32 s66, s66, 11534336
  s_lshl_b32 s87, s78, 1
  v_mul_f32 v144, v158, v144
  v_mul_f32 v145, v159, v145
  v_fmac_f32 v144, v166, v146
  v_fmac_f32 v145, v167, v147
  v_cvt_pk_bf16_f32 v195, v144, v145
  v_mfma_f32_32x32x16_bf16 v[72:87], a[204:207], a[80:83], v[72:87]
  ds_read_b64_tr_b16 a[188:189], v20 offset:8192
  ds_read_b64_tr_b16 a[190:191], v20 offset:8704
  s_add_u32 s88, s87, s86
  s_mul_i32 s88, s88, 88
  buffer_store_dwordx4 v[192:195], v38, s[20:23], s44 offen sc1
  ds_read_b128 v[136:139], v17 offset:53248
  ds_read_b128 v[140:143], v17 offset:55296
  ds_read_b128 v[152:155], v22 offset:49344
  s_waitcnt lgkmcnt(10)
  ds_read_b128 v[160:163], v22 offset:49600
  ds_read_b128 v[156:159], v22 offset:49360
  ds_read_b128 v[164:167], v22 offset:49616
  s_cmp_eq_u32 s47, 2
  s_cselect_b32 s46, 35840, s59
  s_add_u32 s44, s44, s46
  s_waitcnt lgkmcnt(5)
  v_lshlrev_b32 v144, 16, v136
  v_mfma_f32_32x32x16_bf16 v[88:103], a[208:211], a[80:83], v[88:103]
  ds_read_b64_tr_b16 a[192:193], v21 offset:8192
  ds_read_b64_tr_b16 a[194:195], v21 offset:8704
  buffer_load_dwordx4 v11, s[12:15], s55 offen offset:1024 lds
  s_add_u32 s88, s88, s85
  v_and_b32 v145, s52, v136
  s_waitcnt lgkmcnt(6)
  v_lshlrev_b32 v146, 16, v140
  v_and_b32 v147, s52, v140
  s_waitcnt lgkmcnt(5)
  v_mul_f32 v144, v152, v144
  v_mul_f32 v145, v153, v145
  s_waitcnt lgkmcnt(4)
  v_fmac_f32 v144, v160, v146
  v_fmac_f32 v145, v161, v147
  v_cvt_pk_bf16_f32 v196, v144, v145
  v_mfma_f32_32x32x16_bf16 v[40:55], a[160:163], a[84:87], v[40:55]
  ds_read_b64_tr_b16 a[196:197], v18 offset:12288
  ds_read_b64_tr_b16 a[198:199], v18 offset:12800
  s_waitcnt vmcnt(13)
  ds_read_b128 a[96:99], v6 offset:0
  ds_read_b128 a[100:103], v7 offset:0
  ds_read_b128 a[104:107], v8 offset:0
  ds_read_b128 a[108:111], v9 offset:0
  s_lshl_b32 s67, s88, 12
  s_xor_b32 s86, s86, 1
  v_lshlrev_b32 v144, 16, v137
  v_and_b32 v145, s52, v137
  v_lshlrev_b32 v146, 16, v141
  v_and_b32 v147, s52, v141
  v_mul_f32 v144, v154, v144
  v_mul_f32 v145, v155, v145
  v_fmac_f32 v144, v162, v146
  v_fmac_f32 v145, v163, v147
  v_mfma_f32_32x32x16_bf16 v[56:71], a[164:167], a[84:87], v[56:71]
  ds_read_b64_tr_b16 a[200:201], v19 offset:12288
  ds_read_b64_tr_b16 a[202:203], v19 offset:12800
  buffer_load_dwordx4 v10, s[8:11], s56 offen offset:2048 lds
  s_add_u32 s88, s87, s86
  s_mul_i32 s88, s88, 88
  v_cvt_pk_bf16_f32 v197, v144, v145
  v_lshlrev_b32 v144, 16, v138
  v_and_b32 v145, s52, v138
  v_lshlrev_b32 v146, 16, v142
  v_and_b32 v147, s52, v142
  s_waitcnt lgkmcnt(11)
  v_mul_f32 v144, v156, v144
  v_mul_f32 v145, v157, v145
  s_waitcnt lgkmcnt(10)
  v_fmac_f32 v144, v164, v146
  v_mfma_f32_32x32x16_bf16 v[72:87], a[168:171], a[84:87], v[72:87]
  ds_read_b64_tr_b16 a[204:205], v20 offset:12288
  ds_read_b64_tr_b16 a[206:207], v20 offset:12800
  s_add_u32 s88, s88, s85
  v_fmac_f32 v145, v165, v147
  v_cvt_pk_bf16_f32 v198, v144, v145
  v_lshlrev_b32 v144, 16, v139
  v_and_b32 v145, s52, v139
  v_lshlrev_b32 v146, 16, v143
  v_and_b32 v147, s52, v143
  v_mul_f32 v144, v158, v144
  v_mul_f32 v145, v159, v145
  v_mfma_f32_32x32x16_bf16 v[88:103], a[172:175], a[84:87], v[88:103]
  s_waitcnt lgkmcnt(10)
  ds_read_b64_tr_b16 a[208:209], v21 offset:12288
  ds_read_b64_tr_b16 a[210:211], v21 offset:12800
  buffer_load_dwordx4 v11, s[12:15], s56 offen offset:3072 lds
  s_add_u32 s97, s97, 1
  s_cmp_eq_u32 s97, 10
  s_cselect_b32 s97, 0, s97
  s_lshl_b32 s68, s88, 12
  s_lshl_b32 s88, s42, 10
  v_fmac_f32 v144, v166, v146
  v_fmac_f32 v145, v167, v147
  v_cvt_pk_bf16_f32 v199, v144, v145
  buffer_store_dwordx4 v[196:199], v38, s[20:23], s44 offen sc1
  s_lshl_b32 s44, s40, 7
  s_lshl_b32 s45, s43, 11
  s_add_u32 s44, s44, s45
  s_add_u32 s62, s44, 15941632
  v_mfma_f32_32x32x16_bf16 v[40:55], a[180:183], a[88:91], v[40:55]
  s_barrier
  ds_read_b64_tr_b16 a[160:161], v18 offset:16384
  ds_read_b64_tr_b16 a[162:163], v18 offset:16896
  s_lshl_b32 s87, s40, 11
  s_lshl_b32 s86, s42, 9
  s_add_u32 s87, s87, s86
  v_mfma_f32_32x32x16_bf16 v[56:71], a[184:187], a[88:91], v[56:71]
  ds_read_b64_tr_b16 a[164:165], v19 offset:16384
  s_waitcnt lgkmcnt(10)
  ds_read_b64_tr_b16 a[166:167], v19 offset:16896
  v_add_u32 v4, s96, v2
  v_add_u32 v5, s96, v3
  s_add_u32 m0, s54, 32768
  s_nop 0
  buffer_load_dwordx4 v4, s[4:7], s48 offen offset:0 lds
  s_add_u32 s100, s87, 15138816
  v_mfma_f32_32x32x16_bf16 v[72:87], a[188:191], a[88:91], v[72:87]
  ds_read_b64_tr_b16 a[168:169], v20 offset:16384
  ds_read_b64_tr_b16 a[170:171], v20 offset:16896
  buffer_load_dwordx4 v[28:31], v212, s[20:23], s100 offen sc1
  v_lshrrev_b32 v209, 5, v1
  v_mul_u32_u24 v209, 6400, v209
  v_and_b32 v37, 31, v1
  v_mfma_f32_32x32x16_bf16 v[88:103], a[192:195], a[88:91], v[88:103]
  s_waitcnt lgkmcnt(6)
  ds_read_b64_tr_b16 a[172:173], v21 offset:16384
  ds_read_b64_tr_b16 a[174:175], v21 offset:16896
  buffer_load_dwordx4 v5, s[4:7], s49 offen offset:1024 lds
  v_lshl_add_u32 v209, v37, 3, v209
  s_add_u32 s82, s83, 3840
  v_mfma_f32_32x32x16_bf16 v[40:55], a[196:199], a[92:95], v[40:55]
  ds_read_b64_tr_b16 a[180:181], v18 offset:20480
  ds_read_b64_tr_b16 a[182:183], v18 offset:20992
  buffer_load_dwordx2 v[120:121], v209, s[20:23], s83 offen offset:0 sc1
  v_mfma_f32_32x32x16_bf16 v[56:71], a[200:203], a[92:95], v[56:71]
  ds_read_b64_tr_b16 a[184:185], v19 offset:20480
  ds_read_b64_tr_b16 a[186:187], v19 offset:20992
  buffer_load_dwordx4 v4, s[4:7], s50 offen offset:2048 lds
  v_mfma_f32_32x32x16_bf16 v[72:87], a[204:207], a[92:95], v[72:87]
  ds_read_b64_tr_b16 a[188:189], v20 offset:20480
  ds_read_b64_tr_b16 a[190:191], v20 offset:20992
  buffer_load_dwordx2 v[122:123], v209, s[20:23], s83 offen offset:1280 sc1
  v_mfma_f32_32x32x16_bf16 v[88:103], a[208:211], a[92:95], v[88:103]
  s_waitcnt lgkmcnt(6)
  ds_read_b64_tr_b16 a[192:193], v21 offset:20480
  ds_read_b64_tr_b16 a[194:195], v21 offset:20992
  buffer_load_dwordx4 v5, s[4:7], s51 offen offset:3072 lds
  s_add_u32 s96, s96, 128
  s_cmp_eq_u32 s96, 1280
  s_cselect_b32 s96, 0, s96
  v_mfma_f32_32x32x16_bf16 v[40:55], a[160:163], a[96:99], v[40:55]
  ds_read_b64_tr_b16 a[196:197], v18 offset:24576
  ds_read_b64_tr_b16 a[198:199], v18 offset:25088
  buffer_load_dwordx2 v[124:125], v209, s[20:23], s83 offen offset:2560 sc1
  v_mfma_f32_32x32x16_bf16 v[56:71], a[164:167], a[96:99], v[56:71]
  ds_read_b64_tr_b16 a[200:201], v19 offset:24576
  ds_read_b64_tr_b16 a[202:203], v19 offset:25088
  s_mul_i32 s55, s97, 196608
  s_add_u32 s55, s55, s98
  s_add_u32 s56, s55, 22528
  s_add_u32 m0, s54, 147456
  s_nop 0
  buffer_load_dwordx4 v10, s[8:11], s55 offen lds
  v_mfma_f32_32x32x16_bf16 v[72:87], a[168:171], a[96:99], v[72:87]
  ds_read_b64_tr_b16 a[204:205], v20 offset:24576
  ds_read_b64_tr_b16 a[206:207], v20 offset:25088
  buffer_load_dwordx2 v[126:127], v209, s[20:23], s82 offen offset:0 sc1
  v_mfma_f32_32x32x16_bf16 v[88:103], a[172:175], a[96:99], v[88:103]
  s_waitcnt lgkmcnt(6)
  ds_read_b64_tr_b16 a[208:209], v21 offset:24576
  ds_read_b64_tr_b16 a[210:211], v21 offset:25088
  buffer_load_dwordx4 v11, s[12:15], s55 offen offset:1024 lds
  v_mfma_f32_32x32x16_bf16 v[40:55], a[180:183], a[100:103], v[40:55]
  ds_read_b64_tr_b16 a[160:161], v18 offset:28672
  ds_read_b64_tr_b16 a[162:163], v18 offset:29184
  s_waitcnt vmcnt(17)
  ds_read_b128 a[112:115], v6 offset:16384
  ds_read_b128 a[116:119], v7 offset:16384
  ds_read_b128 a[120:123], v8 offset:16384
  ds_read_b128 a[124:127], v9 offset:16384
  buffer_load_dwordx2 v[128:129], v209, s[20:23], s82 offen offset:1280 sc1
  v_mfma_f32_32x32x16_bf16 v[56:71], a[184:187], a[100:103], v[56:71]
  ds_read_b64_tr_b16 a[164:165], v19 offset:28672
  s_waitcnt lgkmcnt(10)
  ds_read_b64_tr_b16 a[166:167], v19 offset:29184
  buffer_load_dwordx4 v10, s[8:11], s56 offen offset:2048 lds
  v_mfma_f32_32x32x16_bf16 v[72:87], a[188:191], a[100:103], v[72:87]
  ds_read_b64_tr_b16 a[168:169], v20 offset:28672
  ds_read_b64_tr_b16 a[170:171], v20 offset:29184
  v_mfma_f32_32x32x16_bf16 v[88:103], a[192:195], a[100:103], v[88:103]
  s_waitcnt lgkmcnt(10)
  ds_read_b64_tr_b16 a[172:173], v21 offset:28672
  ds_read_b64_tr_b16 a[174:175], v21 offset:29184
  buffer_load_dwordx4 v11, s[12:15], s56 offen offset:3072 lds
  s_add_u32 s97, s97, 1
  s_cmp_eq_u32 s97, 10
  s_cselect_b32 s97, 0, s97
  v_mfma_f32_32x32x16_bf16 v[40:55], a[196:199], a[104:107], v[40:55]
  s_waitcnt vmcnt(14)
  s_barrier
  buffer_store_dword v211, v208, s[20:23], s62 offen sc1
  ds_read_b64_tr_b16 a[180:181], v18 offset:32768
  ds_read_b64_tr_b16 a[182:183], v18 offset:33280
  v_mfma_f32_32x32x16_bf16 v[56:71], a[200:203], a[104:107], v[56:71]
  ds_read_b64_tr_b16 a[184:185], v19 offset:32768
  s_waitcnt lgkmcnt(10)
  ds_read_b64_tr_b16 a[186:187], v19 offset:33280
  v_add_u32 v4, s96, v2
  v_add_u32 v5, s96, v3
  s_add_u32 m0, s54, 0
  s_nop 0
  buffer_load_dwordx4 v4, s[4:7], s48 offen offset:0 lds
  v_mfma_f32_32x32x16_bf16 v[72:87], a[204:207], a[104:107], v[72:87]
  ds_read_b64_tr_b16 a[188:189], v20 offset:32768
  ds_read_b64_tr_b16 a[190:191], v20 offset:33280
  v_mfma_f32_32x32x16_bf16 v[88:103], a[208:211], a[104:107], v[88:103]
  s_waitcnt lgkmcnt(6)
  ds_read_b64_tr_b16 a[192:193], v21 offset:32768
  ds_read_b64_tr_b16 a[194:195], v21 offset:33280
  buffer_load_dwordx4 v5, s[4:7], s49 offen offset:1024 lds
  v_mfma_f32_32x32x16_bf16 v[40:55], a[160:163], a[108:111], v[40:55]
  ds_read_b64_tr_b16 a[196:197], v18 offset:36864
  ds_read_b64_tr_b16 a[198:199], v18 offset:37376
  v_mfma_f32_32x32x16_bf16 v[56:71], a[164:167], a[108:111], v[56:71]
  ds_read_b64_tr_b16 a[200:201], v19 offset:36864
  ds_read_b64_tr_b16 a[202:203], v19 offset:37376
  buffer_load_dwordx4 v4, s[4:7], s50 offen offset:2048 lds
  v_mfma_f32_32x32x16_bf16 v[72:87], a[168:171], a[108:111], v[72:87]
  ds_read_b64_tr_b16 a[204:205], v20 offset:36864
  ds_read_b64_tr_b16 a[206:207], v20 offset:37376
  v_mfma_f32_32x32x16_bf16 v[88:103], a[172:175], a[108:111], v[88:103]
  s_waitcnt lgkmcnt(6)
  ds_read_b64_tr_b16 a[208:209], v21 offset:36864
  ds_read_b64_tr_b16 a[210:211], v21 offset:37376
  buffer_load_dwordx4 v5, s[4:7], s51 offen offset:3072 lds
  s_add_u32 s96, s96, 128
  s_cmp_eq_u32 s96, 1280
  s_cselect_b32 s96, 0, s96
  v_mfma_f32_32x32x16_bf16 v[40:55], a[180:183], a[112:115], v[40:55]
  ds_read_b64_tr_b16 a[160:161], v18 offset:40960
  ds_read_b64_tr_b16 a[162:163], v18 offset:41472
  v_mfma_f32_32x32x16_bf16 v[56:71], a[184:187], a[112:115], v[56:71]
  ds_read_b64_tr_b16 a[164:165], v19 offset:40960
  ds_read_b64_tr_b16 a[166:167], v19 offset:41472
  s_add_u32 s98, s98, 128
  s_mul_i32 s55, s97, 196608
  s_add_u32 s55, s55, s98
  s_add_u32 s56, s55, 22528
  s_add_u32 m0, s54, 81920
  s_nop 0
  buffer_load_dwordx4 v10, s[8:11], s55 offen lds
  v_mfma_f32_32x32x16_bf16 v[72:87], a[188:191], a[112:115], v[72:87]
  ds_read_b64_tr_b16 a[168:169], v20 offset:40960
  ds_read_b64_tr_b16 a[170:171], v20 offset:41472
  v_mfma_f32_32x32x16_bf16 v[88:103], a[192:195], a[112:115], v[88:103]
  s_waitcnt lgkmcnt(6)
  ds_read_b64_tr_b16 a[172:173], v21 offset:40960
  ds_read_b64_tr_b16 a[174:175], v21 offset:41472
  buffer_load_dwordx4 v11, s[12:15], s55 offen offset:1024 lds
  v_mfma_f32_32x32x16_bf16 v[40:55], a[196:199], a[116:119], v[40:55]
  ds_read_b64_tr_b16 a[180:181], v18 offset:45056
  ds_read_b64_tr_b16 a[182:183], v18 offset:45568
  s_waitcnt vmcnt(14)
  ds_read_b128 a[128:131], v6 offset:32768
  ds_read_b128 a[132:135], v7 offset:32768
  ds_read_b128 a[136:139], v8 offset:32768
  ds_read_b128 a[140:143], v9 offset:32768
  v_mfma_f32_32x32x16_bf16 v[56:71], a[200:203], a[116:119], v[56:71]
  ds_read_b64_tr_b16 a[184:185], v19 offset:45056
  s_waitcnt lgkmcnt(10)
  ds_read_b64_tr_b16 a[186:187], v19 offset:45568
  buffer_load_dwordx4 v10, s[8:11], s56 offen offset:2048 lds
  v_mfma_f32_32x32x16_bf16 v[72:87], a[204:207], a[116:119], v[72:87]
  ds_read_b64_tr_b16 a[188:189], v20 offset:45056
  ds_read_b64_tr_b16 a[190:191], v20 offset:45568
  v_mfma_f32_32x32x16_bf16 v[88:103], a[208:211], a[116:119], v[88:103]
  s_waitcnt lgkmcnt(10)
  ds_read_b64_tr_b16 a[192:193], v21 offset:45056
  ds_read_b64_tr_b16 a[194:195], v21 offset:45568
  buffer_load_dwordx4 v11, s[12:15], s56 offen offset:3072 lds
  s_add_u32 s97, s97, 1
  s_cmp_eq_u32 s97, 10
  s_cselect_b32 s97, 0, s97
  v_mfma_f32_32x32x16_bf16 v[40:55], a[160:163], a[120:123], v[40:55]
  s_barrier
  ds_read_b64_tr_b16 a[196:197], v18 offset:49152
  ds_read_b64_tr_b16 a[198:199], v18 offset:49664
  v_mfma_f32_32x32x16_bf16 v[56:71], a[164:167], a[120:123], v[56:71]
  ds_read_b64_tr_b16 a[200:201], v19 offset:49152
  s_waitcnt lgkmcnt(10)
  ds_read_b64_tr_b16 a[202:203], v19 offset:49664
  s_mul_i32 s55, s97, 196608
  s_add_u32 s55, s55, s98
  s_add_u32 s56, s55, 22528
  s_add_u32 m0, s54, 98304
  s_nop 0
  buffer_load_dwordx4 v10, s[8:11], s55 offen lds
  v_mfma_f32_32x32x16_bf16 v[72:87], a[168:171], a[120:123], v[72:87]
  ds_read_b64_tr_b16 a[204:205], v20 offset:49152
  ds_read_b64_tr_b16 a[206:207], v20 offset:49664
  v_mfma_f32_32x32x16_bf16 v[88:103], a[172:175], a[120:123], v[88:103]
  s_waitcnt lgkmcnt(6)
  ds_read_b64_tr_b16 a[208:209], v21 offset:49152
  ds_read_b64_tr_b16 a[210:211], v21 offset:49664
  buffer_load_dwordx4 v11, s[12:15], s55 offen offset:1024 lds
  v_mfma_f32_32x32x16_bf16 v[40:55], a[180:183], a[124:127], v[40:55]
  ds_read_b64_tr_b16 a[160:161], v18 offset:53248
  ds_read_b64_tr_b16 a[162:163], v18 offset:53760
  v_xor_b32 v39, s92, v31
  v_mfma_f32_32x32x16_bf16 v[56:71], a[184:187], a[124:127], v[56:71]
  ds_read_b64_tr_b16 a[164:165], v19 offset:53248
  ds_read_b64_tr_b16 a[166:167], v19 offset:53760
  buffer_load_dwordx4 v10, s[8:11], s56 offen offset:2048 lds
  v_bitop3_b32 v39, v39, v30, s92 bitop3:0xf6
  v_cmp_ne_u32 vcc, 0, v39
  v_mfma_f32_32x32x16_bf16 v[72:87], a[188:191], a[124:127], v[72:87]
  ds_read_b64_tr_b16 a[168:169], v20 offset:53248
  ds_read_b64_tr_b16 a[170:171], v20 offset:53760
  s_nop 0
  s_cbranch_vccnz X_poll0_slow
X_poll0_ret:
  v_mfma_f32_32x32x16_bf16 v[88:103], a[192:195], a[124:127], v[88:103]
  s_waitcnt lgkmcnt(6)
  ds_read_b64_tr_b16 a[172:173], v21 offset:53248
  ds_read_b64_tr_b16 a[174:175], v21 offset:53760
  buffer_load_dwordx4 v11, s[12:15], s56 offen offset:3072 lds
  s_add_u32 s97, s97, 1
  s_cmp_eq_u32 s97, 10
  s_cselect_b32 s97, 0, s97
  v_mul_f32 v212, 3216550459, v28
  v_rcp_f32 v213, v28
  v_mfma_f32_32x32x16_bf16 v[40:55], a[196:199], a[128:131], v[40:55]
  ds_read_b64_tr_b16 a[180:181], v18 offset:57344
  ds_read_b64_tr_b16 a[182:183], v18 offset:57856
  v_mfma_f32_32x32x16_bf16 v[56:71], a[200:203], a[128:131], v[56:71]
  ds_read_b64_tr_b16 a[184:185], v19 offset:57344
  ds_read_b64_tr_b16 a[186:187], v19 offset:57856
  v_mov_b32 v28, v29
  v_mfma_f32_32x32x16_bf16 v[72:87], a[204:207], a[128:131], v[72:87]
  ds_read_b64_tr_b16 a[188:189], v20 offset:57344
  ds_read_b64_tr_b16 a[190:191], v20 offset:57856
  v_mov_b32 v30, v29
  v_mov_b32 v31, v29
  v_mfma_f32_32x32x16_bf16 v[88:103], a[208:211], a[128:131], v[88:103]
  s_waitcnt lgkmcnt(6)
  ds_read_b64_tr_b16 a[192:193], v21 offset:57344
  ds_read_b64_tr_b16 a[194:195], v21 offset:57856
  v_mul_f32 v213, v213, v213
  v_mfma_f32_32x32x16_bf16 v[40:55], a[160:163], a[132:135], v[40:55]
  ds_read_b64_tr_b16 a[196:197], v18 offset:61440
  ds_read_b64_tr_b16 a[198:199], v18 offset:61952
  s_waitcnt vmcnt(8)
  ds_read_b128 a[144:147], v6 offset:0
  ds_read_b128 a[148:151], v7 offset:0
  ds_read_b128 a[152:155], v8 offset:0
  ds_read_b128 a[156:159], v9 offset:0
  v_xor_b32 v39, s92, v129
  v_mfma_f32_32x32x16_bf16 v[56:71], a[164:167], a[132:135], v[56:71]
  ds_read_b64_tr_b16 a[200:201], v19 offset:61440
  s_waitcnt lgkmcnt(10)
  ds_read_b64_tr_b16 a[202:203], v19 offset:61952
  v_bitop3_b32 v39, v39, v127, s92 bitop3:0xf6
  v_bitop3_b32 v39, v39, v125, s92 bitop3:0xf6
  v_mfma_f32_32x32x16_bf16 v[72:87], a[168:171], a[132:135], v[72:87]
  ds_read_b64_tr_b16 a[204:205], v20 offset:61440
  ds_read_b64_tr_b16 a[206:207], v20 offset:61952
  v_bitop3_b32 v39, v39, v123, s92 bitop3:0xf6
  v_mfma_f32_32x32x16_bf16 v[88:103], a[172:175], a[132:135], v[88:103]
  s_waitcnt lgkmcnt(10)
  ds_read_b64_tr_b16 a[208:209], v21 offset:61440
  ds_read_b64_tr_b16 a[210:211], v21 offset:61952
  v_bitop3_b32 v39, v39, v121, s92 bitop3:0xf6
  v_cmp_ne_u32 vcc, 0, v39
  v_mfma_f32_32x32x16_bf16 v[40:55], a[180:183], a[136:139], v[40:55]
  s_barrier
  v_add_u32 v18, 65536, v18
  v_add_u32 v19, 65536, v19
  v_add_u32 v20, 65536, v20
  v_add_u32 v21, 65536, v21
  ds_read_b64_tr_b16 a[160:161], v18 offset:0
  ds_read_b64_tr_b16 a[162:163], v18 offset:512
  s_mul_i32 s55, s97, 196608
  s_add_u32 s55, s55, s98
  s_add_u32 s56, s55, 22528
  s_add_u32 m0, s54, 114688
  s_nop 0
  buffer_load_dwordx4 v10, s[8:11], s55 offen lds
  s_cbranch_vccnz X_poll1_slow
X_poll1_ret:
  v_mfma_f32_32x32x16_bf16 v[56:71], a[184:187], a[136:139], v[56:71]
  ds_read_b64_tr_b16 a[164:165], v19 offset:0
  s_waitcnt lgkmcnt(10)
  ds_read_b64_tr_b16 a[166:167], v19 offset:512
  v_cmp_gt_u32 vcc, 32, v1
  v_mfma_f32_32x32x16_bf16 v[72:87], a[188:191], a[136:139], v[72:87]
  ds_read_b64_tr_b16 a[168:169], v20 offset:0
  ds_read_b64_tr_b16 a[170:171], v20 offset:512
  buffer_load_dwordx4 v11, s[12:15], s55 offen offset:1024 lds
  v_add_f32 v120, v120, v122
  v_add_f32 v124, v124, v126
  v_mfma_f32_32x32x16_bf16 v[88:103], a[192:195], a[136:139], v[88:103]
  s_waitcnt lgkmcnt(6)
  ds_read_b64_tr_b16 a[172:173], v21 offset:0
  ds_read_b64_tr_b16 a[174:175], v21 offset:512
  v_add_f32 v120, v120, v128
  v_mfma_f32_32x32x16_bf16 v[40:55], a[196:199], a[140:143], v[40:55]
  ds_read_b64_tr_b16 a[180:181], v18 offset:4096
  ds_read_b64_tr_b16 a[182:183], v18 offset:4608
  buffer_load_dwordx4 v10, s[8:11], s56 offen offset:2048 lds
  v_add_f32 v120, v120, v124
  v_mov_b32 v121, v120
  v_mfma_f32_32x32x16_bf16 v[56:71], a[200:203], a[140:143], v[56:71]
  ds_read_b64_tr_b16 a[184:185], v19 offset:4096
  ds_read_b64_tr_b16 a[186:187], v19 offset:4608
  v_mov_b32 v126, 0
  v_mfma_f32_32x32x16_bf16 v[72:87], a[204:207], a[140:143], v[72:87]
  ds_read_b64_tr_b16 a[188:189], v20 offset:4096
  ds_read_b64_tr_b16 a[190:191], v20 offset:4608
  buffer_load_dwordx4 v11, s[12:15], s56 offen offset:3072 lds
  s_add_u32 s97, s97, 1
  s_cmp_eq_u32 s97, 10
  s_cselect_b32 s97, 0, s97
  v_mov_b32 v127, 0
  v_mfma_f32_32x32x16_bf16 v[88:103], a[208:211], a[140:143], v[88:103]
  s_waitcnt lgkmcnt(6)
  ds_read_b64_tr_b16 a[192:193], v21 offset:4096
  ds_read_b64_tr_b16 a[194:195], v21 offset:4608
  v_permlane32_swap_b32 v120, v121
  v_add_f32 v120, v120, v121
  v_mfma_f32_32x32x16_bf16 v[40:55], a[160:163], a[144:147], v[40:55]
  ds_read_b64_tr_b16 a[196:197], v18 offset:8192
  ds_read_b64_tr_b16 a[198:199], v18 offset:8704
  v_cndmask_b32 v120, 0, v120, vcc
  v_mfma_f32_32x32x16_bf16 v[56:71], a[164:167], a[144:147], v[56:71]
  ds_read_b64_tr_b16 a[200:201], v19 offset:8192
  ds_read_b64_tr_b16 a[202:203], v19 offset:8704
  v_cvt_pk_bf16_f32 v121, v120, v120
  v_and_b32 v121, s52, v121
  v_mfma_f32_32x32x16_bf16 v[72:87], a[168:171], a[144:147], v[72:87]
  ds_read_b64_tr_b16 a[204:205], v20 offset:8192
  ds_read_b64_tr_b16 a[206:207], v20 offset:8704
  v_sub_f32 v120, v120, v121
  v_mfma_f32_32x32x16_bf16 v[88:103], a[172:175], a[144:147], v[88:103]
  s_waitcnt lgkmcnt(6)
  ds_read_b64_tr_b16 a[208:209], v21 offset:8192
  ds_read_b64_tr_b16 a[210:211], v21 offset:8704
  v_cvt_pk_bf16_f32 v124, v121, v120
  v_mfma_f32_32x32x16_bf16 v[40:55], a[180:183], a[148:151], v[40:55]
  ds_read_b64_tr_b16 a[160:161], v18 offset:12288
  ds_read_b64_tr_b16 a[162:163], v18 offset:12800
  v_and_b32 v122, s52, v124
  v_sub_f32 v120, v120, v122
  v_mfma_f32_32x32x16_bf16 v[56:71], a[184:187], a[148:151], v[56:71]
  ds_read_b64_tr_b16 a[164:165], v19 offset:12288
  ds_read_b64_tr_b16 a[166:167], v19 offset:12800
  v_cvt_pk_bf16_f32 v125, v120, 0
  v_mfma_f32_32x32x16_bf16 v[72:87], a[188:191], a[148:151], v[72:87]
  ds_read_b64_tr_b16 a[168:169], v20 offset:12288
  ds_read_b64_tr_b16 a[170:171], v20 offset:12800
  s_lshr_b32 s86, s54, 2
  v_add_u32 v37, s86, v38
  v_mfma_f32_32x32x16_bf16 v[88:103], a[192:195], a[148:151], v[88:103]
  s_waitcnt lgkmcnt(6)
  ds_read_b64_tr_b16 a[172:173], v21 offset:12288
  ds_read_b64_tr_b16 a[174:175], v21 offset:12800
  ds_write_b128 v37, v[124:127] offset:16384
  v_mfma_f32_32x32x16_bf16 v[40:55], a[196:199], a[152:155], v[40:55]
  s_waitcnt vmcnt(8)
  s_waitcnt lgkmcnt(0)
  s_barrier
  v_add_u32 v18, 4294901760, v18
  v_add_u32 v19, 4294901760, v19
  v_add_u32 v20, 4294901760, v20
  v_add_u32 v21, 4294901760, v21
  ds_read_b64_tr_b16 a[180:181], v18 offset:0
  ds_read_b64_tr_b16 a[182:183], v18 offset:512
  s_mul_i32 s55, s97, 196608
  s_add_u32 s55, s55, s98
  s_add_u32 s56, s55, 22528
  s_add_u32 m0, s54, 131072
  s_nop 0
  buffer_load_dwordx4 v10, s[8:11], s55 offen lds
  ds_read_b128 a[220:223], v38 offset:16384
  v_mfma_f32_32x32x16_bf16 v[56:71], a[200:203], a[152:155], v[56:71]
  ds_read_b64_tr_b16 a[184:185], v19 offset:0
  ds_read_b64_tr_b16 a[186:187], v19 offset:512
  ds_read_b128 a[224:227], v38 offset:17408
  v_mfma_f32_32x32x16_bf16 v[72:87], a[204:207], a[152:155], v[72:87]
  ds_read_b64_tr_b16 a[188:189], v20 offset:0
  ds_read_b64_tr_b16 a[190:191], v20 offset:512
  buffer_load_dwordx4 v11, s[12:15], s55 offen offset:1024 lds
  ds_read_b128 a[228:231], v38 offset:18432
  v_mfma_f32_32x32x16_bf16 v[88:103], a[208:211], a[152:155], v[88:103]
  ds_read_b64_tr_b16 a[192:193], v21 offset:0
  ds_read_b64_tr_b16 a[194:195], v21 offset:512
  ds_read_b128 a[232:235], v38 offset:19456
  v_mfma_f32_32x32x16_bf16 v[40:55], a[160:163], a[156:159], v[40:55]
  ds_read_b64_tr_b16 a[196:197], v18 offset:4096
  ds_read_b64_tr_b16 a[198:199], v18 offset:4608
  buffer_load_dwordx4 v10, s[8:11], s56 offen offset:2048 lds
  v_mfma_f32_32x32x16_bf16 v[56:71], a[164:167], a[156:159], v[56:71]
  ds_read_b64_tr_b16 a[200:201], v19 offset:4096
  s_waitcnt lgkmcnt(10)
  ds_read_b64_tr_b16 a[202:203], v19 offset:4608
  s_lshr_b32 s48, s79, 3
  v_mfma_f32_32x32x16_bf16 v[72:87], a[168:171], a[156:159], v[72:87]
  ds_read_b64_tr_b16 a[204:205], v20 offset:4096
  ds_read_b64_tr_b16 a[206:207], v20 offset:4608
  buffer_load_dwordx4 v11, s[12:15], s56 offen offset:3072 lds
  s_add_u32 s97, s97, 1
  s_cmp_eq_u32 s97, 10
  s_cselect_b32 s97, 0, s97
  s_lshl_b32 s49, s78, 1
  v_mfma_f32_32x32x16_bf16 v[88:103], a[172:175], a[156:159], v[88:103]
  s_waitcnt lgkmcnt(7)
  ds_read_b64_tr_b16 a[208:209], v21 offset:4096
  ds_read_b64_tr_b16 a[210:211], v21 offset:4608
  v_mfma_f32_32x32x16_bf16 v[40:55], a[220:223], v[28:31], v[40:55]
  s_add_u32 s48, s48, s49
  v_mfma_f32_32x32x16_bf16 v[56:71], a[224:227], v[28:31], v[56:71]
  v_mfma_f32_32x32x16_bf16 v[72:87], a[228:231], v[28:31], v[72:87]
  s_lshl_b32 s48, s48, 2
  s_waitcnt lgkmcnt(8)
  v_mfma_f32_32x32x16_bf16 v[88:103], a[232:235], v[28:31], v[88:103]
  s_add_u32 s48, s48, s42
  v_mfma_f32_32x32x16_bf16 v[120:135], a[180:183], a[0:3], 0
  ds_read_b64_tr_b16 a[160:161], v18 offset:8192
  ds_read_b64_tr_b16 a[162:163], v18 offset:8704
  s_lshl_b32 s48, s48, 4
  s_and_b32 s49, s79, 7
  s_mul_i32 s49, s49, 160
  s_lshl_b32 s44, s42, 5
  v_xor_b32 v22, s44, v18
  v_mfma_f32_32x32x16_bf16 v[136:151], a[184:187], a[0:3], 0
  ds_read_b64_tr_b16 a[164:165], v19 offset:8192
  ds_read_b64_tr_b16 a[166:167], v19 offset:8704
  s_mul_i32 s51, s48, 1280
  s_andn2_b32 s50, s49, 127
  s_add_u32 s51, s51, s50
  ds_read_b64_tr_b16 a[240:241], v22 offset:0
  ds_read_b64_tr_b16 a[242:243], v22 offset:512
  v_mfma_f32_32x32x16_bf16 v[152:167], a[188:191], a[0:3], 0
  ds_read_b64_tr_b16 a[168:169], v20 offset:8192
  s_waitcnt lgkmcnt(10)
  ds_read_b64_tr_b16 a[170:171], v20 offset:8704
  s_mul_i32 s50, s42, 4608
  s_add_u32 s50, s50, 32768
  v_lshrrev_b32 v6, 4, v1
  v_mul_u32_u24 v6, 1280, v6
  ds_read_b64_tr_b16 a[244:245], v22 offset:4096
  ds_read_b64_tr_b16 a[246:247], v22 offset:4608
  v_mfma_f32_32x32x16_bf16 v[168:183], a[192:195], a[0:3], 0
  s_waitcnt lgkmcnt(10)
  ds_read_b64_tr_b16 a[172:173], v21 offset:8192
  ds_read_b64_tr_b16 a[174:175], v21 offset:8704
  v_and_b32 v7, 15, v1
  v_lshl_add_u32 v6, v7, 4, v6
  buffer_load_dword v249, v248, s[20:23], s69 offen sc1
  ds_read_b64_tr_b16 a[248:249], v22 offset:8192
  ds_read_b64_tr_b16 a[250:251], v22 offset:8704
  v_mfma_f32_32x32x16_bf16 v[120:135], a[196:199], a[4:7], v[120:135]
  ds_read_b64_tr_b16 a[180:181], v18 offset:12288
  s_waitcnt lgkmcnt(10)
  ds_read_b64_tr_b16 a[182:183], v18 offset:12800
  ds_read_b64_tr_b16 a[252:253], v22 offset:12288
  ds_read_b64_tr_b16 a[254:255], v22 offset:12800
  v_mfma_f32_32x32x16_bf16 v[136:151], a[200:203], a[4:7], v[136:151]
  ds_read_b64_tr_b16 a[184:185], v19 offset:12288
  ds_read_b64_tr_b16 a[186:187], v19 offset:12800
  s_mul_i32 s44, s43, 3
  s_add_u32 s44, s44, 1
  v_mfma_f32_32x32x16_bf16 v[152:167], a[204:207], a[4:7], v[152:167]
  s_waitcnt lgkmcnt(10)
  ds_read_b64_tr_b16 a[188:189], v20 offset:12288
  ds_read_b64_tr_b16 a[190:191], v20 offset:12800
  s_mul_i32 s83, s44, 12800
  s_add_u32 s83, s83, 15499264
  v_mfma_f32_32x32x16_bf16 v[168:183], a[208:211], a[4:7], v[168:183]
  s_waitcnt lgkmcnt(10)
  ds_read_b64_tr_b16 a[192:193], v21 offset:12288
  ds_read_b64_tr_b16 a[194:195], v21 offset:12800
  s_mul_i32 s44, s99, 1280
  s_add_u32 s82, s83, s44
  v_mfma_f32_32x32x16_bf16 v[120:135], a[160:163], a[8:11], v[120:135]
  s_waitcnt vmcnt(9)
  s_barrier
  ds_read_b64_tr_b16 a[196:197], v18 offset:16384
  ds_read_b64_tr_b16 a[198:199], v18 offset:16896
  s_mul_i32 s55, s97, 196608
  s_add_u32 s55, s55, s98
  s_add_u32 s56, s55, 22528
  s_add_u32 m0, s54, 147456
  s_nop 0
  buffer_load_dwordx4 v10, s[8:11], s55 offen lds
  s_lshl_b32 s44, s42, 8
  s_add_u32 s82, s82, s44
  v_mfma_f32_32x32x16_bf16 v[136:151], a[164:167], a[8:11], v[136:151]
  ds_read_b64_tr_b16 a[200:201], v19 offset:16384
  s_waitcnt lgkmcnt(10)
  ds_read_b64_tr_b16 a[202:203], v19 offset:16896
  s_add_u32 s83, s83, s44
  s_cmp_lt_u32 s40, 10
  s_cselect_b32 s44, 32, 0
  v_mfma_f32_32x32x16_bf16 v[152:167], a[168:171], a[8:11], v[152:167]
  ds_read_b64_tr_b16 a[204:205], v20 offset:16384
  ds_read_b64_tr_b16 a[206:207], v20 offset:16896
  buffer_load_dwordx4 v11, s[12:15], s55 offen offset:1024 lds
  v_cmp_gt_u32 vcc, s44, v1
  v_mfma_f32_32x32x16_bf16 v[168:183], a[172:175], a[8:11], v[168:183]
  s_waitcnt lgkmcnt(6)
  ds_read_b64_tr_b16 a[208:209], v21 offset:16384
  ds_read_b64_tr_b16 a[210:211], v21 offset:16896
  v_lshlrev_b32 v36, 3, v1
  v_mov_b32 v37, 2130706432
  v_mfma_f32_32x32x16_bf16 v[120:135], a[180:183], a[12:15], v[120:135]
  ds_read_b64_tr_b16 a[160:161], v18 offset:20480
  ds_read_b64_tr_b16 a[162:163], v18 offset:20992
  buffer_load_dwordx4 v10, s[8:11], s56 offen offset:2048 lds
  v_cndmask_b32 v36, v37, v36, vcc
  v_mfma_f32_32x32x16_bf16 v[184:199], v[24:27], a[240:243], 0
  v_mfma_f32_32x32x16_bf16 v[136:151], a[184:187], a[12:15], v[136:151]
  ds_read_b64_tr_b16 a[164:165], v19 offset:20480
  ds_read_b64_tr_b16 a[166:167], v19 offset:20992
  v_mfma_f32_32x32x16_bf16 v[184:199], v[24:27], a[244:247], v[184:199]
  v_mfma_f32_32x32x16_bf16 v[184:199], v[24:27], a[248:251], v[184:199]
  v_mfma_f32_32x32x16_bf16 v[152:167], a[188:191], a[12:15], v[152:167]
  ds_read_b64_tr_b16 a[168:169], v20 offset:20480
  ds_read_b64_tr_b16 a[170:171], v20 offset:20992
  buffer_load_dwordx4 v11, s[12:15], s56 offen offset:3072 lds
  s_add_u32 s97, s97, 1
  s_cmp_eq_u32 s97, 10
  s_cselect_b32 s97, 0, s97
  v_mfma_f32_32x32x16_bf16 v[184:199], v[24:27], a[252:255], v[184:199]
  v_mfma_f32_32x32x16_bf16 v[168:183], a[192:195], a[12:15], v[168:183]
  s_waitcnt lgkmcnt(6)
  ds_read_b64_tr_b16 a[172:173], v21 offset:20480
  ds_read_b64_tr_b16 a[174:175], v21 offset:20992
  v_mfma_f32_32x32x16_bf16 v[120:135], a[196:199], a[16:19], v[120:135]
  ds_read_b64_tr_b16 a[180:181], v18 offset:24576
  ds_read_b64_tr_b16 a[182:183], v18 offset:25088
  s_waitcnt vmcnt(4)
  v_xor_b32 v250, s92, v249
  v_mfma_f32_32x32x16_bf16 v[136:151], a[200:203], a[16:19], v[136:151]
  ds_read_b64_tr_b16 a[184:185], v19 offset:24576
  ds_read_b64_tr_b16 a[186:187], v19 offset:25088
  v_cmp_ne_u32 s[86:87], 0, v250
  v_mfma_f32_32x32x16_bf16 v[152:167], a[204:207], a[16:19], v[152:167]
  ds_read_b64_tr_b16 a[188:189], v20 offset:24576
  ds_read_b64_tr_b16 a[190:191], v20 offset:25088
  s_nop 0
  s_cmp_lg_u64 s[86:87], 0
  s_cbranch_scc1 X_poll2_slow
X_poll2_ret:
  v_mfma_f32_32x32x16_bf16 v[168:183], a[208:211], a[16:19], v[168:183]
  s_waitcnt lgkmcnt(6)
  ds_read_b64_tr_b16 a[192:193], v21 offset:24576
  ds_read_b64_tr_b16 a[194:195], v21 offset:25088
  v_mfma_f32_32x32x16_bf16 v[120:135], a[160:163], a[20:23], v[120:135]
  ds_read_b64_tr_b16 a[196:197], v18 offset:28672
  ds_read_b64_tr_b16 a[198:199], v18 offset:29184
  s_add_u32 s64, s66, 0
  buffer_load_dwordx4 a[0:3], v38, s[20:23], s64 offen offset:0 sc1
  v_mov_b32 v185, s92
  v_mfma_f32_32x32x16_bf16 v[136:151], a[164:167], a[20:23], v[136:151]
  ds_read_b64_tr_b16 a[200:201], v19 offset:28672
  ds_read_b64_tr_b16 a[202:203], v19 offset:29184
  buffer_store_dwordx2 v[184:185], v36, s[20:23], s82 offen sc1
  v_mul_f32 v200, v212, v40
  v_mul_f32 v201, v212, v41
  v_mul_f32 v202, v212, v42
  v_mul_f32 v203, v212, v43
  v_mul_f32 v204, v212, v44
  v_mul_f32 v205, v212, v45
  v_mul_f32 v206, v212, v46
  v_mfma_f32_32x32x16_bf16 v[152:167], a[168:171], a[20:23], v[152:167]
  ds_read_b64_tr_b16 a[204:205], v20 offset:28672
  ds_read_b64_tr_b16 a[206:207], v20 offset:29184
  buffer_load_dwordx4 a[4:7], v38, s[20:23], s64 offen offset:1024 sc1
  v_mul_f32 v207, v212, v47
  v_exp_f32 v200, v200
  v_mul_f32 v40, v40, v48
  v_exp_f32 v201, v201
  v_mfma_f32_32x32x16_bf16 v[168:183], a[172:175], a[20:23], v[168:183]
  s_waitcnt lgkmcnt(6)
  ds_read_b64_tr_b16 a[208:209], v21 offset:28672
  ds_read_b64_tr_b16 a[210:211], v21 offset:29184
  v_mul_f32 v41, v41, v49
  v_exp_f32 v202, v202
  v_mul_f32 v42, v42, v50
  v_exp_f32 v203, v203
  v_mfma_f32_32x32x16_bf16 v[120:135], a[180:183], a[24:27], v[120:135]
  s_barrier
  ds_read_b64_tr_b16 a[160:161], v18 offset:32768
  ds_read_b64_tr_b16 a[162:163], v18 offset:33280
  s_mul_i32 s55, s97, 196608
  s_add_u32 s55, s55, s98
  s_add_u32 s56, s55, 22528
  s_add_u32 m0, s54, 81920
  s_nop 0
  buffer_load_dwordx4 v10, s[8:11], s55 offen lds
  v_mul_f32 v43, v43, v51
  v_exp_f32 v204, v204
  v_mul_f32 v44, v44, v52
  v_exp_f32 v205, v205
  v_mfma_f32_32x32x16_bf16 v[136:151], a[184:187], a[24:27], v[136:151]
  ds_read_b64_tr_b16 a[164:165], v19 offset:32768
  ds_read_b64_tr_b16 a[166:167], v19 offset:33280
  v_mul_f32 v45, v45, v53
  v_exp_f32 v206, v206
  v_mul_f32 v46, v46, v54
  v_exp_f32 v207, v207
  v_mfma_f32_32x32x16_bf16 v[152:167], a[188:191], a[24:27], v[152:167]
  ds_read_b64_tr_b16 a[168:169], v20 offset:32768
  ds_read_b64_tr_b16 a[170:171], v20 offset:33280
  buffer_load_dwordx4 v11, s[12:15], s55 offen offset:1024 lds
  v_mul_f32 v47, v47, v55
  v_fma_f32 v200, v200, v213, v213
  v_fma_f32 v201, v201, v213, v213
  v_fma_f32 v202, v202, v213, v213
  v_fma_f32 v203, v203, v213, v213
  v_fma_f32 v204, v204, v213, v213
  v_mfma_f32_32x32x16_bf16 v[168:183], a[192:195], a[24:27], v[168:183]
  s_waitcnt lgkmcnt(6)
  ds_read_b64_tr_b16 a[172:173], v21 offset:32768
  ds_read_b64_tr_b16 a[174:175], v21 offset:33280
  v_fma_f32 v205, v205, v213, v213
  v_fma_f32 v206, v206, v213, v213
  v_fma_f32 v207, v207, v213, v213
  v_rcp_f32 v200, v200
  v_rcp_f32 v201, v201
  v_mfma_f32_32x32x16_bf16 v[120:135], a[196:199], a[28:31], v[120:135]
  ds_read_b64_tr_b16 a[180:181], v18 offset:36864
  ds_read_b64_tr_b16 a[182:183], v18 offset:37376
  buffer_load_dwordx4 v10, s[8:11], s56 offen offset:2048 lds
  v_rcp_f32 v202, v202
  v_rcp_f32 v203, v203
  v_mfma_f32_32x32x16_bf16 v[136:151], a[200:203], a[28:31], v[136:151]
  ds_read_b64_tr_b16 a[184:185], v19 offset:36864
  ds_read_b64_tr_b16 a[186:187], v19 offset:37376
  v_rcp_f32 v204, v204
  v_rcp_f32 v205, v205
  v_rcp_f32 v206, v206
  v_mfma_f32_32x32x16_bf16 v[152:167], a[204:207], a[28:31], v[152:167]
  ds_read_b64_tr_b16 a[188:189], v20 offset:36864
  ds_read_b64_tr_b16 a[190:191], v20 offset:37376
  buffer_load_dwordx4 v11, s[12:15], s56 offen offset:3072 lds
  s_add_u32 s97, s97, 1
  s_cmp_eq_u32 s97, 10
  s_cselect_b32 s97, 0, s97
  v_rcp_f32 v207, v207
  s_add_u32 s46, s57, 0
  v_mul_f32 v40, v40, v200
  v_mul_f32 v41, v41, v201
  v_mul_f32 v42, v42, v202
  v_mfma_f32_32x32x16_bf16 v[168:183], a[208:211], a[28:31], v[168:183]
  s_waitcnt lgkmcnt(6)
  ds_read_b64_tr_b16 a[192:193], v21 offset:36864
  ds_read_b64_tr_b16 a[194:195], v21 offset:37376
  v_mul_f32 v43, v43, v203
  v_mul_f32 v44, v44, v204
  v_mul_f32 v45, v45, v205
  v_mul_f32 v46, v46, v206
  v_mul_f32 v47, v47, v207
  v_cvt_pk_bf16_f32 v48, v40, v41
  v_mfma_f32_32x32x16_bf16 v[120:135], a[160:163], a[32:35], v[120:135]
  ds_read_b64_tr_b16 a[196:197], v18 offset:40960
  ds_read_b64_tr_b16 a[198:199], v18 offset:41472
  s_add_u32 m0, s50, 0
  s_add_u32 s65, s51, 0
  buffer_load_dwordx4 v6, s[4:7], s65 offen lds
  v_cvt_pk_bf16_f32 v49, v42, v43
  v_cvt_pk_bf16_f32 v50, v44, v45
  v_cvt_pk_bf16_f32 v51, v46, v47
  v_mfma_f32_32x32x16_bf16 v[136:151], a[164:167], a[32:35], v[136:151]
  ds_read_b64_tr_b16 a[200:201], v19 offset:40960
  ds_read_b64_tr_b16 a[202:203], v19 offset:41472
  buffer_store_dwordx4 v[48:51], v23, s[20:23], s46 offen offset:0 sc1
  v_mul_f32 v200, v212, v56
  v_mul_f32 v201, v212, v57
  v_mul_f32 v202, v212, v58
  v_mul_f32 v203, v212, v59
  v_mul_f32 v204, v212, v60
  v_mul_f32 v205, v212, v61
  v_mul_f32 v206, v212, v62
  v_mfma_f32_32x32x16_bf16 v[152:167], a[168:171], a[32:35], v[152:167]
  ds_read_b64_tr_b16 a[204:205], v20 offset:40960
  ds_read_b64_tr_b16 a[206:207], v20 offset:41472
  s_add_u32 m0, s50, 1024
  s_add_u32 s65, s51, 5120
  buffer_load_dwordx4 v6, s[4:7], s65 offen lds
  v_mul_f32 v207, v212, v63
  v_exp_f32 v200, v200
  v_mul_f32 v56, v56, v64
  v_exp_f32 v201, v201
  v_mfma_f32_32x32x16_bf16 v[168:183], a[172:175], a[32:35], v[168:183]
  s_waitcnt lgkmcnt(6)
  ds_read_b64_tr_b16 a[208:209], v21 offset:40960
  ds_read_b64_tr_b16 a[210:211], v21 offset:41472
  v_mul_f32 v57, v57, v65
  v_exp_f32 v202, v202
  v_mul_f32 v58, v58, v66
  v_exp_f32 v203, v203
  v_mfma_f32_32x32x16_bf16 v[120:135], a[180:183], a[36:39], v[120:135]
  ds_read_b64_tr_b16 a[160:161], v18 offset:45056
  ds_read_b64_tr_b16 a[162:163], v18 offset:45568
  s_add_u32 m0, s50, 2048
  s_add_u32 s65, s51, 10240
  buffer_load_dwordx4 v6, s[4:7], s65 offen lds
  v_mul_f32 v59, v59, v67
  v_exp_f32 v204, v204
  v_mul_f32 v60, v60, v68
  v_exp_f32 v205, v205
  v_mfma_f32_32x32x16_bf16 v[136:151], a[184:187], a[36:39], v[136:151]
  ds_read_b64_tr_b16 a[164:165], v19 offset:45056
  ds_read_b64_tr_b16 a[166:167], v19 offset:45568
  v_mul_f32 v61, v61, v69
  v_exp_f32 v206, v206
  v_mul_f32 v62, v62, v70
  v_exp_f32 v207, v207
  v_mfma_f32_32x32x16_bf16 v[152:167], a[188:191], a[36:39], v[152:167]
  ds_read_b64_tr_b16 a[168:169], v20 offset:45056
  ds_read_b64_tr_b16 a[170:171], v20 offset:45568
  s_add_u32 m0, s50, 3072
  s_add_u32 s65, s51, 15360
  buffer_load_dwordx4 v6, s[4:7], s65 offen lds
  v_mul_f32 v63, v63, v71
  v_fma_f32 v200, v200, v213, v213
  v_fma_f32 v201, v201, v213, v213
  v_fma_f32 v202, v202, v213, v213
  v_fma_f32 v203, v203, v213, v213
  v_fma_f32 v204, v204, v213, v213
  v_mfma_f32_32x32x16_bf16 v[168:183], a[192:195], a[36:39], v[168:183]
  s_waitcnt lgkmcnt(6)
  ds_read_b64_tr_b16 a[172:173], v21 offset:45056
  ds_read_b64_tr_b16 a[174:175], v21 offset:45568
  v_fma_f32 v205, v205, v213, v213
  v_fma_f32 v206, v206, v213, v213
  v_fma_f32 v207, v207, v213, v213
  v_rcp_f32 v200, v200
  v_rcp_f32 v201, v201
  v_mfma_f32_32x32x16_bf16 v[120:135], a[196:199], a[40:43], v[120:135]
  s_barrier
  ds_read_b64_tr_b16 a[180:181], v18 offset:49152
  ds_read_b64_tr_b16 a[182:183], v18 offset:49664
  s_mul_i32 s55, s97, 196608
  s_add_u32 s55, s55, s98
  s_add_u32 s56, s55, 22528
  s_add_u32 m0, s54, 98304
  s_nop 0
  buffer_load_dwordx4 v10, s[8:11], s55 offen lds
  v_rcp_f32 v202, v202
  v_rcp_f32 v203, v203
  v_rcp_f32 v204, v204
  v_mfma_f32_32x32x16_bf16 v[136:151], a[200:203], a[40:43], v[136:151]
  ds_read_b64_tr_b16 a[184:185], v19 offset:49152
  ds_read_b64_tr_b16 a[186:187], v19 offset:49664
  v_rcp_f32 v205, v205
  v_rcp_f32 v206, v206
  v_rcp_f32 v207, v207
  v_mfma_f32_32x32x16_bf16 v[152:167], a[204:207], a[40:43], v[152:167]
  ds_read_b64_tr_b16 a[188:189], v20 offset:49152
  ds_read_b64_tr_b16 a[190:191], v20 offset:49664
  buffer_load_dwordx4 v11, s[12:15], s55 offen offset:1024 lds
  s_add_u32 s46, s57, 0
  v_mul_f32 v56, v56, v200
  v_mul_f32 v57, v57, v201
  v_mul_f32 v58, v58, v202
  v_mul_f32 v59, v59, v203
  v_mfma_f32_32x32x16_bf16 v[168:183], a[208:211], a[40:43], v[168:183]
  s_waitcnt lgkmcnt(6)
  ds_read_b64_tr_b16 a[192:193], v21 offset:49152
  ds_read_b64_tr_b16 a[194:195], v21 offset:49664
  v_mul_f32 v60, v60, v204
  v_mul_f32 v61, v61, v205
  v_mul_f32 v62, v62, v206
  v_mul_f32 v63, v63, v207
  v_cvt_pk_bf16_f32 v64, v56, v57
  v_cvt_pk_bf16_f32 v65, v58, v59
  v_mfma_f32_32x32x16_bf16 v[120:135], a[160:163], a[44:47], v[120:135]
  ds_read_b64_tr_b16 a[196:197], v18 offset:53248
  ds_read_b64_tr_b16 a[198:199], v18 offset:53760
  buffer_load_dwordx4 v10, s[8:11], s56 offen offset:2048 lds
  v_cvt_pk_bf16_f32 v66, v60, v61
  v_cvt_pk_bf16_f32 v67, v62, v63
  v_mfma_f32_32x32x16_bf16 v[136:151], a[164:167], a[44:47], v[136:151]
  ds_read_b64_tr_b16 a[200:201], v19 offset:53248
  ds_read_b64_tr_b16 a[202:203], v19 offset:53760
  buffer_store_dwordx4 v[64:67], v23, s[20:23], s46 offen offset:512 sc1
  v_mul_f32 v200, v212, v72
  v_mul_f32 v201, v212, v73
  v_mul_f32 v202, v212, v74
  v_mul_f32 v203, v212, v75
  v_mul_f32 v204, v212, v76
  v_mul_f32 v205, v212, v77
  v_mul_f32 v206, v212, v78
  v_mfma_f32_32x32x16_bf16 v[152:167], a[168:171], a[44:47], v[152:167]
  ds_read_b64_tr_b16 a[204:205], v20 offset:53248
  ds_read_b64_tr_b16 a[206:207], v20 offset:53760
  buffer_load_dwordx4 v11, s[12:15], s56 offen offset:3072 lds
  s_add_u32 s97, s97, 1
  s_cmp_eq_u32 s97, 10
  s_cselect_b32 s97, 0, s97
  v_mul_f32 v207, v212, v79
  v_exp_f32 v200, v200
  v_mul_f32 v72, v72, v80
  v_exp_f32 v201, v201
  v_mfma_f32_32x32x16_bf16 v[168:183], a[172:175], a[44:47], v[168:183]
  s_waitcnt lgkmcnt(6)
  ds_read_b64_tr_b16 a[208:209], v21 offset:53248
  ds_read_b64_tr_b16 a[210:211], v21 offset:53760
  v_mul_f32 v73, v73, v81
  v_exp_f32 v202, v202
  v_mul_f32 v74, v74, v82
  v_exp_f32 v203, v203
  v_mfma_f32_32x32x16_bf16 v[120:135], a[180:183], a[48:51], v[120:135]
  ds_read_b64_tr_b16 a[160:161], v18 offset:57344
  ds_read_b64_tr_b16 a[162:163], v18 offset:57856
  s_add_u32 m0, s88, 0
  s_add_u32 s65, s66, 35840
  buffer_load_dwordx4 v38, s[20:23], s65 offen sc1 lds
  v_mul_f32 v75, v75, v83
  v_exp_f32 v204, v204
  v_mul_f32 v76, v76, v84
  v_exp_f32 v205, v205
  v_mfma_f32_32x32x16_bf16 v[136:151], a[184:187], a[48:51], v[136:151]
  ds_read_b64_tr_b16 a[164:165], v19 offset:57344
  ds_read_b64_tr_b16 a[166:167], v19 offset:57856
  v_lshrrev_b32 v209, 5, v1
  v_mul_u32_u24 v209, 6400, v209
  v_mul_f32 v77, v77, v85
  v_exp_f32 v206, v206
  v_mul_f32 v78, v78, v86
  v_exp_f32 v207, v207
  v_mfma_f32_32x32x16_bf16 v[152:167], a[188:191], a[48:51], v[152:167]
  ds_read_b64_tr_b16 a[168:169], v20 offset:57344
  ds_read_b64_tr_b16 a[170:171], v20 offset:57856
  s_add_u32 m0, s88, 4096
  s_add_u32 s65, s66, 36864
  buffer_load_dwordx4 v38, s[20:23], s65 offen sc1 lds
  v_and_b32 v37, 31, v1
  v_mul_f32 v79, v79, v87
  v_fma_f32 v200, v200, v213, v213
  v_fma_f32 v201, v201, v213, v213
  v_fma_f32 v202, v202, v213, v213
  v_fma_f32 v203, v203, v213, v213
  v_fma_f32 v204, v204, v213, v213
  v_mfma_f32_32x32x16_bf16 v[168:183], a[192:195], a[48:51], v[168:183]
  s_waitcnt lgkmcnt(6)
  ds_read_b64_tr_b16 a[172:173], v21 offset:57344
  ds_read_b64_tr_b16 a[174:175], v21 offset:57856
  v_lshl_add_u32 v209, v37, 3, v209
  s_add_u32 s82, s83, 3840
  v_fma_f32 v205, v205, v213, v213
  v_fma_f32 v206, v206, v213, v213
  v_fma_f32 v207, v207, v213, v213
  v_rcp_f32 v200, v200
  v_rcp_f32 v201, v201
  v_mfma_f32_32x32x16_bf16 v[120:135], a[196:199], a[52:55], v[120:135]
  ds_read_b64_tr_b16 a[180:181], v18 offset:61440
  ds_read_b64_tr_b16 a[182:183], v18 offset:61952
  buffer_load_dwordx2 v[184:185], v209, s[20:23], s83 offen offset:0 sc1
  v_rcp_f32 v202, v202
  v_rcp_f32 v203, v203
  v_rcp_f32 v204, v204
  v_mfma_f32_32x32x16_bf16 v[136:151], a[200:203], a[52:55], v[136:151]
  ds_read_b64_tr_b16 a[184:185], v19 offset:61440
  ds_read_b64_tr_b16 a[186:187], v19 offset:61952
  buffer_load_dwordx2 v[186:187], v209, s[20:23], s83 offen offset:1280 sc1
  v_rcp_f32 v205, v205
  v_rcp_f32 v206, v206
  v_rcp_f32 v207, v207
  v_mfma_f32_32x32x16_bf16 v[152:167], a[204:207], a[52:55], v[152:167]
  ds_read_b64_tr_b16 a[188:189], v20 offset:61440
  ds_read_b64_tr_b16 a[190:191], v20 offset:61952
  buffer_load_dwordx2 v[188:189], v209, s[20:23], s83 offen offset:2560 sc1
  s_add_u32 s46, s57, 4096
  v_mul_f32 v72, v72, v200
  v_mul_f32 v73, v73, v201
  v_mul_f32 v74, v74, v202
  v_mul_f32 v75, v75, v203
  v_mfma_f32_32x32x16_bf16 v[168:183], a[208:211], a[52:55], v[168:183]
  s_waitcnt lgkmcnt(6)
  ds_read_b64_tr_b16 a[192:193], v21 offset:61440
  ds_read_b64_tr_b16 a[194:195], v21 offset:61952
  buffer_load_dwordx2 v[190:191], v209, s[20:23], s82 offen offset:0 sc1
  v_mul_f32 v76, v76, v204
  v_mul_f32 v77, v77, v205
  v_mul_f32 v78, v78, v206
  v_mul_f32 v79, v79, v207
  v_cvt_pk_bf16_f32 v80, v72, v73
  v_cvt_pk_bf16_f32 v81, v74, v75
  v_cvt_pk_bf16_f32 v82, v76, v77
  v_mfma_f32_32x32x16_bf16 v[120:135], a[160:163], a[56:59], v[120:135]
  s_waitcnt vmcnt(23)
  s_barrier
  v_add_u32 v18, 65536, v18
  v_add_u32 v19, 65536, v19
  v_add_u32 v20, 65536, v20
  v_add_u32 v21, 65536, v21
  ds_read_b64_tr_b16 a[196:197], v18 offset:0
  ds_read_b64_tr_b16 a[198:199], v18 offset:512
  s_mul_i32 s55, s97, 196608
  s_add_u32 s55, s55, s98
  s_add_u32 s56, s55, 22528
  s_add_u32 m0, s54, 114688
  s_nop 0
  buffer_load_dwordx4 v10, s[8:11], s55 offen lds
  v_cvt_pk_bf16_f32 v83, v78, v79
  v_mfma_f32_32x32x16_bf16 v[136:151], a[164:167], a[56:59], v[136:151]
  ds_read_b64_tr_b16 a[200:201], v19 offset:0
  ds_read_b64_tr_b16 a[202:203], v19 offset:512
  buffer_load_dwordx2 v[192:193], v209, s[20:23], s82 offen offset:1280 sc1
  v_mfma_f32_32x32x16_bf16 v[152:167], a[168:171], a[56:59], v[152:167]
  ds_read_b64_tr_b16 a[204:205], v20 offset:0
  ds_read_b64_tr_b16 a[206:207], v20 offset:512
  buffer_load_dwordx4 v11, s[12:15], s55 offen offset:1024 lds
  v_mfma_f32_32x32x16_bf16 v[168:183], a[172:175], a[56:59], v[168:183]
  s_waitcnt lgkmcnt(6)
  ds_read_b64_tr_b16 a[208:209], v21 offset:0
  ds_read_b64_tr_b16 a[210:211], v21 offset:512
  buffer_store_dwordx4 v[80:83], v23, s[20:23], s46 offen offset:0 sc1
  v_mul_f32 v200, v212, v88
  v_mul_f32 v201, v212, v89
  v_mul_f32 v202, v212, v90
  v_mul_f32 v203, v212, v91
  v_mul_f32 v204, v212, v92
  v_mul_f32 v205, v212, v93
  v_mul_f32 v206, v212, v94
  v_mul_f32 v207, v212, v95
  v_exp_f32 v200, v200
  v_mfma_f32_32x32x16_bf16 v[120:135], a[180:183], a[60:63], v[120:135]
  ds_read_b64_tr_b16 a[160:161], v18 offset:4096
  ds_read_b64_tr_b16 a[162:163], v18 offset:4608
  buffer_load_dwordx4 v10, s[8:11], s56 offen offset:2048 lds
  v_mul_f32 v88, v88, v96
  v_exp_f32 v201, v201
  v_mul_f32 v89, v89, v97
  v_exp_f32 v202, v202
  v_mfma_f32_32x32x16_bf16 v[136:151], a[184:187], a[60:63], v[136:151]
  ds_read_b64_tr_b16 a[164:165], v19 offset:4096
  ds_read_b64_tr_b16 a[166:167], v19 offset:4608
  v_mul_f32 v90, v90, v98
  v_exp_f32 v203, v203
  v_mul_f32 v91, v91, v99
  v_exp_f32 v204, v204
  v_mul_f32 v92, v92, v100
  v_exp_f32 v205, v205
  v_mfma_f32_32x32x16_bf16 v[152:167], a[188:191], a[60:63], v[152:167]
  ds_read_b64_tr_b16 a[168:169], v20 offset:4096
  ds_read_b64_tr_b16 a[170:171], v20 offset:4608
  buffer_load_dwordx4 v11, s[12:15], s56 offen offset:3072 lds
  s_add_u32 s97, s97, 1
  s_cmp_eq_u32 s97, 10
  s_cselect_b32 s97, 0, s97
  v_mul_f32 v93, v93, v101
  v_exp_f32 v206, v206
  v_mul_f32 v94, v94, v102
  v_exp_f32 v207, v207
  v_mul_f32 v95, v95, v103
  v_mfma_f32_32x32x16_bf16 v[168:183], a[192:195], a[60:63], v[168:183]
  s_waitcnt lgkmcnt(6)
  ds_read_b64_tr_b16 a[172:173], v21 offset:4096
  ds_read_b64_tr_b16 a[174:175], v21 offset:4608
  v_fma_f32 v200, v200, v213, v213
  v_fma_f32 v201, v201, v213, v213
  v_fma_f32 v202, v202, v213, v213
  v_fma_f32 v203, v203, v213, v213
  v_fma_f32 v204, v204, v213, v213
  v_fma_f32 v205, v205, v213, v213
  v_fma_f32 v206, v206, v213, v213
  v_mfma_f32_32x32x16_bf16 v[120:135], a[196:199], a[64:67], v[120:135]
  ds_read_b64_tr_b16 a[180:181], v18 offset:8192
  ds_read_b64_tr_b16 a[182:183], v18 offset:8704
  s_add_u32 m0, s88, 8192
  s_add_u32 s65, s66, 37888
  buffer_load_dwordx4 v38, s[20:23], s65 offen sc1 lds
  v_fma_f32 v207, v207, v213, v213
  v_rcp_f32 v200, v200
  v_rcp_f32 v201, v201
  v_rcp_f32 v202, v202
  v_rcp_f32 v203, v203
  v_mfma_f32_32x32x16_bf16 v[136:151], a[200:203], a[64:67], v[136:151]
  ds_read_b64_tr_b16 a[184:185], v19 offset:8192
  ds_read_b64_tr_b16 a[186:187], v19 offset:8704
  v_rcp_f32 v204, v204
  v_rcp_f32 v205, v205
  v_rcp_f32 v206, v206
  v_mfma_f32_32x32x16_bf16 v[152:167], a[204:207], a[64:67], v[152:167]
  ds_read_b64_tr_b16 a[188:189], v20 offset:8192
  ds_read_b64_tr_b16 a[190:191], v20 offset:8704
  s_add_u32 m0, s88, 12288
  s_add_u32 s65, s66, 38912
  buffer_load_dwordx4 v38, s[20:23], s65 offen sc1 lds
  v_rcp_f32 v207, v207
  s_add_u32 s46, s57, 4096
  v_mul_f32 v88, v88, v200
  v_mul_f32 v89, v89, v201
  v_mul_f32 v90, v90, v202
  v_mul_f32 v91, v91, v203
  v_mul_f32 v92, v92, v204
  v_mfma_f32_32x32x16_bf16 v[168:183], a[208:211], a[64:67], v[168:183]
  s_waitcnt lgkmcnt(6)
  ds_read_b64_tr_b16 a[192:193], v21 offset:8192
  ds_read_b64_tr_b16 a[194:195], v21 offset:8704
  v_mul_f32 v93, v93, v205
  v_mul_f32 v94, v94, v206
  v_mul_f32 v95, v95, v207
  v_cvt_pk_bf16_f32 v96, v88, v89
  v_cvt_pk_bf16_f32 v97, v90, v91
  v_cvt_pk_bf16_f32 v98, v92, v93
  v_cvt_pk_bf16_f32 v99, v94, v95
  buffer_store_dwordx4 v[96:99], v23, s[20:23], s46 offen offset:512 sc1
  v_mfma_f32_32x32x16_bf16 v[120:135], a[160:163], a[68:71], v[120:135]
  ds_read_b64_tr_b16 a[196:197], v18 offset:12288
  ds_read_b64_tr_b16 a[198:199], v18 offset:12800
  s_add_u32 m0, s88, 53248
  s_add_u32 s65, s66, 39936
  buffer_load_dwordx4 v38, s[20:23], s65 offen sc1 lds
  v_mfma_f32_32x32x16_bf16 v[136:151], a[164:167], a[68:71], v[136:151]
  ds_read_b64_tr_b16 a[200:201], v19 offset:12288
  ds_read_b64_tr_b16 a[202:203], v19 offset:12800
  v_mfma_f32_32x32x16_bf16 v[152:167], a[168:171], a[68:71], v[152:167]
  ds_read_b64_tr_b16 a[204:205], v20 offset:12288
  ds_read_b64_tr_b16 a[206:207], v20 offset:12800
  s_add_u32 m0, s88, 57344
  s_add_u32 s65, s66, 40960
  buffer_load_dwordx4 v38, s[20:23], s65 offen sc1 lds
  v_mfma_f32_32x32x16_bf16 v[168:183], a[172:175], a[68:71], v[168:183]
  s_waitcnt lgkmcnt(6)
  ds_read_b64_tr_b16 a[208:209], v21 offset:12288
  ds_read_b64_tr_b16 a[210:211], v21 offset:12800
  v_mfma_f32_32x32x16_bf16 v[120:135], a[180:183], a[72:75], v[120:135]
  s_waitcnt vmcnt(27)
  s_barrier
  v_add_u32 v18, 4294901760, v18
  v_add_u32 v19, 4294901760, v19
  v_add_u32 v20, 4294901760, v20
  v_add_u32 v21, 4294901760, v21
  ds_read_b64_tr_b16 a[160:161], v18 offset:0
  ds_read_b64_tr_b16 a[162:163], v18 offset:512
  s_mul_i32 s55, s97, 196608
  s_add_u32 s55, s55, s98
  s_add_u32 s56, s55, 22528
  s_add_u32 m0, s54, 131072
  s_nop 0
  buffer_load_dwordx4 v10, s[8:11], s55 offen lds
  v_mfma_f32_32x32x16_bf16 v[136:151], a[184:187], a[72:75], v[136:151]
  ds_read_b64_tr_b16 a[164:165], v19 offset:0
  ds_read_b64_tr_b16 a[166:167], v19 offset:512
  v_mfma_f32_32x32x16_bf16 v[152:167], a[188:191], a[72:75], v[152:167]
  ds_read_b64_tr_b16 a[168:169], v20 offset:0
  ds_read_b64_tr_b16 a[170:171], v20 offset:512
  buffer_load_dwordx4 v11, s[12:15], s55 offen offset:1024 lds
  v_mfma_f32_32x32x16_bf16 v[168:183], a[192:195], a[72:75], v[168:183]
  s_waitcnt lgkmcnt(6)
  ds_read_b64_tr_b16 a[172:173], v21 offset:0
  ds_read_b64_tr_b16 a[174:175], v21 offset:512
  v_mfma_f32_32x32x16_bf16 v[120:135], a[196:199], a[76:79], v[120:135]
  ds_read_b64_tr_b16 a[180:181], v18 offset:4096
  ds_read_b64_tr_b16 a[182:183], v18 offset:4608
  buffer_load_dwordx4 v10, s[8:11], s56 offen offset:2048 lds
  v_mfma_f32_32x32x16_bf16 v[136:151], a[200:203], a[76:79], v[136:151]
  ds_read_b64_tr_b16 a[184:185], v19 offset:4096
  ds_read_b64_tr_b16 a[186:187], v19 offset:4608
  v_mfma_f32_32x32x16_bf16 v[152:167], a[204:207], a[76:79], v[152:167]
  ds_read_b64_tr_b16 a[188:189], v20 offset:4096
  ds_read_b64_tr_b16 a[190:191], v20 offset:4608
  buffer_load_dwordx4 v11, s[12:15], s56 offen offset:3072 lds
  s_add_u32 s97, s97, 1
  s_cmp_eq_u32 s97, 10
  s_cselect_b32 s97, 0, s97
  v_mfma_f32_32x32x16_bf16 v[168:183], a[208:211], a[76:79], v[168:183]
  s_waitcnt lgkmcnt(6)
  ds_read_b64_tr_b16 a[192:193], v21 offset:4096
  ds_read_b64_tr_b16 a[194:195], v21 offset:4608
  v_mfma_f32_32x32x16_bf16 v[120:135], a[160:163], a[80:83], v[120:135]
  ds_read_b64_tr_b16 a[196:197], v18 offset:8192
  ds_read_b64_tr_b16 a[198:199], v18 offset:8704
  s_add_u32 m0, s88, 61440
  s_add_u32 s65, s66, 41984
  buffer_load_dwordx4 v38, s[20:23], s65 offen sc1 lds
  v_mfma_f32_32x32x16_bf16 v[136:151], a[164:167], a[80:83], v[136:151]
  ds_read_b64_tr_b16 a[200:201], v19 offset:8192
  ds_read_b64_tr_b16 a[202:203], v19 offset:8704
  v_mfma_f32_32x32x16_bf16 v[152:167], a[168:171], a[80:83], v[152:167]
  ds_read_b64_tr_b16 a[204:205], v20 offset:8192
  ds_read_b64_tr_b16 a[206:207], v20 offset:8704
  s_add_u32 m0, s88, 65536
  s_add_u32 s65, s66, 43008
  buffer_load_dwordx4 v38, s[20:23], s65 offen sc1 lds
  v_mfma_f32_32x32x16_bf16 v[168:183], a[172:175], a[80:83], v[168:183]
  s_waitcnt lgkmcnt(6)
  ds_read_b64_tr_b16 a[208:209], v21 offset:8192
  ds_read_b64_tr_b16 a[210:211], v21 offset:8704
  v_mfma_f32_32x32x16_bf16 v[120:135], a[180:183], a[84:87], v[120:135]
  ds_read_b64_tr_b16 a[160:161], v18 offset:12288
  ds_read_b64_tr_b16 a[162:163], v18 offset:12800
  s_add_u32 m0, s88, 69632
  s_add_u32 s65, s66, 44032
  buffer_load_dwordx4 v38, s[20:23], s65 offen sc1 lds
  s_waitcnt vmcnt(16)
  v_xor_b32 v39, s92, v193
  v_bitop3_b32 v39, v39, v191, s92 bitop3:0xf6
  v_mfma_f32_32x32x16_bf16 v[136:151], a[184:187], a[84:87], v[136:151]
  ds_read_b64_tr_b16 a[164:165], v19 offset:12288
  ds_read_b64_tr_b16 a[166:167], v19 offset:12800
  v_bitop3_b32 v39, v39, v189, s92 bitop3:0xf6
  v_bitop3_b32 v39, v39, v187, s92 bitop3:0xf6
  v_mfma_f32_32x32x16_bf16 v[152:167], a[188:191], a[84:87], v[152:167]
  ds_read_b64_tr_b16 a[168:169], v20 offset:12288
  ds_read_b64_tr_b16 a[170:171], v20 offset:12800
  s_add_u32 m0, s88, 73728
  s_add_u32 s65, s66, 45056
  buffer_load_dwordx4 v38, s[20:23], s65 offen sc1 lds
  v_bitop3_b32 v39, v39, v185, s92 bitop3:0xf6
  v_cmp_ne_u32 vcc, 0, v39
  v_mfma_f32_32x32x16_bf16 v[168:183], a[192:195], a[84:87], v[168:183]
  s_waitcnt lgkmcnt(6)
  ds_read_b64_tr_b16 a[172:173], v21 offset:12288
  ds_read_b64_tr_b16 a[174:175], v21 offset:12800
  s_cbranch_vccnz X_poll4_slow
X_poll4_ret:
  v_cmp_gt_u32 vcc, 32, v1
  v_mfma_f32_32x32x16_bf16 v[120:135], a[196:199], a[88:91], v[120:135]
  s_waitcnt vmcnt(10)
  s_barrier
  buffer_store_dword v211, v208, s[20:23], s53 offen offset:4 sc1
  ds_read_b64_tr_b16 a[180:181], v18 offset:16384
  ds_read_b64_tr_b16 a[182:183], v18 offset:16896
  s_mul_i32 s55, s97, 196608
  s_add_u32 s55, s55, s98
  s_add_u32 s56, s55, 22528
  s_add_u32 m0, s54, 147456
  s_nop 0
  buffer_load_dwordx4 v10, s[8:11], s55 offen lds
  v_add_f32 v184, v184, v186
  v_add_f32 v188, v188, v190
  v_mfma_f32_32x32x16_bf16 v[136:151], a[200:203], a[88:91], v[136:151]
  ds_read_b64_tr_b16 a[184:185], v19 offset:16384
  ds_read_b64_tr_b16 a[186:187], v19 offset:16896
  v_add_f32 v184, v184, v192
  v_add_f32 v184, v184, v188
  v_mfma_f32_32x32x16_bf16 v[152:167], a[204:207], a[88:91], v[152:167]
  ds_read_b64_tr_b16 a[188:189], v20 offset:16384
  ds_read_b64_tr_b16 a[190:191], v20 offset:16896
  buffer_load_dwordx4 v11, s[12:15], s55 offen offset:1024 lds
  v_mov_b32 v185, v184
  v_mov_b32 v190, 0
  v_mfma_f32_32x32x16_bf16 v[168:183], a[208:211], a[88:91], v[168:183]
  s_waitcnt lgkmcnt(6)
  ds_read_b64_tr_b16 a[192:193], v21 offset:16384
  ds_read_b64_tr_b16 a[194:195], v21 offset:16896
  v_mov_b32 v191, 0
  v_permlane32_swap_b32 v184, v185
  v_mfma_f32_32x32x16_bf16 v[120:135], a[160:163], a[92:95], v[120:135]
  ds_read_b64_tr_b16 a[196:197], v18 offset:20480
  ds_read_b64_tr_b16 a[198:199], v18 offset:20992
  buffer_load_dwordx4 v10, s[8:11], s56 offen offset:2048 lds
  v_add_f32 v184, v184, v185
  v_cndmask_b32 v184, 0, v184, vcc
  v_mfma_f32_32x32x16_bf16 v[136:151], a[164:167], a[92:95], v[136:151]
  ds_read_b64_tr_b16 a[200:201], v19 offset:20480
  ds_read_b64_tr_b16 a[202:203], v19 offset:20992
  v_cvt_pk_bf16_f32 v185, v184, v184
  v_and_b32 v185, s52, v185
  v_mfma_f32_32x32x16_bf16 v[152:167], a[168:171], a[92:95], v[152:167]
  ds_read_b64_tr_b16 a[204:205], v20 offset:20480
  ds_read_b64_tr_b16 a[206:207], v20 offset:20992
  buffer_load_dwordx4 v11, s[12:15], s56 offen offset:3072 lds
  s_add_u32 s97, s97, 1
  s_cmp_eq_u32 s97, 10
  s_cselect_b32 s97, 0, s97
  v_sub_f32 v184, v184, v185
  v_cvt_pk_bf16_f32 v188, v185, v184
  v_mfma_f32_32x32x16_bf16 v[168:183], a[172:175], a[92:95], v[168:183]
  s_waitcnt lgkmcnt(6)
  ds_read_b64_tr_b16 a[208:209], v21 offset:20480
  ds_read_b64_tr_b16 a[210:211], v21 offset:20992
  v_and_b32 v186, s52, v188
  v_sub_f32 v184, v184, v186
  v_mfma_f32_32x32x16_bf16 v[120:135], a[180:183], a[96:99], v[120:135]
  ds_read_b64_tr_b16 a[160:161], v18 offset:24576
  ds_read_b64_tr_b16 a[162:163], v18 offset:25088
  s_add_u32 m0, s88, 77824
  s_add_u32 s65, s66, 46080
  buffer_load_dwordx4 v38, s[20:23], s65 offen sc1 lds
  v_cvt_pk_bf16_f32 v189, v184, 0
  s_lshr_b32 s86, s54, 2
  v_mfma_f32_32x32x16_bf16 v[136:151], a[184:187], a[96:99], v[136:151]
  ds_read_b64_tr_b16 a[164:165], v19 offset:24576
  ds_read_b64_tr_b16 a[166:167], v19 offset:25088
  v_add_u32 v37, s86, v38
  ds_write_b128 v37, v[188:191] offset:16384
  v_mfma_f32_32x32x16_bf16 v[152:167], a[188:191], a[96:99], v[152:167]
  ds_read_b64_tr_b16 a[168:169], v20 offset:24576
  ds_read_b64_tr_b16 a[170:171], v20 offset:25088
  buffer_load_dwordx4 a[8:11], v38, s[20:23], s64 offen offset:2048 sc1
  v_mfma_f32_32x32x16_bf16 v[168:183], a[192:195], a[96:99], v[168:183]
  s_waitcnt lgkmcnt(7)
  ds_read_b64_tr_b16 a[172:173], v21 offset:24576
  ds_read_b64_tr_b16 a[174:175], v21 offset:25088
  v_mfma_f32_32x32x16_bf16 v[120:135], a[196:199], a[100:103], v[120:135]
  ds_read_b64_tr_b16 a[180:181], v18 offset:28672
  ds_read_b64_tr_b16 a[182:183], v18 offset:29184
  buffer_load_dwordx4 a[12:15], v38, s[20:23], s64 offen offset:3072 sc1
  v_mfma_f32_32x32x16_bf16 v[136:151], a[200:203], a[100:103], v[136:151]
  ds_read_b64_tr_b16 a[184:185], v19 offset:28672
  ds_read_b64_tr_b16 a[186:187], v19 offset:29184
  v_mfma_f32_32x32x16_bf16 v[152:167], a[204:207], a[100:103], v[152:167]
  ds_read_b64_tr_b16 a[188:189], v20 offset:28672
  ds_read_b64_tr_b16 a[190:191], v20 offset:29184
  s_add_u32 s64, s66, 4096
  buffer_load_dwordx4 a[16:19], v38, s[20:23], s64 offen offset:0 sc1
  v_mfma_f32_32x32x16_bf16 v[168:183], a[208:211], a[100:103], v[168:183]
  s_waitcnt lgkmcnt(6)
  ds_read_b64_tr_b16 a[192:193], v21 offset:28672
  ds_read_b64_tr_b16 a[194:195], v21 offset:29184
  v_mfma_f32_32x32x16_bf16 v[120:135], a[160:163], a[104:107], v[120:135]
  s_barrier
  ds_read_b64_tr_b16 a[196:197], v18 offset:32768
  ds_read_b64_tr_b16 a[198:199], v18 offset:33280
  s_add_u32 s64, s66, 5120
  buffer_load_dwordx4 a[20:23], v38, s[20:23], s64 offen offset:0 sc1
  ds_read_b128 a[220:223], v38 offset:16384
  ds_read_b128 a[224:227], v38 offset:17408
  v_mfma_f32_32x32x16_bf16 v[136:151], a[164:167], a[104:107], v[136:151]
  ds_read_b64_tr_b16 a[200:201], v18 offset:36864
  ds_read_b64_tr_b16 a[202:203], v18 offset:37376
  ds_read_b128 a[228:231], v38 offset:18432
  s_waitcnt lgkmcnt(10)
  ds_read_b128 a[232:235], v38 offset:19456
  v_mfma_f32_32x32x16_bf16 v[152:167], a[168:171], a[104:107], v[152:167]
  ds_read_b64_tr_b16 a[204:205], v18 offset:40960
  ds_read_b64_tr_b16 a[206:207], v18 offset:41472
  buffer_load_dwordx4 a[24:27], v38, s[20:23], s64 offen offset:1024 sc1
  s_and_b32 s87, s79, 8
  s_lshl_b32 s86, s42, 1
  v_mfma_f32_32x32x16_bf16 v[168:183], a[172:175], a[104:107], v[168:183]
  s_waitcnt lgkmcnt(10)
  ds_read_b64_tr_b16 a[208:209], v18 offset:45056
  ds_read_b64_tr_b16 a[210:211], v18 offset:45568
  s_add_u32 s87, s87, s86
  s_lshl_b32 s86, s78, 4
  v_mfma_f32_32x32x16_bf16 v[120:135], a[180:183], a[108:111], v[120:135]
  s_waitcnt vmcnt(15)
  s_waitcnt vmcnt(6)
  s_barrier
  ds_read_b64_tr_b16 a[160:161], v18 offset:49152
  ds_read_b64_tr_b16 a[162:163], v18 offset:49664
  buffer_load_dwordx4 a[28:31], v38, s[20:23], s64 offen offset:2048 sc1
  s_add_u32 s87, s87, s86
  s_lshl_b32 s87, s87, 7
  v_mfma_f32_32x32x16_bf16 v[136:151], a[184:187], a[108:111], v[136:151]
  ds_read_b64_tr_b16 a[164:165], v18 offset:53248
  s_waitcnt lgkmcnt(10)
  ds_read_b64_tr_b16 a[166:167], v18 offset:53760
  s_add_u32 s87, s87, 15908864
  v_mov_b32 v248, 0
  v_mfma_f32_32x32x16_bf16 v[152:167], a[188:191], a[108:111], v[152:167]
  ds_read_b64_tr_b16 a[168:169], v18 offset:57344
  ds_read_b64_tr_b16 a[170:171], v18 offset:57856
  buffer_load_dwordx4 a[32:35], v38, s[20:23], s64 offen offset:3072 sc1
  v_mfma_f32_32x32x16_bf16 v[168:183], a[192:195], a[108:111], v[168:183]
  s_waitcnt lgkmcnt(6)
  ds_read_b64_tr_b16 a[172:173], v18 offset:61440
  ds_read_b64_tr_b16 a[174:175], v18 offset:61952
  v_mfma_f32_32x32x16_bf16 v[120:135], a[196:199], a[112:115], v[120:135]
  v_add_u32 v18, 65536, v18
  v_add_u32 v19, 65536, v19
  v_add_u32 v20, 65536, v20
  v_add_u32 v21, 65536, v21
  ds_read_b64_tr_b16 a[180:181], v18 offset:0
  ds_read_b64_tr_b16 a[182:183], v18 offset:512
  s_add_u32 s64, s66, 9216
  buffer_load_dwordx4 a[36:39], v38, s[20:23], s64 offen offset:0 sc1
  v_mfma_f32_32x32x16_bf16 v[120:135], a[200:203], a[116:119], v[120:135]
  ds_read_b64_tr_b16 a[184:185], v18 offset:4096
  ds_read_b64_tr_b16 a[186:187], v18 offset:4608
  v_mfma_f32_32x32x16_bf16 v[120:135], a[204:207], a[120:123], v[120:135]
  ds_read_b64_tr_b16 a[188:189], v18 offset:8192
  ds_read_b64_tr_b16 a[190:191], v18 offset:8704
  s_add_u32 s64, s66, 10240
  buffer_load_dwordx4 a[40:43], v38, s[20:23], s64 offen offset:0 sc1
  v_mfma_f32_32x32x16_bf16 v[120:135], a[208:211], a[124:127], v[120:135]
  s_waitcnt lgkmcnt(6)
  ds_read_b64_tr_b16 a[192:193], v18 offset:12288
  ds_read_b64_tr_b16 a[194:195], v18 offset:12800
  v_mfma_f32_32x32x16_bf16 v[120:135], a[160:163], a[128:131], v[120:135]
  v_add_u32 v18, 4294934528, v18
  v_add_u32 v19, 4294934528, v19
  v_add_u32 v20, 4294934528, v20
  v_add_u32 v21, 4294934528, v21
  ds_read_b64_tr_b16 a[196:197], v19 offset:0
  ds_read_b64_tr_b16 a[198:199], v19 offset:512
  buffer_load_dwordx4 a[44:47], v38, s[20:23], s64 offen offset:1024 sc1
  v_mfma_f32_32x32x16_bf16 v[120:135], a[164:167], a[132:135], v[120:135]
  ds_read_b64_tr_b16 a[200:201], v19 offset:4096
  ds_read_b64_tr_b16 a[202:203], v19 offset:4608
  v_mfma_f32_32x32x16_bf16 v[120:135], a[168:171], a[136:139], v[120:135]
  ds_read_b64_tr_b16 a[204:205], v19 offset:8192
  ds_read_b64_tr_b16 a[206:207], v19 offset:8704
  buffer_load_dwordx4 a[48:51], v38, s[20:23], s64 offen offset:2048 sc1
  v_mfma_f32_32x32x16_bf16 v[120:135], a[172:175], a[140:143], v[120:135]
  s_waitcnt lgkmcnt(6)
  ds_read_b64_tr_b16 a[208:209], v19 offset:12288
  ds_read_b64_tr_b16 a[210:211], v19 offset:12800
  v_mfma_f32_32x32x16_bf16 v[120:135], a[180:183], a[144:147], v[120:135]
  ds_read_b64_tr_b16 a[160:161], v19 offset:16384
  ds_read_b64_tr_b16 a[162:163], v19 offset:16896
  buffer_load_dwordx4 a[52:55], v38, s[20:23], s64 offen offset:3072 sc1
  v_mfma_f32_32x32x16_bf16 v[120:135], a[184:187], a[148:151], v[120:135]
  ds_read_b64_tr_b16 a[164:165], v19 offset:20480
  ds_read_b64_tr_b16 a[166:167], v19 offset:20992
  v_mfma_f32_32x32x16_bf16 v[120:135], a[188:191], a[152:155], v[120:135]
  ds_read_b64_tr_b16 a[168:169], v19 offset:24576
  ds_read_b64_tr_b16 a[170:171], v19 offset:25088
  s_add_u32 s64, s66, 14336
  buffer_load_dwordx4 a[56:59], v38, s[20:23], s64 offen offset:0 sc1
  v_mfma_f32_32x32x16_bf16 v[120:135], a[192:195], a[156:159], v[120:135]
  s_waitcnt lgkmcnt(6)
  ds_read_b64_tr_b16 a[172:173], v19 offset:28672
  ds_read_b64_tr_b16 a[174:175], v19 offset:29184
  v_mfma_f32_32x32x16_bf16 v[120:135], a[220:223], v[28:31], v[120:135]
  s_add_u32 s64, s66, 15360
  buffer_load_dwordx4 a[60:63], v38, s[20:23], s64 offen offset:0 sc1
  v_mfma_f32_32x32x16_bf16 v[136:151], a[196:199], a[112:115], v[136:151]
  ds_read_b64_tr_b16 a[180:181], v19 offset:32768
  ds_read_b64_tr_b16 a[182:183], v19 offset:33280
  s_nop 1
  s_nop 4
  v_mul_f32 v200, v212, v120
  v_mul_f32 v201, v212, v121
  v_mul_f32 v202, v212, v122
  v_mul_f32 v203, v212, v123
  v_mfma_f32_32x32x16_bf16 v[136:151], a[200:203], a[116:119], v[136:151]
  ds_read_b64_tr_b16 a[184:185], v19 offset:36864
  ds_read_b64_tr_b16 a[186:187], v19 offset:37376
  buffer_load_dwordx4 a[64:67], v38, s[20:23], s64 offen offset:1024 sc1
  v_mul_f32 v204, v212, v124
  v_mul_f32 v205, v212, v125
  v_mul_f32 v206, v212, v126
  v_mul_f32 v207, v212, v127
  v_exp_f32 v200, v200
  v_mfma_f32_32x32x16_bf16 v[136:151], a[204:207], a[120:123], v[136:151]
  ds_read_b64_tr_b16 a[188:189], v19 offset:40960
  ds_read_b64_tr_b16 a[190:191], v19 offset:41472
  v_mul_f32 v120, v120, v128
  v_exp_f32 v201, v201
  v_mul_f32 v121, v121, v129
  v_exp_f32 v202, v202
  v_mfma_f32_32x32x16_bf16 v[136:151], a[208:211], a[124:127], v[136:151]
  s_waitcnt lgkmcnt(6)
  ds_read_b64_tr_b16 a[192:193], v19 offset:45056
  ds_read_b64_tr_b16 a[194:195], v19 offset:45568
  buffer_load_dwordx4 a[68:71], v38, s[20:23], s64 offen offset:2048 sc1
  v_mul_f32 v122, v122, v130
  v_exp_f32 v203, v203
  v_mul_f32 v123, v123, v131
  v_exp_f32 v204, v204
  v_mfma_f32_32x32x16_bf16 v[136:151], a[160:163], a[128:131], v[136:151]
  ds_read_b64_tr_b16 a[196:197], v20 offset:0
  ds_read_b64_tr_b16 a[198:199], v20 offset:512
  v_mul_f32 v124, v124, v132
  v_exp_f32 v205, v205
  v_mul_f32 v125, v125, v133
  v_mfma_f32_32x32x16_bf16 v[136:151], a[164:167], a[132:135], v[136:151]
  ds_read_b64_tr_b16 a[200:201], v20 offset:4096
  ds_read_b64_tr_b16 a[202:203], v20 offset:4608
  buffer_load_dwordx4 a[72:75], v38, s[20:23], s64 offen offset:3072 sc1
  v_exp_f32 v206, v206
  v_mul_f32 v126, v126, v134
  v_exp_f32 v207, v207
  v_mul_f32 v127, v127, v135
  v_mfma_f32_32x32x16_bf16 v[136:151], a[168:171], a[136:139], v[136:151]
  ds_read_b64_tr_b16 a[204:205], v20 offset:8192
  ds_read_b64_tr_b16 a[206:207], v20 offset:8704
  v_fma_f32 v200, v200, v213, v213
  v_fma_f32 v201, v201, v213, v213
  v_fma_f32 v202, v202, v213, v213
  v_fma_f32 v203, v203, v213, v213
  v_fma_f32 v204, v204, v213, v213
  v_mfma_f32_32x32x16_bf16 v[136:151], a[172:175], a[140:143], v[136:151]
  s_waitcnt lgkmcnt(6)
  ds_read_b64_tr_b16 a[208:209], v20 offset:12288
  ds_read_b64_tr_b16 a[210:211], v20 offset:12800
  s_add_u32 s64, s66, 19456
  buffer_load_dwordx4 a[76:79], v38, s[20:23], s64 offen offset:0 sc1
  v_fma_f32 v205, v205, v213, v213
  v_fma_f32 v206, v206, v213, v213
  v_fma_f32 v207, v207, v213, v213
  v_rcp_f32 v200, v200
  v_rcp_f32 v201, v201
  v_mfma_f32_32x32x16_bf16 v[136:151], a[180:183], a[144:147], v[136:151]
  ds_read_b64_tr_b16 a[160:161], v20 offset:16384
  ds_read_b64_tr_b16 a[162:163], v20 offset:16896
  v_rcp_f32 v202, v202
  v_rcp_f32 v203, v203
  v_mfma_f32_32x32x16_bf16 v[136:151], a[184:187], a[148:151], v[136:151]
  ds_read_b64_tr_b16 a[164:165], v20 offset:20480
  ds_read_b64_tr_b16 a[166:167], v20 offset:20992
  s_add_u32 s64, s66, 20480
  buffer_load_dwordx4 a[80:83], v38, s[20:23], s64 offen offset:0 sc1
  v_rcp_f32 v204, v204
  v_rcp_f32 v205, v205
  v_rcp_f32 v206, v206
  v_mfma_f32_32x32x16_bf16 v[136:151], a[188:191], a[152:155], v[136:151]
  ds_read_b64_tr_b16 a[168:169], v20 offset:24576
  ds_read_b64_tr_b16 a[170:171], v20 offset:25088
  v_rcp_f32 v207, v207
  s_add_u32 s46, s57, 8192
  v_mul_f32 v120, v120, v200
  v_mul_f32 v121, v121, v201
  v_mfma_f32_32x32x16_bf16 v[136:151], a[192:195], a[156:159], v[136:151]
  s_waitcnt lgkmcnt(6)
  ds_read_b64_tr_b16 a[172:173], v20 offset:28672
  ds_read_b64_tr_b16 a[174:175], v20 offset:29184
  buffer_load_dwordx4 a[84:87], v38, s[20:23], s64 offen offset:1024 sc1
  v_mul_f32 v122, v122, v202
  v_mul_f32 v123, v123, v203
  v_mul_f32 v124, v124, v204
  v_mul_f32 v125, v125, v205
  v_mul_f32 v126, v126, v206
  v_mfma_f32_32x32x16_bf16 v[136:151], a[224:227], v[28:31], v[136:151]
  v_mul_f32 v127, v127, v207
  v_cvt_pk_bf16_f32 v128, v120, v121
  v_cvt_pk_bf16_f32 v129, v122, v123
  v_cvt_pk_bf16_f32 v130, v124, v125
  v_cvt_pk_bf16_f32 v131, v126, v127
  buffer_store_dwordx4 v[128:131], v23, s[20:23], s46 offen offset:0 sc1
  v_mfma_f32_32x32x16_bf16 v[152:167], a[196:199], a[112:115], v[152:167]
  ds_read_b64_tr_b16 a[180:181], v20 offset:32768
  ds_read_b64_tr_b16 a[182:183], v20 offset:33280
  buffer_load_dwordx4 a[88:91], v38, s[20:23], s64 offen offset:2048 sc1
  s_nop 1
  v_mul_f32 v200, v212, v136
  v_mul_f32 v201, v212, v137
  v_mul_f32 v202, v212, v138
  v_mul_f32 v203, v212, v139
  v_mul_f32 v204, v212, v140
  v_mfma_f32_32x32x16_bf16 v[152:167], a[200:203], a[116:119], v[152:167]
  ds_read_b64_tr_b16 a[184:185], v20 offset:36864
  ds_read_b64_tr_b16 a[186:187], v20 offset:37376
  v_mul_f32 v205, v212, v141
  v_mul_f32 v206, v212, v142
  v_mul_f32 v207, v212, v143
  v_exp_f32 v200, v200
  v_mfma_f32_32x32x16_bf16 v[152:167], a[204:207], a[120:123], v[152:167]
  ds_read_b64_tr_b16 a[188:189], v20 offset:40960
  ds_read_b64_tr_b16 a[190:191], v20 offset:41472
  buffer_load_dwordx4 a[92:95], v38, s[20:23], s64 offen offset:3072 sc1
  v_mul_f32 v136, v136, v144
  v_exp_f32 v201, v201
  v_mul_f32 v137, v137, v145
  v_exp_f32 v202, v202
  v_mfma_f32_32x32x16_bf16 v[152:167], a[208:211], a[124:127], v[152:167]
  s_waitcnt lgkmcnt(6)
  ds_read_b64_tr_b16 a[192:193], v20 offset:45056
  ds_read_b64_tr_b16 a[194:195], v20 offset:45568
  v_mul_f32 v138, v138, v146
  v_exp_f32 v203, v203
  v_mul_f32 v139, v139, v147
  v_exp_f32 v204, v204
  v_mfma_f32_32x32x16_bf16 v[152:167], a[160:163], a[128:131], v[152:167]
  ds_read_b64_tr_b16 a[196:197], v21 offset:0
  ds_read_b64_tr_b16 a[198:199], v21 offset:512
  s_add_u32 s64, s66, 24576
  buffer_load_dwordx4 a[96:99], v38, s[20:23], s64 offen offset:0 sc1
  v_mul_f32 v140, v140, v148
  v_exp_f32 v205, v205
  v_mul_f32 v141, v141, v149
  v_mfma_f32_32x32x16_bf16 v[152:167], a[164:167], a[132:135], v[152:167]
  ds_read_b64_tr_b16 a[200:201], v21 offset:4096
  ds_read_b64_tr_b16 a[202:203], v21 offset:4608
  v_exp_f32 v206, v206
  v_mul_f32 v142, v142, v150
  v_exp_f32 v207, v207
  v_mul_f32 v143, v143, v151
  v_mfma_f32_32x32x16_bf16 v[152:167], a[168:171], a[136:139], v[152:167]
  ds_read_b64_tr_b16 a[204:205], v21 offset:8192
  ds_read_b64_tr_b16 a[206:207], v21 offset:8704
  s_add_u32 s64, s66, 25600
  buffer_load_dwordx4 a[100:103], v38, s[20:23], s64 offen offset:0 sc1
  v_fma_f32 v200, v200, v213, v213
  v_fma_f32 v201, v201, v213, v213
  v_fma_f32 v202, v202, v213, v213
  v_fma_f32 v203, v203, v213, v213
  v_fma_f32 v204, v204, v213, v213
  v_mfma_f32_32x32x16_bf16 v[152:167], a[172:175], a[140:143], v[152:167]
  s_waitcnt lgkmcnt(6)
  ds_read_b64_tr_b16 a[208:209], v21 offset:12288
  ds_read_b64_tr_b16 a[210:211], v21 offset:12800
  v_fma_f32 v205, v205, v213, v213
  v_fma_f32 v206, v206, v213, v213
  v_fma_f32 v207, v207, v213, v213
  v_rcp_f32 v200, v200
  v_rcp_f32 v201, v201
  v_mfma_f32_32x32x16_bf16 v[152:167], a[180:183], a[144:147], v[152:167]
  ds_read_b64_tr_b16 a[160:161], v21 offset:16384
  ds_read_b64_tr_b16 a[162:163], v21 offset:16896
  buffer_load_dwordx4 a[104:107], v38, s[20:23], s64 offen offset:1024 sc1
  v_rcp_f32 v202, v202
  v_rcp_f32 v203, v203
  v_mfma_f32_32x32x16_bf16 v[152:167], a[184:187], a[148:151], v[152:167]
  ds_read_b64_tr_b16 a[164:165], v21 offset:20480
  ds_read_b64_tr_b16 a[166:167], v21 offset:20992
  v_rcp_f32 v204, v204
  v_rcp_f32 v205, v205
  v_rcp_f32 v206, v206
  v_mfma_f32_32x32x16_bf16 v[152:167], a[188:191], a[152:155], v[152:167]
  ds_read_b64_tr_b16 a[168:169], v21 offset:24576
  ds_read_b64_tr_b16 a[170:171], v21 offset:25088
  buffer_load_dwordx4 a[108:111], v38, s[20:23], s64 offen offset:2048 sc1
  v_rcp_f32 v207, v207
  s_add_u32 s46, s57, 8192
  v_mul_f32 v136, v136, v200
  v_mul_f32 v137, v137, v201
  v_mfma_f32_32x32x16_bf16 v[152:167], a[192:195], a[156:159], v[152:167]
  s_waitcnt lgkmcnt(6)
  ds_read_b64_tr_b16 a[172:173], v21 offset:28672
  ds_read_b64_tr_b16 a[174:175], v21 offset:29184
  v_mul_f32 v138, v138, v202
  v_mul_f32 v139, v139, v203
  v_mul_f32 v140, v140, v204
  v_mul_f32 v141, v141, v205
  v_mul_f32 v142, v142, v206
  v_mfma_f32_32x32x16_bf16 v[152:167], a[228:231], v[28:31], v[152:167]
  buffer_load_dwordx4 a[176:179], v38, s[20:23], s64 offen offset:3072 sc1
  v_mul_f32 v143, v143, v207
  v_cvt_pk_bf16_f32 v144, v136, v137
  v_cvt_pk_bf16_f32 v145, v138, v139
  v_cvt_pk_bf16_f32 v146, v140, v141
  v_cvt_pk_bf16_f32 v147, v142, v143
  buffer_store_dwordx4 v[144:147], v23, s[20:23], s46 offen offset:512 sc1
  v_mfma_f32_32x32x16_bf16 v[168:183], a[196:199], a[112:115], v[168:183]
  ds_read_b64_tr_b16 a[180:181], v21 offset:32768
  ds_read_b64_tr_b16 a[182:183], v21 offset:33280
  s_nop 1
  v_mul_f32 v200, v212, v152
  v_mul_f32 v201, v212, v153
  v_mul_f32 v202, v212, v154
  v_mul_f32 v203, v212, v155
  v_mul_f32 v204, v212, v156
  v_mul_f32 v205, v212, v157
  v_mfma_f32_32x32x16_bf16 v[168:183], a[200:203], a[116:119], v[168:183]
  ds_read_b64_tr_b16 a[184:185], v21 offset:36864
  ds_read_b64_tr_b16 a[186:187], v21 offset:37376
  s_add_u32 s64, s66, 29696
  buffer_load_dwordx4 a[212:215], v38, s[20:23], s64 offen offset:0 sc1
  v_mul_f32 v206, v212, v158
  v_mul_f32 v207, v212, v159
  v_exp_f32 v200, v200
  v_mul_f32 v152, v152, v160
  v_mfma_f32_32x32x16_bf16 v[168:183], a[204:207], a[120:123], v[168:183]
  ds_read_b64_tr_b16 a[188:189], v21 offset:40960
  ds_read_b64_tr_b16 a[190:191], v21 offset:41472
  v_exp_f32 v201, v201
  v_mul_f32 v153, v153, v161
  v_exp_f32 v202, v202
  v_mfma_f32_32x32x16_bf16 v[168:183], a[208:211], a[124:127], v[168:183]
  s_waitcnt lgkmcnt(6)
  ds_read_b64_tr_b16 a[192:193], v21 offset:45056
  ds_read_b64_tr_b16 a[194:195], v21 offset:45568
  s_add_u32 s64, s66, 30720
  buffer_load_dwordx4 a[216:219], v38, s[20:23], s64 offen offset:0 sc1
  v_mul_f32 v154, v154, v162
  v_exp_f32 v203, v203
  v_mul_f32 v155, v155, v163
  v_exp_f32 v204, v204
  v_mfma_f32_32x32x16_bf16 v[168:183], a[160:163], a[128:131], v[168:183]
  v_mul_f32 v156, v156, v164
  v_exp_f32 v205, v205
  v_mul_f32 v157, v157, v165
  v_exp_f32 v206, v206
  v_mfma_f32_32x32x16_bf16 v[168:183], a[164:167], a[132:135], v[168:183]
  buffer_load_dwordx4 a[240:243], v38, s[20:23], s64 offen offset:1024 sc1
  v_mul_f32 v158, v158, v166
  v_exp_f32 v207, v207
  v_mul_f32 v159, v159, v167
  v_mfma_f32_32x32x16_bf16 v[168:183], a[168:171], a[136:139], v[168:183]
  v_fma_f32 v200, v200, v213, v213
  v_fma_f32 v201, v201, v213, v213
  v_fma_f32 v202, v202, v213, v213
  v_fma_f32 v203, v203, v213, v213
  v_fma_f32 v204, v204, v213, v213
  v_fma_f32 v205, v205, v213, v213
  v_mfma_f32_32x32x16_bf16 v[168:183], a[172:175], a[140:143], v[168:183]
  buffer_load_dwordx4 a[244:247], v38, s[20:23], s64 offen offset:2048 sc1
  v_fma_f32 v206, v206, v213, v213
  v_fma_f32 v207, v207, v213, v213
  v_rcp_f32 v200, v200
  v_rcp_f32 v201, v201
  s_waitcnt lgkmcnt(0)
  v_mfma_f32_32x32x16_bf16 v[168:183], a[180:183], a[144:147], v[168:183]
  v_rcp_f32 v202, v202
  v_rcp_f32 v203, v203
  v_mfma_f32_32x32x16_bf16 v[168:183], a[184:187], a[148:151], v[168:183]
  buffer_load_dwordx4 a[248:251], v38, s[20:23], s64 offen offset:3072 sc1
  v_rcp_f32 v204, v204
  v_rcp_f32 v205, v205
  v_rcp_f32 v206, v206
  v_mfma_f32_32x32x16_bf16 v[168:183], a[188:191], a[152:155], v[168:183]
  v_rcp_f32 v207, v207
  s_add_u32 s46, s57, 12288
  v_mul_f32 v152, v152, v200
  v_mul_f32 v153, v153, v201
  v_mfma_f32_32x32x16_bf16 v[168:183], a[192:195], a[156:159], v[168:183]
  s_add_u32 s64, s66, 34816
  buffer_load_dwordx4 a[252:255], v38, s[20:23], s64 offen offset:0 sc1
  v_mul_f32 v154, v154, v202
  v_mul_f32 v155, v155, v203
  v_mul_f32 v156, v156, v204
  v_mul_f32 v157, v157, v205
  v_mul_f32 v158, v158, v206
  v_mul_f32 v159, v159, v207
  v_mfma_f32_32x32x16_bf16 v[168:183], a[232:235], v[28:31], v[168:183]
  v_cvt_pk_bf16_f32 v160, v152, v153
  v_cvt_pk_bf16_f32 v161, v154, v155
  v_cvt_pk_bf16_f32 v162, v156, v157
  v_cvt_pk_bf16_f32 v163, v158, v159
  buffer_store_dwordx4 v[160:163], v23, s[20:23], s46 offen offset:0 sc1
  s_nop 6
  v_mul_f32 v200, v212, v168
  v_mul_f32 v201, v212, v169
  v_mul_f32 v202, v212, v170
  v_mul_f32 v203, v212, v171
  v_mul_f32 v204, v212, v172
  v_mul_f32 v205, v212, v173
  v_mul_f32 v206, v212, v174
  v_mul_f32 v207, v212, v175
  v_exp_f32 v200, v200
  v_mul_f32 v168, v168, v176
  v_exp_f32 v201, v201
  v_mul_f32 v169, v169, v177
  v_exp_f32 v202, v202
  v_mul_f32 v170, v170, v178
  v_exp_f32 v203, v203
  v_mul_f32 v171, v171, v179
  v_exp_f32 v204, v204
  v_mul_f32 v172, v172, v180
  v_exp_f32 v205, v205
  v_mul_f32 v173, v173, v181
  v_exp_f32 v206, v206
  v_mul_f32 v174, v174, v182
  v_exp_f32 v207, v207
  v_mul_f32 v175, v175, v183
  v_fma_f32 v200, v200, v213, v213
  v_fma_f32 v201, v201, v213, v213
  v_fma_f32 v202, v202, v213, v213
  v_fma_f32 v203, v203, v213, v213
  v_fma_f32 v204, v204, v213, v213
  v_fma_f32 v205, v205, v213, v213
  v_fma_f32 v206, v206, v213, v213
  v_fma_f32 v207, v207, v213, v213
  v_rcp_f32 v200, v200
  v_rcp_f32 v201, v201
  v_rcp_f32 v202, v202
  v_rcp_f32 v203, v203
  v_rcp_f32 v204, v204
  v_rcp_f32 v205, v205
  v_rcp_f32 v206, v206
  v_rcp_f32 v207, v207
  s_add_u32 s46, s57, 12288
  v_mul_f32 v168, v168, v200
  v_mul_f32 v169, v169, v201
  v_mul_f32 v170, v170, v202
  v_mul_f32 v171, v171, v203
  v_mul_f32 v172, v172, v204
  v_mul_f32 v173, v173, v205
  v_mul_f32 v174, v174, v206
  v_mul_f32 v175, v175, v207
  v_cvt_pk_bf16_f32 v176, v168, v169
  v_cvt_pk_bf16_f32 v177, v170, v171
  v_cvt_pk_bf16_f32 v178, v172, v173
  v_cvt_pk_bf16_f32 v179, v174, v175
  buffer_store_dwordx4 v[176:179], v23, s[20:23], s46 offen offset:512 sc1
  v_add_u32 v209, s88, v38
  v_add_u32 v22, 65536, v209
  v_add_u32 v28, 131072, v209
  s_waitcnt vmcnt(37)
  ds_read_b128 a[112:115], v209 offset:0
  ds_read_b128 a[116:119], v209 offset:4096
  ds_read_b128 a[120:123], v209 offset:8192
  ds_read_b128 a[124:127], v209 offset:12288
  ds_read_b128 a[128:131], v209 offset:53248
  ds_read_b128 a[132:135], v209 offset:57344
  ds_read_b128 a[136:139], v209 offset:61440
  ds_read_b128 a[140:143], v22 offset:0
  ds_read_b128 a[144:147], v22 offset:4096
  ds_read_b128 a[148:151], v22 offset:8192
  ds_read_b128 a[152:155], v22 offset:12288
  v_mov_b32 v35, v211
  v_mov_b32 v37, v208
  s_add_u32 s64, s66, 47104
  buffer_load_dwordx4 a[156:159], v38, s[20:23], s64 offen sc1
  s_add_u32 s64, s66, 48128
  buffer_load_dwordx4 a[160:163], v38, s[20:23], s64 offen sc1
  s_add_u32 s64, s66, 49152
  buffer_load_dwordx4 a[164:167], v38, s[20:23], s64 offen sc1
  s_add_u32 s64, s66, 50176
  buffer_load_dwordx4 a[168:171], v38, s[20:23], s64 offen sc1
  s_add_u32 s64, s66, 51200
  buffer_load_dwordx4 a[172:175], v38, s[20:23], s64 offen sc1
  s_add_u32 s64, s66, 52224
  buffer_load_dwordx4 a[180:183], v38, s[20:23], s64 offen sc1
  s_add_u32 s64, s66, 53248
  buffer_load_dwordx4 a[184:187], v38, s[20:23], s64 offen sc1
  s_add_u32 s64, s66, 54272
  buffer_load_dwordx4 a[188:191], v38, s[20:23], s64 offen sc1
  s_add_u32 s64, s66, 55296
  buffer_load_dwordx4 a[192:195], v38, s[20:23], s64 offen sc1
  s_waitcnt vmcnt(9)
  s_barrier
  buffer_store_dword v35, v37, s[20:23], s53 offen sc1
  s_mov_b32 s8, s80
  s_mov_b32 s9, s81
  s_mov_b32 s10, 1280
  s_mov_b32 s11, 0x20000
  s_mov_b32 s12, s90
  s_mov_b32 s13, s91
  s_mov_b32 s14, 5242880
  s_mov_b32 s15, 0x20000
  s_and_b32 s100, s79, 7
  s_lshr_b32 s101, s79, 3
  s_lshl_b32 s45, s78, 1
  s_add_u32 s101, s101, s45
  s_mul_i32 s61, s48, 1280
  s_add_u32 s61, s61, s49
  s_lshl_b32 s61, s61, 1
  s_and_b32 s59, s49, 127
  s_add_u32 s59, s59, s50
  s_mov_b32 s60, s50
  v_lshlrev_b32 v5, 2, v1
  s_add_u32 m0, s60, 4096
  s_nop 0
  buffer_load_dword v5, s[8:11], s49 offen lds
  s_lshl_b32 s49, s48, 4
  s_add_u32 s49, s49, 15138816
  v_and_b32 v3, 15, v1
  v_lshlrev_b32 v3, 4, v3
  buffer_load_dwordx4 v[252:255], v3, s[20:23], s49 offen sc1
  s_lshl_b32 s44, s101, 3
  s_add_u32 s44, s44, s100
  s_mul_i32 s62, s44, 28672
  s_add_u32 s62, s62, 15958016
  s_xor_b32 s44, s44, 8
  s_mul_i32 s63, s44, 28672
  s_add_u32 s63, s63, 15958016
  v_lshlrev_b32 v17, 4, v0
  v_and_b32 v4, 15, v1
  v_mul_u32_u24 v4, 336, v4
  v_lshrrev_b32 v5, 4, v1
  v_lshl_add_u32 v4, v5, 4, v4
  s_mul_i32 s44, s42, 21504
  v_add_u32 v36, s44, v4
  s_mul_i32 s44, s42, 5376
  v_add_u32 v4, 0, v1
  v_mul_u32_u24 v5, 3277, v4
  v_lshrrev_b32 v5, 16, v5
  v_lshlrev_b32 v4, 4, v4
  v_lshl_add_u32 v2, v5, 4, v4
  v_add_u32 v6, s44, v2
  v_mul_u32_u24 v2, 320, v5
  v_sub_u32 v4, v4, v2
  v_lshl_add_u32 v11, v2, 3, v4
  v_lshrrev_b32 v4, 1, v4
  v_lshl_add_u32 v2, v5, 8, v4
  v_add_u32 v216, s59, v2
  v_add_u32 v226, s60, v4
  v_lshlrev_b32 v5, 3, v5
  v_add_u32 v236, s60, v5
  v_add_u32 v4, 64, v1
  v_mul_u32_u24 v5, 3277, v4
  v_lshrrev_b32 v5, 16, v5
  v_lshlrev_b32 v4, 4, v4
  v_lshl_add_u32 v2, v5, 4, v4
  v_add_u32 v7, s44, v2
  v_mul_u32_u24 v2, 320, v5
  v_sub_u32 v4, v4, v2
  v_lshl_add_u32 v12, v2, 3, v4
  v_lshrrev_b32 v4, 1, v4
  v_lshl_add_u32 v2, v5, 8, v4
  v_add_u32 v218, s59, v2
  v_add_u32 v228, s60, v4
  v_lshlrev_b32 v5, 3, v5
  v_add_u32 v238, s60, v5
  v_add_u32 v4, 128, v1
  v_mul_u32_u24 v5, 3277, v4
  v_lshrrev_b32 v5, 16, v5
  v_lshlrev_b32 v4, 4, v4
  v_lshl_add_u32 v2, v5, 4, v4
  v_add_u32 v8, s44, v2
  v_mul_u32_u24 v2, 320, v5
  v_sub_u32 v4, v4, v2
  v_lshl_add_u32 v13, v2, 3, v4
  v_lshrrev_b32 v4, 1, v4
  v_lshl_add_u32 v2, v5, 8, v4
  v_add_u32 v220, s59, v2
  v_add_u32 v230, s60, v4
  v_lshlrev_b32 v5, 3, v5
  v_add_u32 v240, s60, v5
  v_add_u32 v4, 192, v1
  v_mul_u32_u24 v5, 3277, v4
  v_lshrrev_b32 v5, 16, v5
  v_lshlrev_b32 v4, 4, v4
  v_lshl_add_u32 v2, v5, 4, v4
  v_add_u32 v9, s44, v2
  v_mul_u32_u24 v2, 320, v5
  v_sub_u32 v4, v4, v2
  v_lshl_add_u32 v14, v2, 3, v4
  v_lshrrev_b32 v4, 1, v4
  v_lshl_add_u32 v2, v5, 8, v4
  v_add_u32 v222, s59, v2
  v_add_u32 v232, s60, v4
  v_lshlrev_b32 v5, 3, v5
  v_add_u32 v242, s60, v5
  v_add_u32 v4, 256, v1
  v_mul_u32_u24 v5, 3277, v4
  v_lshrrev_b32 v5, 16, v5
  v_lshlrev_b32 v4, 4, v4
  v_lshl_add_u32 v2, v5, 4, v4
  v_add_u32 v10, s44, v2
  v_mul_u32_u24 v2, 320, v5
  v_sub_u32 v4, v4, v2
  v_lshl_add_u32 v15, v2, 3, v4
  v_lshrrev_b32 v4, 1, v4
  v_lshl_add_u32 v2, v5, 8, v4
  v_add_u32 v224, s59, v2
  v_add_u32 v234, s60, v4
  v_lshlrev_b32 v5, 3, v5
  v_add_u32 v244, s60, v5
  buffer_load_dword v249, v248, s[20:23], s87 offen sc1
  s_waitcnt vmcnt(0)
  v_xor_b32 v39, s92, v249
  v_cmp_ne_u32 vcc, 0, v39
  s_nop 3
  s_cbranch_vccnz X_poll5_slow
X_poll5_ret:
  s_add_u32 s65, s67, 0
  buffer_load_dwordx4 a[220:223], v38, s[20:23], s65 offen offset:0 sc1
  buffer_load_dwordx4 a[224:227], v38, s[20:23], s65 offen offset:1024 sc1
  buffer_load_dwordx4 a[228:231], v38, s[20:23], s65 offen offset:2048 sc1
  buffer_load_dwordx4 a[232:235], v38, s[20:23], s65 offen offset:3072 sc1
  s_add_u32 s65, s67, 4096
  buffer_load_dwordx4 a[196:199], v38, s[20:23], s65 offen offset:0 sc1
  buffer_load_dwordx4 a[200:203], v38, s[20:23], s65 offen offset:1024 sc1
  buffer_load_dwordx4 a[204:207], v38, s[20:23], s65 offen offset:2048 sc1
  buffer_load_dwordx4 a[208:211], v38, s[20:23], s65 offen offset:3072 sc1
  s_add_u32 s65, s68, 0
  buffer_load_dwordx4 v[200:203], v38, s[20:23], s65 offen offset:0 sc1
  buffer_load_dwordx4 v[204:207], v38, s[20:23], s65 offen offset:1024 sc1
  buffer_load_dwordx4 v[208:211], v38, s[20:23], s65 offen offset:2048 sc1
  buffer_load_dwordx4 v[212:215], v38, s[20:23], s65 offen offset:3072 sc1
  s_waitcnt vmcnt(11)
  v_mfma_f32_16x16x32_bf16 v[120:123], a[0:3], a[220:223], 0
  s_add_u32 s65, s68, 4096
  buffer_load_dwordx4 v[18:21], v38, s[20:23], s65 offen offset:0 sc1
  v_mfma_f32_16x16x32_bf16 v[124:127], a[4:7], a[220:223], 0
  v_mfma_f32_16x16x32_bf16 v[128:131], a[8:11], a[220:223], 0
  v_mfma_f32_16x16x32_bf16 v[132:135], a[12:15], a[220:223], 0
  v_mfma_f32_16x16x32_bf16 v[136:139], a[16:19], a[220:223], 0
  buffer_load_dwordx4 v[22:25], v38, s[20:23], s65 offen offset:1024 sc1
  s_waitcnt vmcnt(12)
  v_mfma_f32_16x16x32_bf16 v[140:143], a[0:3], a[224:227], 0
  v_mfma_f32_16x16x32_bf16 v[144:147], a[4:7], a[224:227], 0
  v_mfma_f32_16x16x32_bf16 v[148:151], a[8:11], a[224:227], 0
  v_mfma_f32_16x16x32_bf16 v[152:155], a[12:15], a[224:227], 0
  buffer_load_dwordx4 v[26:29], v38, s[20:23], s65 offen offset:2048 sc1
  v_mfma_f32_16x16x32_bf16 v[156:159], a[16:19], a[224:227], 0
  s_waitcnt vmcnt(12)
  v_mfma_f32_16x16x32_bf16 v[160:163], a[0:3], a[228:231], 0
  v_mfma_f32_16x16x32_bf16 v[164:167], a[4:7], a[228:231], 0
  v_mfma_f32_16x16x32_bf16 v[168:171], a[8:11], a[228:231], 0
  buffer_load_dwordx4 v[30:33], v38, s[20:23], s65 offen offset:3072 sc1
  v_mfma_f32_16x16x32_bf16 v[172:175], a[12:15], a[228:231], 0
  v_mfma_f32_16x16x32_bf16 v[176:179], a[16:19], a[228:231], 0
  s_waitcnt vmcnt(12)
  v_mfma_f32_16x16x32_bf16 v[180:183], a[0:3], a[232:235], 0
  v_mfma_f32_16x16x32_bf16 v[184:187], a[4:7], a[232:235], 0
  v_mfma_f32_16x16x32_bf16 v[188:191], a[8:11], a[232:235], 0
  v_mfma_f32_16x16x32_bf16 v[192:195], a[12:15], a[232:235], 0
  v_mfma_f32_16x16x32_bf16 v[196:199], a[16:19], a[232:235], 0
  s_waitcnt vmcnt(11)
  v_mfma_f32_16x16x32_bf16 v[120:123], a[20:23], a[196:199], v[120:123]
  s_add_u32 s65, s67, 8192
  buffer_load_dwordx4 a[220:223], v38, s[20:23], s65 offen offset:0 sc1
  v_xor_b32 v39, s92, v255
  v_bitop3_b32 v39, v39, v254, s92 bitop3:0xf6
  v_cmp_ne_u32 vcc, 0, v39
  v_mfma_f32_16x16x32_bf16 v[124:127], a[24:27], a[196:199], v[124:127]
  s_nop 2
  s_cbranch_vccnz X_poll6_slow
X_poll6_ret:
  v_lshrrev_b32 v3, 1, v3
  v_add_u32 v3, s60, v3
  v_mfma_f32_16x16x32_bf16 v[128:131], a[28:31], a[196:199], v[128:131]
  ds_write_b64 v3, v[252:253] offset:4352
  ds_read_b64 v[216:217], v216
  ds_read_b64 v[226:227], v226 offset:4096
  v_mfma_f32_16x16x32_bf16 v[132:135], a[32:35], a[196:199], v[132:135]
  ds_read_b64 v[236:237], v236 offset:4352
  s_waitcnt lgkmcnt(10)
  ds_read_b64 v[218:219], v218
  ds_read_b64 v[228:229], v228 offset:4096
  v_mfma_f32_16x16x32_bf16 v[136:139], a[36:39], a[196:199], v[136:139]
  buffer_load_dwordx4 a[224:227], v38, s[20:23], s65 offen offset:1024 sc1
  ds_read_b64 v[238:239], v238 offset:4352
  ds_read_b64 v[220:221], v220
  ds_read_b64 v[230:231], v230 offset:4096
  s_waitcnt lgkmcnt(10)
  ds_read_b64 v[240:241], v240 offset:4352
  s_waitcnt vmcnt(12)
  v_mfma_f32_16x16x32_bf16 v[140:143], a[20:23], a[200:203], v[140:143]
  ds_read_b64 v[222:223], v222
  ds_read_b64 v[232:233], v232 offset:4096
  ds_read_b64 v[242:243], v242 offset:4352
  v_mfma_f32_16x16x32_bf16 v[144:147], a[24:27], a[200:203], v[144:147]
  ds_read_b64 v[224:225], v224
  s_waitcnt lgkmcnt(10)
  ds_read_b64 v[234:235], v234 offset:4096
  ds_read_b64 v[244:245], v244 offset:4352
  v_mfma_f32_16x16x32_bf16 v[148:151], a[28:31], a[200:203], v[148:151]
  v_lshlrev_b32 v2, 16, v216
  v_and_b32 v3, s52, v216
  v_lshlrev_b32 v4, 16, v217
  v_mfma_f32_16x16x32_bf16 v[152:155], a[32:35], a[200:203], v[152:155]
  buffer_load_dwordx4 a[228:231], v38, s[20:23], s65 offen offset:2048 sc1
  v_and_b32 v5, s52, v217
  v_lshlrev_b32 v246, 16, v226
  v_and_b32 v247, s52, v226
  v_mfma_f32_16x16x32_bf16 v[156:159], a[36:39], a[200:203], v[156:159]
  v_lshlrev_b32 v252, 16, v227
  v_and_b32 v253, s52, v227
  v_and_b32 v237, s52, v237
  v_mul_f32 v237, v237, v236
  s_waitcnt vmcnt(12)
  v_mfma_f32_16x16x32_bf16 v[160:163], a[20:23], a[204:207], v[160:163]
  v_fma_f32 v254, v2, v236, v237
  v_fma_f32 v255, v3, v236, v237
  v_fma_f32 v16, v4, v236, v237
  v_mfma_f32_16x16x32_bf16 v[164:167], a[24:27], a[204:207], v[164:167]
  v_fma_f32 v34, v5, v236, v237
  v_cvt_pk_bf16_f32 v254, v254, v255
  v_cvt_pk_bf16_f32 v16, v16, v34
  v_mfma_f32_16x16x32_bf16 v[168:171], a[28:31], a[204:207], v[168:171]
  buffer_load_dwordx4 a[232:235], v38, s[20:23], s65 offen offset:3072 sc1
  v_and_b32 v255, s52, v254
  v_lshlrev_b32 v254, 16, v254
  v_and_b32 v34, s52, v16
  v_mfma_f32_16x16x32_bf16 v[172:175], a[32:35], a[204:207], v[172:175]
  v_lshlrev_b32 v16, 16, v16
  v_mul_f32 v254, v254, v246
  v_mul_f32 v255, v255, v247
  v_mfma_f32_16x16x32_bf16 v[176:179], a[36:39], a[204:207], v[176:179]
  v_mul_f32 v16, v16, v252
  v_mul_f32 v34, v34, v253
  v_cvt_pk_bf16_f32 v254, v254, v255
  v_cvt_pk_bf16_f32 v16, v16, v34
  s_waitcnt vmcnt(12)
  v_mfma_f32_16x16x32_bf16 v[180:183], a[20:23], a[208:211], v[180:183]
  v_and_b32 v255, s52, v254
  v_lshlrev_b32 v254, 16, v254
  v_and_b32 v34, s52, v16
  v_mfma_f32_16x16x32_bf16 v[184:187], a[24:27], a[208:211], v[184:187]
  v_lshlrev_b32 v16, 16, v16
  v_add_f32 v216, v2, v254
  v_add_f32 v217, v3, v255
  v_mfma_f32_16x16x32_bf16 v[188:191], a[28:31], a[208:211], v[188:191]
  v_add_f32 v226, v4, v16
  v_add_f32 v227, v5, v34
  s_waitcnt lgkmcnt(11)
  v_lshlrev_b32 v2, 16, v218
  v_mfma_f32_16x16x32_bf16 v[192:195], a[32:35], a[208:211], v[192:195]
  v_and_b32 v3, s52, v218
  v_lshlrev_b32 v4, 16, v219
  v_and_b32 v5, s52, v219
  v_mfma_f32_16x16x32_bf16 v[196:199], a[36:39], a[208:211], v[196:199]
  s_waitcnt lgkmcnt(10)
  v_lshlrev_b32 v246, 16, v228
  v_and_b32 v247, s52, v228
  v_lshlrev_b32 v252, 16, v229
  v_and_b32 v253, s52, v229
  s_waitcnt vmcnt(11)
  v_mfma_f32_16x16x32_bf16 v[40:43], a[0:3], v[200:203], 0
  s_add_u32 s65, s68, 8192
  buffer_load_dwordx4 a[196:199], v38, s[20:23], s65 offen offset:0 sc1
  s_waitcnt lgkmcnt(9)
  v_and_b32 v239, s52, v239
  v_mul_f32 v239, v239, v238
  v_fma_f32 v254, v2, v238, v239
  v_mfma_f32_16x16x32_bf16 v[44:47], a[4:7], v[200:203], 0
  v_fma_f32 v255, v3, v238, v239
  v_fma_f32 v16, v4, v238, v239
  v_fma_f32 v34, v5, v238, v239
  v_mfma_f32_16x16x32_bf16 v[48:51], a[8:11], v[200:203], 0
  v_cvt_pk_bf16_f32 v254, v254, v255
  v_cvt_pk_bf16_f32 v16, v16, v34
  v_and_b32 v255, s52, v254
  v_mfma_f32_16x16x32_bf16 v[52:55], a[12:15], v[200:203], 0
  v_lshlrev_b32 v254, 16, v254
  v_and_b32 v34, s52, v16
  v_lshlrev_b32 v16, 16, v16
  v_mul_f32 v254, v254, v246
  v_mfma_f32_16x16x32_bf16 v[56:59], a[16:19], v[200:203], 0
  buffer_load_dwordx4 a[200:203], v38, s[20:23], s65 offen offset:1024 sc1
  v_mul_f32 v255, v255, v247
  v_mul_f32 v16, v16, v252
  v_mul_f32 v34, v34, v253
  s_waitcnt vmcnt(12)
  v_mfma_f32_16x16x32_bf16 v[60:63], a[0:3], v[204:207], 0
  v_cvt_pk_bf16_f32 v254, v254, v255
  v_cvt_pk_bf16_f32 v16, v16, v34
  v_and_b32 v255, s52, v254
  v_mfma_f32_16x16x32_bf16 v[64:67], a[4:7], v[204:207], 0
  v_lshlrev_b32 v254, 16, v254
  v_and_b32 v34, s52, v16
  v_lshlrev_b32 v16, 16, v16
  v_mfma_f32_16x16x32_bf16 v[68:71], a[8:11], v[204:207], 0
  v_add_f32 v218, v2, v254
  v_add_f32 v219, v3, v255
  v_add_f32 v228, v4, v16
  v_mfma_f32_16x16x32_bf16 v[72:75], a[12:15], v[204:207], 0
  buffer_load_dwordx4 a[204:207], v38, s[20:23], s65 offen offset:2048 sc1
  v_add_f32 v229, v5, v34
  s_waitcnt lgkmcnt(8)
  v_lshlrev_b32 v2, 16, v220
  v_and_b32 v3, s52, v220
  v_lshlrev_b32 v4, 16, v221
  v_mfma_f32_16x16x32_bf16 v[76:79], a[16:19], v[204:207], 0
  v_and_b32 v5, s52, v221
  s_waitcnt lgkmcnt(7)
  v_lshlrev_b32 v246, 16, v230
  v_and_b32 v247, s52, v230
  s_waitcnt vmcnt(12)
  v_mfma_f32_16x16x32_bf16 v[80:83], a[0:3], v[208:211], 0
  v_lshlrev_b32 v252, 16, v231
  v_and_b32 v253, s52, v231
  s_waitcnt lgkmcnt(6)
  v_and_b32 v241, s52, v241
  v_mfma_f32_16x16x32_bf16 v[84:87], a[4:7], v[208:211], 0
  v_mul_f32 v241, v241, v240
  v_fma_f32 v254, v2, v240, v241
  v_fma_f32 v255, v3, v240, v241
  v_mfma_f32_16x16x32_bf16 v[88:91], a[8:11], v[208:211], 0
  buffer_load_dwordx4 a[208:211], v38, s[20:23], s65 offen offset:3072 sc1
  v_fma_f32 v16, v4, v240, v241
  v_fma_f32 v34, v5, v240, v241
  v_cvt_pk_bf16_f32 v254, v254, v255
  v_mfma_f32_16x16x32_bf16 v[92:95], a[12:15], v[208:211], 0
  v_cvt_pk_bf16_f32 v16, v16, v34
  v_and_b32 v255, s52, v254
  v_lshlrev_b32 v254, 16, v254
  v_and_b32 v34, s52, v16
  v_mfma_f32_16x16x32_bf16 v[96:99], a[16:19], v[208:211], 0
  v_lshlrev_b32 v16, 16, v16
  v_mul_f32 v254, v254, v246
  v_mul_f32 v255, v255, v247
  s_waitcnt vmcnt(12)
  v_mfma_f32_16x16x32_bf16 v[100:103], a[0:3], v[212:215], 0
  v_mul_f32 v16, v16, v252
  v_mul_f32 v34, v34, v253
  v_cvt_pk_bf16_f32 v254, v254, v255
  v_mfma_f32_16x16x32_bf16 v[104:107], a[4:7], v[212:215], 0
  v_cvt_pk_bf16_f32 v16, v16, v34
  v_and_b32 v255, s52, v254
  v_lshlrev_b32 v254, 16, v254
  v_mfma_f32_16x16x32_bf16 v[108:111], a[8:11], v[212:215], 0
  v_and_b32 v34, s52, v16
  v_lshlrev_b32 v16, 16, v16
  v_add_f32 v220, v2, v254
  v_mfma_f32_16x16x32_bf16 v[112:115], a[12:15], v[212:215], 0
  v_add_f32 v221, v3, v255
  v_add_f32 v230, v4, v16
  v_add_f32 v231, v5, v34
  s_waitcnt lgkmcnt(5)
  v_lshlrev_b32 v2, 16, v222
  v_mfma_f32_16x16x32_bf16 v[116:119], a[16:19], v[212:215], 0
  v_and_b32 v3, s52, v222
  v_lshlrev_b32 v4, 16, v223
  v_and_b32 v5, s52, v223
  s_waitcnt vmcnt(11)
  v_mfma_f32_16x16x32_bf16 v[40:43], a[20:23], v[18:21], v[40:43]
  s_add_u32 s65, s68, 12288
  buffer_load_dwordx4 v[200:203], v38, s[20:23], s65 offen offset:0 sc1
  s_waitcnt lgkmcnt(4)
  v_lshlrev_b32 v246, 16, v232
  v_and_b32 v247, s52, v232
  v_lshlrev_b32 v252, 16, v233
  v_mfma_f32_16x16x32_bf16 v[44:47], a[24:27], v[18:21], v[44:47]
  v_and_b32 v253, s52, v233
  s_waitcnt lgkmcnt(3)
  v_and_b32 v243, s52, v243
  v_mul_f32 v243, v243, v242
  v_mfma_f32_16x16x32_bf16 v[48:51], a[28:31], v[18:21], v[48:51]
  v_fma_f32 v254, v2, v242, v243
  v_fma_f32 v255, v3, v242, v243
  v_fma_f32 v16, v4, v242, v243
  v_mfma_f32_16x16x32_bf16 v[52:55], a[32:35], v[18:21], v[52:55]
  v_fma_f32 v34, v5, v242, v243
  v_cvt_pk_bf16_f32 v254, v254, v255
  v_cvt_pk_bf16_f32 v16, v16, v34
  v_and_b32 v255, s52, v254
  v_mfma_f32_16x16x32_bf16 v[56:59], a[36:39], v[18:21], v[56:59]
  buffer_load_dwordx4 v[204:207], v38, s[20:23], s65 offen offset:1024 sc1
  v_lshlrev_b32 v254, 16, v254
  v_and_b32 v34, s52, v16
  v_lshlrev_b32 v16, 16, v16
  s_waitcnt vmcnt(12)
  v_mfma_f32_16x16x32_bf16 v[60:63], a[20:23], v[22:25], v[60:63]
  v_mul_f32 v254, v254, v246
  v_mul_f32 v255, v255, v247
  v_mul_f32 v16, v16, v252
  v_mfma_f32_16x16x32_bf16 v[64:67], a[24:27], v[22:25], v[64:67]
  v_mul_f32 v34, v34, v253
  v_cvt_pk_bf16_f32 v254, v254, v255
  v_cvt_pk_bf16_f32 v16, v16, v34
  v_mfma_f32_16x16x32_bf16 v[68:71], a[28:31], v[22:25], v[68:71]
  v_and_b32 v255, s52, v254
  v_lshlrev_b32 v254, 16, v254
  v_and_b32 v34, s52, v16
  v_lshlrev_b32 v16, 16, v16
  v_mfma_f32_16x16x32_bf16 v[72:75], a[32:35], v[22:25], v[72:75]
  buffer_load_dwordx4 v[208:211], v38, s[20:23], s65 offen offset:2048 sc1
  v_add_f32 v222, v2, v254
  v_add_f32 v223, v3, v255
  v_add_f32 v232, v4, v16
  v_mfma_f32_16x16x32_bf16 v[76:79], a[36:39], v[22:25], v[76:79]
  v_add_f32 v233, v5, v34
  s_waitcnt lgkmcnt(2)
  v_lshlrev_b32 v2, 16, v224
  v_and_b32 v3, s52, v224
  s_waitcnt vmcnt(12)
  v_mfma_f32_16x16x32_bf16 v[80:83], a[20:23], v[26:29], v[80:83]
  buffer_load_dword v250, v248, s[20:23], s87 offen offset:128 sc1
  v_lshlrev_b32 v4, 16, v225
  v_and_b32 v5, s52, v225
  s_waitcnt lgkmcnt(1)
  v_lshlrev_b32 v246, 16, v234
  v_mfma_f32_16x16x32_bf16 v[84:87], a[24:27], v[26:29], v[84:87]
  v_and_b32 v247, s52, v234
  v_lshlrev_b32 v252, 16, v235
  v_and_b32 v253, s52, v235
  v_mfma_f32_16x16x32_bf16 v[88:91], a[28:31], v[26:29], v[88:91]
  buffer_load_dwordx4 v[212:215], v38, s[20:23], s65 offen offset:3072 sc1
  s_waitcnt lgkmcnt(0)
  v_and_b32 v245, s52, v245
  v_mul_f32 v245, v245, v244
  v_fma_f32 v254, v2, v244, v245
  v_fma_f32 v255, v3, v244, v245
  v_mfma_f32_16x16x32_bf16 v[92:95], a[32:35], v[26:29], v[92:95]
  v_fma_f32 v16, v4, v244, v245
  v_fma_f32 v34, v5, v244, v245
  v_cvt_pk_bf16_f32 v254, v254, v255
  v_mfma_f32_16x16x32_bf16 v[96:99], a[36:39], v[26:29], v[96:99]
  v_cvt_pk_bf16_f32 v16, v16, v34
  v_and_b32 v255, s52, v254
  v_lshlrev_b32 v254, 16, v254
  s_waitcnt vmcnt(13)
  v_mfma_f32_16x16x32_bf16 v[100:103], a[20:23], v[30:33], v[100:103]
  v_and_b32 v34, s52, v16
  v_lshlrev_b32 v16, 16, v16
  v_mul_f32 v254, v254, v246
  v_mfma_f32_16x16x32_bf16 v[104:107], a[24:27], v[30:33], v[104:107]
  v_mul_f32 v255, v255, v247
  v_mul_f32 v16, v16, v252
  v_mul_f32 v34, v34, v253
  v_mfma_f32_16x16x32_bf16 v[108:111], a[28:31], v[30:33], v[108:111]
  v_cvt_pk_bf16_f32 v254, v254, v255
  v_cvt_pk_bf16_f32 v16, v16, v34
  v_and_b32 v255, s52, v254
  v_lshlrev_b32 v254, 16, v254
  v_mfma_f32_16x16x32_bf16 v[112:115], a[32:35], v[30:33], v[112:115]
  v_and_b32 v34, s52, v16
  v_lshlrev_b32 v16, 16, v16
  v_add_f32 v224, v2, v254
  v_mfma_f32_16x16x32_bf16 v[116:119], a[36:39], v[30:33], v[116:119]
  v_add_f32 v225, v3, v255
  v_add_f32 v234, v4, v16
  v_add_f32 v235, v5, v34
  s_waitcnt vmcnt(1)
  v_xor_b32 v39, s92, v250
  v_cmp_ne_u32 vcc, 0, v39
  s_nop 3
  s_cbranch_vccnz X_poll7_slow
X_poll7_ret:
  v_mfma_f32_16x16x32_bf16 v[120:123], a[40:43], a[220:223], v[120:123]
  s_add_u32 s65, s68, 16384
  buffer_load_dwordx4 a[0:3], v38, s[20:23], s65 offen offset:0 sc1
  v_mfma_f32_16x16x32_bf16 v[124:127], a[44:47], a[220:223], v[124:127]
  v_mfma_f32_16x16x32_bf16 v[128:131], a[48:51], a[220:223], v[128:131]
  v_mfma_f32_16x16x32_bf16 v[132:135], a[52:55], a[220:223], v[132:135]
  v_mfma_f32_16x16x32_bf16 v[136:139], a[56:59], a[220:223], v[136:139]
  buffer_load_dwordx4 a[4:7], v38, s[20:23], s65 offen offset:1024 sc1
  v_mfma_f32_16x16x32_bf16 v[140:143], a[40:43], a[224:227], v[140:143]
  v_mfma_f32_16x16x32_bf16 v[144:147], a[44:47], a[224:227], v[144:147]
  v_mfma_f32_16x16x32_bf16 v[148:151], a[48:51], a[224:227], v[148:151]
  v_mfma_f32_16x16x32_bf16 v[152:155], a[52:55], a[224:227], v[152:155]
  buffer_load_dwordx4 a[8:11], v38, s[20:23], s65 offen offset:2048 sc1
  v_mfma_f32_16x16x32_bf16 v[156:159], a[56:59], a[224:227], v[156:159]
  v_mfma_f32_16x16x32_bf16 v[160:163], a[40:43], a[228:231], v[160:163]
  v_mfma_f32_16x16x32_bf16 v[164:167], a[44:47], a[228:231], v[164:167]
  v_mfma_f32_16x16x32_bf16 v[168:171], a[48:51], a[228:231], v[168:171]
  buffer_load_dwordx4 a[12:15], v38, s[20:23], s65 offen offset:3072 sc1
  v_mfma_f32_16x16x32_bf16 v[172:175], a[52:55], a[228:231], v[172:175]
  v_mfma_f32_16x16x32_bf16 v[176:179], a[56:59], a[228:231], v[176:179]
  v_mfma_f32_16x16x32_bf16 v[180:183], a[40:43], a[232:235], v[180:183]
  v_mfma_f32_16x16x32_bf16 v[184:187], a[44:47], a[232:235], v[184:187]
  s_add_u32 s65, s68, 20480
  buffer_load_dwordx4 v[18:21], v38, s[20:23], s65 offen offset:0 sc1
  v_mfma_f32_16x16x32_bf16 v[188:191], a[48:51], a[232:235], v[188:191]
  v_mfma_f32_16x16x32_bf16 v[192:195], a[52:55], a[232:235], v[192:195]
  v_mfma_f32_16x16x32_bf16 v[196:199], a[56:59], a[232:235], v[196:199]
  v_mfma_f32_16x16x32_bf16 v[40:43], a[40:43], a[196:199], v[40:43]
  buffer_load_dwordx4 v[22:25], v38, s[20:23], s65 offen offset:1024 sc1
  v_mfma_f32_16x16x32_bf16 v[44:47], a[44:47], a[196:199], v[44:47]
  v_mfma_f32_16x16x32_bf16 v[48:51], a[48:51], a[196:199], v[48:51]
  v_mfma_f32_16x16x32_bf16 v[52:55], a[52:55], a[196:199], v[52:55]
  v_mfma_f32_16x16x32_bf16 v[56:59], a[56:59], a[196:199], v[56:59]
  buffer_load_dwordx4 v[26:29], v38, s[20:23], s65 offen offset:2048 sc1
  v_mfma_f32_16x16x32_bf16 v[60:63], a[40:43], a[200:203], v[60:63]
  v_mfma_f32_16x16x32_bf16 v[64:67], a[44:47], a[200:203], v[64:67]
  v_mfma_f32_16x16x32_bf16 v[68:71], a[48:51], a[200:203], v[68:71]
  v_mfma_f32_16x16x32_bf16 v[72:75], a[52:55], a[200:203], v[72:75]
  buffer_load_dwordx4 v[30:33], v38, s[20:23], s65 offen offset:3072 sc1
  v_mfma_f32_16x16x32_bf16 v[76:79], a[56:59], a[200:203], v[76:79]
  v_mfma_f32_16x16x32_bf16 v[80:83], a[40:43], a[204:207], v[80:83]
  v_mfma_f32_16x16x32_bf16 v[84:87], a[44:47], a[204:207], v[84:87]
  v_mfma_f32_16x16x32_bf16 v[88:91], a[48:51], a[204:207], v[88:91]
  s_add_u32 s65, s68, 24576
  buffer_load_dwordx4 a[16:19], v38, s[20:23], s65 offen offset:0 sc1
  v_mfma_f32_16x16x32_bf16 v[92:95], a[52:55], a[204:207], v[92:95]
  v_mfma_f32_16x16x32_bf16 v[96:99], a[56:59], a[204:207], v[96:99]
  v_mfma_f32_16x16x32_bf16 v[100:103], a[40:43], a[208:211], v[100:103]
  v_mfma_f32_16x16x32_bf16 v[104:107], a[44:47], a[208:211], v[104:107]
  buffer_load_dwordx4 a[20:23], v38, s[20:23], s65 offen offset:1024 sc1
  v_mfma_f32_16x16x32_bf16 v[108:111], a[48:51], a[208:211], v[108:111]
  v_mfma_f32_16x16x32_bf16 v[112:115], a[52:55], a[208:211], v[112:115]
  v_mfma_f32_16x16x32_bf16 v[116:119], a[56:59], a[208:211], v[116:119]
  s_getpc_b64 s[90:91]
X_cp2:
  v_lshlrev_b32 v4, 7, v0
  v_min_u32 v4, X_end-X_cp2, v4
  global_load_dword v250, v4, s[90:91]
  v_mfma_f32_16x16x32_bf16 v[40:43], a[60:63], v[200:203], v[40:43]
  buffer_load_dwordx4 a[24:27], v38, s[20:23], s65 offen offset:2048 sc1
  v_mfma_f32_16x16x32_bf16 v[44:47], a[64:67], v[200:203], v[44:47]
  v_mfma_f32_16x16x32_bf16 v[48:51], a[68:71], v[200:203], v[48:51]
  v_mfma_f32_16x16x32_bf16 v[52:55], a[72:75], v[200:203], v[52:55]
  v_mfma_f32_16x16x32_bf16 v[56:59], a[76:79], v[200:203], v[56:59]
  buffer_load_dwordx4 a[28:31], v38, s[20:23], s65 offen offset:3072 sc1
  v_mfma_f32_16x16x32_bf16 v[60:63], a[60:63], v[204:207], v[60:63]
  v_mfma_f32_16x16x32_bf16 v[64:67], a[64:67], v[204:207], v[64:67]
  v_mfma_f32_16x16x32_bf16 v[68:71], a[68:71], v[204:207], v[68:71]
  v_mfma_f32_16x16x32_bf16 v[72:75], a[72:75], v[204:207], v[72:75]
  s_add_u32 s65, s68, 28672
  buffer_load_dwordx4 a[220:223], v38, s[20:23], s65 offen offset:0 sc1
  v_mfma_f32_16x16x32_bf16 v[76:79], a[76:79], v[204:207], v[76:79]
  v_mfma_f32_16x16x32_bf16 v[80:83], a[60:63], v[208:211], v[80:83]
  v_mfma_f32_16x16x32_bf16 v[84:87], a[64:67], v[208:211], v[84:87]
  v_mfma_f32_16x16x32_bf16 v[88:91], a[68:71], v[208:211], v[88:91]
  buffer_load_dwordx4 a[224:227], v38, s[20:23], s65 offen offset:1024 sc1
  v_mfma_f32_16x16x32_bf16 v[92:95], a[72:75], v[208:211], v[92:95]
  v_mfma_f32_16x16x32_bf16 v[96:99], a[76:79], v[208:211], v[96:99]
  s_waitcnt vmcnt(15)
  v_mfma_f32_16x16x32_bf16 v[100:103], a[60:63], v[212:215], v[100:103]
  v_mfma_f32_16x16x32_bf16 v[104:107], a[64:67], v[212:215], v[104:107]
  buffer_load_dwordx4 a[228:231], v38, s[20:23], s65 offen offset:2048 sc1
  v_mfma_f32_16x16x32_bf16 v[108:111], a[68:71], v[212:215], v[108:111]
  v_mfma_f32_16x16x32_bf16 v[112:115], a[72:75], v[212:215], v[112:115]
  v_mfma_f32_16x16x32_bf16 v[116:119], a[76:79], v[212:215], v[116:119]
  s_waitcnt vmcnt(15)
  v_mfma_f32_16x16x32_bf16 v[40:43], a[80:83], a[0:3], v[40:43]
  buffer_load_dwordx4 a[232:235], v38, s[20:23], s65 offen offset:3072 sc1
  v_mfma_f32_16x16x32_bf16 v[44:47], a[84:87], a[0:3], v[44:47]
  v_mfma_f32_16x16x32_bf16 v[48:51], a[88:91], a[0:3], v[48:51]
  v_mfma_f32_16x16x32_bf16 v[52:55], a[92:95], a[0:3], v[52:55]
  v_mfma_f32_16x16x32_bf16 v[56:59], a[96:99], a[0:3], v[56:59]
  s_add_u32 s65, s68, 32768
  buffer_load_dwordx4 a[196:199], v38, s[20:23], s65 offen offset:0 sc1
  s_waitcnt vmcnt(16)
  v_mfma_f32_16x16x32_bf16 v[60:63], a[80:83], a[4:7], v[60:63]
  v_mfma_f32_16x16x32_bf16 v[64:67], a[84:87], a[4:7], v[64:67]
  v_mfma_f32_16x16x32_bf16 v[68:71], a[88:91], a[4:7], v[68:71]
  v_mfma_f32_16x16x32_bf16 v[72:75], a[92:95], a[4:7], v[72:75]
  buffer_load_dwordx4 a[200:203], v38, s[20:23], s65 offen offset:1024 sc1
  v_mfma_f32_16x16x32_bf16 v[76:79], a[96:99], a[4:7], v[76:79]
  s_waitcnt vmcnt(16)
  v_mfma_f32_16x16x32_bf16 v[80:83], a[80:83], a[8:11], v[80:83]
  v_mfma_f32_16x16x32_bf16 v[84:87], a[84:87], a[8:11], v[84:87]
  v_mfma_f32_16x16x32_bf16 v[88:91], a[88:91], a[8:11], v[88:91]
  buffer_load_dwordx4 a[204:207], v38, s[20:23], s65 offen offset:2048 sc1
  v_mfma_f32_16x16x32_bf16 v[92:95], a[92:95], a[8:11], v[92:95]
  v_mfma_f32_16x16x32_bf16 v[96:99], a[96:99], a[8:11], v[96:99]
  s_waitcnt vmcnt(16)
  v_mfma_f32_16x16x32_bf16 v[100:103], a[80:83], a[12:15], v[100:103]
  v_mfma_f32_16x16x32_bf16 v[104:107], a[84:87], a[12:15], v[104:107]
  buffer_load_dwordx4 a[208:211], v38, s[20:23], s65 offen offset:3072 sc1
  v_mfma_f32_16x16x32_bf16 v[108:111], a[88:91], a[12:15], v[108:111]
  v_mfma_f32_16x16x32_bf16 v[112:115], a[92:95], a[12:15], v[112:115]
  v_mfma_f32_16x16x32_bf16 v[116:119], a[96:99], a[12:15], v[116:119]
  s_waitcnt vmcnt(16)
  v_mfma_f32_16x16x32_bf16 v[40:43], a[100:103], v[18:21], v[40:43]
  s_add_u32 s65, s68, 36864
  buffer_load_dwordx4 a[32:35], v38, s[20:23], s65 offen offset:0 sc1
  v_mfma_f32_16x16x32_bf16 v[44:47], a[104:107], v[18:21], v[44:47]
  v_mfma_f32_16x16x32_bf16 v[48:51], a[108:111], v[18:21], v[48:51]
  v_mfma_f32_16x16x32_bf16 v[52:55], a[176:179], v[18:21], v[52:55]
  v_mfma_f32_16x16x32_bf16 v[56:59], a[212:215], v[18:21], v[56:59]
  buffer_load_dwordx4 a[36:39], v38, s[20:23], s65 offen offset:1024 sc1
  s_waitcnt vmcnt(17)
  v_mfma_f32_16x16x32_bf16 v[60:63], a[100:103], v[22:25], v[60:63]
  v_mfma_f32_16x16x32_bf16 v[64:67], a[104:107], v[22:25], v[64:67]
  v_mfma_f32_16x16x32_bf16 v[68:71], a[108:111], v[22:25], v[68:71]
  v_mfma_f32_16x16x32_bf16 v[72:75], a[176:179], v[22:25], v[72:75]
  buffer_load_dwordx4 a[40:43], v38, s[20:23], s65 offen offset:2048 sc1
  v_mfma_f32_16x16x32_bf16 v[76:79], a[212:215], v[22:25], v[76:79]
  s_waitcnt vmcnt(17)
  v_mfma_f32_16x16x32_bf16 v[80:83], a[100:103], v[26:29], v[80:83]
  v_mfma_f32_16x16x32_bf16 v[84:87], a[104:107], v[26:29], v[84:87]
  v_mfma_f32_16x16x32_bf16 v[88:91], a[108:111], v[26:29], v[88:91]
  buffer_load_dwordx4 a[44:47], v38, s[20:23], s65 offen offset:3072 sc1
  v_mfma_f32_16x16x32_bf16 v[92:95], a[176:179], v[26:29], v[92:95]
  v_mfma_f32_16x16x32_bf16 v[96:99], a[212:215], v[26:29], v[96:99]
  s_waitcnt vmcnt(17)
  v_mfma_f32_16x16x32_bf16 v[100:103], a[100:103], v[30:33], v[100:103]
  v_mfma_f32_16x16x32_bf16 v[104:107], a[104:107], v[30:33], v[104:107]
  s_add_u32 s65, s68, 40960
  buffer_load_dwordx4 v[200:203], v38, s[20:23], s65 offen offset:0 sc1
  v_mfma_f32_16x16x32_bf16 v[108:111], a[108:111], v[30:33], v[108:111]
  v_mfma_f32_16x16x32_bf16 v[112:115], a[176:179], v[30:33], v[112:115]
  v_mfma_f32_16x16x32_bf16 v[116:119], a[212:215], v[30:33], v[116:119]
  s_waitcnt vmcnt(17)
  v_mfma_f32_16x16x32_bf16 v[40:43], a[216:219], a[16:19], v[40:43]
  buffer_load_dwordx4 v[204:207], v38, s[20:23], s65 offen offset:1024 sc1
  v_mfma_f32_16x16x32_bf16 v[44:47], a[240:243], a[16:19], v[44:47]
  v_mfma_f32_16x16x32_bf16 v[48:51], a[244:247], a[16:19], v[48:51]
  v_mfma_f32_16x16x32_bf16 v[52:55], a[248:251], a[16:19], v[52:55]
  v_mfma_f32_16x16x32_bf16 v[56:59], a[252:255], a[16:19], v[56:59]
  buffer_load_dwordx4 v[208:211], v38, s[20:23], s65 offen offset:2048 sc1
  s_waitcnt vmcnt(18)
  v_mfma_f32_16x16x32_bf16 v[60:63], a[216:219], a[20:23], v[60:63]
  v_mfma_f32_16x16x32_bf16 v[64:67], a[240:243], a[20:23], v[64:67]
  v_mfma_f32_16x16x32_bf16 v[68:71], a[244:247], a[20:23], v[68:71]
  v_mfma_f32_16x16x32_bf16 v[72:75], a[248:251], a[20:23], v[72:75]
  buffer_load_dwordx4 v[212:215], v38, s[20:23], s65 offen offset:3072 sc1
  v_mfma_f32_16x16x32_bf16 v[76:79], a[252:255], a[20:23], v[76:79]
  s_waitcnt vmcnt(17)
  v_mfma_f32_16x16x32_bf16 v[80:83], a[216:219], a[24:27], v[80:83]
  v_mfma_f32_16x16x32_bf16 v[84:87], a[240:243], a[24:27], v[84:87]
  v_mfma_f32_16x16x32_bf16 v[88:91], a[244:247], a[24:27], v[88:91]
  s_add_u32 s65, s67, 12288
  buffer_load_dwordx4 a[0:3], v38, s[20:23], s65 offen offset:0 sc1
  v_mfma_f32_16x16x32_bf16 v[92:95], a[248:251], a[24:27], v[92:95]
  v_mfma_f32_16x16x32_bf16 v[96:99], a[252:255], a[24:27], v[96:99]
  s_waitcnt vmcnt(17)
  v_mfma_f32_16x16x32_bf16 v[100:103], a[216:219], a[28:31], v[100:103]
  v_mfma_f32_16x16x32_bf16 v[104:107], a[240:243], a[28:31], v[104:107]
  buffer_load_dwordx4 a[4:7], v38, s[20:23], s65 offen offset:1024 sc1
  v_mfma_f32_16x16x32_bf16 v[108:111], a[244:247], a[28:31], v[108:111]
  v_mfma_f32_16x16x32_bf16 v[112:115], a[248:251], a[28:31], v[112:115]
  v_mfma_f32_16x16x32_bf16 v[116:119], a[252:255], a[28:31], v[116:119]
  s_waitcnt vmcnt(17)
  v_mfma_f32_16x16x32_bf16 v[40:43], a[112:115], a[220:223], v[40:43]
  buffer_load_dwordx4 a[8:11], v38, s[20:23], s65 offen offset:2048 sc1
  v_mfma_f32_16x16x32_bf16 v[44:47], a[116:119], a[220:223], v[44:47]
  v_mfma_f32_16x16x32_bf16 v[48:51], a[120:123], a[220:223], v[48:51]
  v_mfma_f32_16x16x32_bf16 v[52:55], a[124:127], a[220:223], v[52:55]
  v_mfma_f32_16x16x32_bf16 v[56:59], a[128:131], a[220:223], v[56:59]
  buffer_load_dwordx4 a[12:15], v38, s[20:23], s65 offen offset:3072 sc1
  s_waitcnt vmcnt(18)
  v_mfma_f32_16x16x32_bf16 v[60:63], a[112:115], a[224:227], v[60:63]
  v_mfma_f32_16x16x32_bf16 v[64:67], a[116:119], a[224:227], v[64:67]
  v_mfma_f32_16x16x32_bf16 v[68:71], a[120:123], a[224:227], v[68:71]
  v_mfma_f32_16x16x32_bf16 v[72:75], a[124:127], a[224:227], v[72:75]
  s_add_u32 s65, s67, 16384
  buffer_load_dwordx4 v[18:21], v38, s[20:23], s65 offen offset:0 sc1
  v_mfma_f32_16x16x32_bf16 v[76:79], a[128:131], a[224:227], v[76:79]
  s_waitcnt vmcnt(18)
  v_mfma_f32_16x16x32_bf16 v[80:83], a[112:115], a[228:231], v[80:83]
  v_mfma_f32_16x16x32_bf16 v[84:87], a[116:119], a[228:231], v[84:87]
  v_mfma_f32_16x16x32_bf16 v[88:91], a[120:123], a[228:231], v[88:91]
  buffer_load_dwordx4 v[22:25], v38, s[20:23], s65 offen offset:1024 sc1
  v_mfma_f32_16x16x32_bf16 v[92:95], a[124:127], a[228:231], v[92:95]
  v_mfma_f32_16x16x32_bf16 v[96:99], a[128:131], a[228:231], v[96:99]
  s_waitcnt vmcnt(18)
  v_mfma_f32_16x16x32_bf16 v[100:103], a[112:115], a[232:235], v[100:103]
  v_mfma_f32_16x16x32_bf16 v[104:107], a[116:119], a[232:235], v[104:107]
  buffer_load_dwordx4 v[26:29], v38, s[20:23], s65 offen offset:2048 sc1
  v_mfma_f32_16x16x32_bf16 v[108:111], a[120:123], a[232:235], v[108:111]
  v_mfma_f32_16x16x32_bf16 v[112:115], a[124:127], a[232:235], v[112:115]
  v_mfma_f32_16x16x32_bf16 v[116:119], a[128:131], a[232:235], v[116:119]
  s_waitcnt vmcnt(18)
  v_mfma_f32_16x16x32_bf16 v[40:43], a[132:135], a[196:199], v[40:43]
  buffer_load_dwordx4 v[30:33], v38, s[20:23], s65 offen offset:3072 sc1
  v_mfma_f32_16x16x32_bf16 v[44:47], a[136:139], a[196:199], v[44:47]
  v_mfma_f32_16x16x32_bf16 v[48:51], a[140:143], a[196:199], v[48:51]
  v_mfma_f32_16x16x32_bf16 v[52:55], a[144:147], a[196:199], v[52:55]
  v_mfma_f32_16x16x32_bf16 v[56:59], a[148:151], a[196:199], v[56:59]
  s_add_u32 s65, s67, 20480
  buffer_load_dwordx4 a[16:19], v38, s[20:23], s65 offen offset:0 sc1
  s_waitcnt vmcnt(19)
  v_mfma_f32_16x16x32_bf16 v[60:63], a[132:135], a[200:203], v[60:63]
  v_mfma_f32_16x16x32_bf16 v[64:67], a[136:139], a[200:203], v[64:67]
  v_mfma_f32_16x16x32_bf16 v[68:71], a[140:143], a[200:203], v[68:71]
  v_mfma_f32_16x16x32_bf16 v[72:75], a[144:147], a[200:203], v[72:75]
  buffer_load_dwordx4 a[20:23], v38, s[20:23], s65 offen offset:1024 sc1
  v_mfma_f32_16x16x32_bf16 v[76:79], a[148:151], a[200:203], v[76:79]
  s_waitcnt vmcnt(19)
  v_mfma_f32_16x16x32_bf16 v[80:83], a[132:135], a[204:207], v[80:83]
  v_mfma_f32_16x16x32_bf16 v[84:87], a[136:139], a[204:207], v[84:87]
  v_mfma_f32_16x16x32_bf16 v[88:91], a[140:143], a[204:207], v[88:91]
  buffer_load_dwordx4 a[24:27], v38, s[20:23], s65 offen offset:2048 sc1
  v_mfma_f32_16x16x32_bf16 v[92:95], a[144:147], a[204:207], v[92:95]
  v_mfma_f32_16x16x32_bf16 v[96:99], a[148:151], a[204:207], v[96:99]
  s_waitcnt vmcnt(19)
  v_mfma_f32_16x16x32_bf16 v[100:103], a[132:135], a[208:211], v[100:103]
  v_mfma_f32_16x16x32_bf16 v[104:107], a[136:139], a[208:211], v[104:107]
  buffer_load_dwordx4 a[28:31], v38, s[20:23], s65 offen offset:3072 sc1
  v_mfma_f32_16x16x32_bf16 v[108:111], a[140:143], a[208:211], v[108:111]
  v_mfma_f32_16x16x32_bf16 v[112:115], a[144:147], a[208:211], v[112:115]
  v_mfma_f32_16x16x32_bf16 v[116:119], a[148:151], a[208:211], v[116:119]
  s_waitcnt vmcnt(19)
  v_mfma_f32_16x16x32_bf16 v[40:43], a[152:155], a[32:35], v[40:43]
  s_add_u32 s65, s67, 24576
  buffer_load_dwordx4 a[220:223], v38, s[20:23], s65 offen offset:0 sc1
  v_mfma_f32_16x16x32_bf16 v[44:47], a[156:159], a[32:35], v[44:47]
  v_mfma_f32_16x16x32_bf16 v[48:51], a[160:163], a[32:35], v[48:51]
  v_mfma_f32_16x16x32_bf16 v[52:55], a[164:167], a[32:35], v[52:55]
  v_mfma_f32_16x16x32_bf16 v[56:59], a[168:171], a[32:35], v[56:59]
  buffer_load_dwordx4 a[224:227], v38, s[20:23], s65 offen offset:1024 sc1
  s_waitcnt vmcnt(17)
  v_mfma_f32_16x16x32_bf16 v[40:43], a[172:175], v[200:203], v[40:43]
  v_mfma_f32_16x16x32_bf16 v[44:47], a[180:183], v[200:203], v[44:47]
  v_mfma_f32_16x16x32_bf16 v[48:51], a[184:187], v[200:203], v[48:51]
  v_mfma_f32_16x16x32_bf16 v[52:55], a[188:191], v[200:203], v[52:55]
  buffer_load_dwordx4 a[228:231], v38, s[20:23], s65 offen offset:2048 sc1
  v_mfma_f32_16x16x32_bf16 v[56:59], a[192:195], v[200:203], v[56:59]
  v_mfma_f32_16x16x32_bf16 v[60:63], a[152:155], a[36:39], v[60:63]
  v_mfma_f32_16x16x32_bf16 v[64:67], a[156:159], a[36:39], v[64:67]
  v_mfma_f32_16x16x32_bf16 v[68:71], a[160:163], a[36:39], v[68:71]
  buffer_load_dwordx4 a[232:235], v38, s[20:23], s65 offen offset:3072 sc1
  v_mfma_f32_16x16x32_bf16 v[72:75], a[164:167], a[36:39], v[72:75]
  ds_write_b128 v36, v[40:43] offset:0
  v_mfma_f32_16x16x32_bf16 v[76:79], a[168:171], a[36:39], v[76:79]
  ds_write_b128 v36, v[44:47] offset:64
  s_waitcnt vmcnt(18)
  v_mfma_f32_16x16x32_bf16 v[60:63], a[172:175], v[204:207], v[60:63]
  ds_write_b128 v36, v[48:51] offset:128
  v_mfma_f32_16x16x32_bf16 v[64:67], a[180:183], v[204:207], v[64:67]
  s_add_u32 s65, s67, 28672
  buffer_load_dwordx4 a[196:199], v38, s[20:23], s65 offen offset:0 sc1
  ds_write_b128 v36, v[52:55] offset:192
  v_mfma_f32_16x16x32_bf16 v[68:71], a[184:187], v[204:207], v[68:71]
  ds_write_b128 v36, v[56:59] offset:256
  v_mfma_f32_16x16x32_bf16 v[72:75], a[188:191], v[204:207], v[72:75]
  v_mfma_f32_16x16x32_bf16 v[76:79], a[192:195], v[204:207], v[76:79]
  v_mfma_f32_16x16x32_bf16 v[80:83], a[152:155], a[40:43], v[80:83]
  buffer_load_dwordx4 a[200:203], v38, s[20:23], s65 offen offset:1024 sc1
  v_mfma_f32_16x16x32_bf16 v[84:87], a[156:159], a[40:43], v[84:87]
  v_mfma_f32_16x16x32_bf16 v[88:91], a[160:163], a[40:43], v[88:91]
  v_mfma_f32_16x16x32_bf16 v[92:95], a[164:167], a[40:43], v[92:95]
  ds_write_b128 v36, v[60:63] offset:5376
  v_mfma_f32_16x16x32_bf16 v[96:99], a[168:171], a[40:43], v[96:99]
  buffer_load_dwordx4 a[204:207], v38, s[20:23], s65 offen offset:2048 sc1
  ds_write_b128 v36, v[64:67] offset:5440
  s_waitcnt vmcnt(20)
  v_mfma_f32_16x16x32_bf16 v[80:83], a[172:175], v[208:211], v[80:83]
  ds_write_b128 v36, v[68:71] offset:5504
  v_mfma_f32_16x16x32_bf16 v[84:87], a[180:183], v[208:211], v[84:87]
  ds_write_b128 v36, v[72:75] offset:5568
  v_mfma_f32_16x16x32_bf16 v[88:91], a[184:187], v[208:211], v[88:91]
  ds_write_b128 v36, v[76:79] offset:5632
  v_mfma_f32_16x16x32_bf16 v[92:95], a[188:191], v[208:211], v[92:95]
  buffer_load_dwordx4 a[208:211], v38, s[20:23], s65 offen offset:3072 sc1
  v_mfma_f32_16x16x32_bf16 v[96:99], a[192:195], v[208:211], v[96:99]
  v_mfma_f32_16x16x32_bf16 v[100:103], a[152:155], a[44:47], v[100:103]
  v_mfma_f32_16x16x32_bf16 v[104:107], a[156:159], a[44:47], v[104:107]
  v_mfma_f32_16x16x32_bf16 v[108:111], a[160:163], a[44:47], v[108:111]
  v_mfma_f32_16x16x32_bf16 v[112:115], a[164:167], a[44:47], v[112:115]
  ds_write_b128 v36, v[80:83] offset:10752
  v_mfma_f32_16x16x32_bf16 v[116:119], a[168:171], a[44:47], v[116:119]
  ds_write_b128 v36, v[84:87] offset:10816
  s_waitcnt vmcnt(20)
  v_mfma_f32_16x16x32_bf16 v[100:103], a[172:175], v[212:215], v[100:103]
  ds_write_b128 v36, v[88:91] offset:10880
  v_mfma_f32_16x16x32_bf16 v[104:107], a[180:183], v[212:215], v[104:107]
  ds_write_b128 v36, v[92:95] offset:10944
  v_mfma_f32_16x16x32_bf16 v[108:111], a[184:187], v[212:215], v[108:111]
  ds_write_b128 v36, v[96:99] offset:11008
  v_mfma_f32_16x16x32_bf16 v[112:115], a[188:191], v[212:215], v[112:115]
  v_mfma_f32_16x16x32_bf16 v[116:119], a[192:195], v[212:215], v[116:119]
  s_waitcnt vmcnt(19)
  v_mfma_f32_16x16x32_bf16 v[120:123], a[60:63], a[0:3], v[120:123]
  s_add_u32 s65, s67, 32768
  buffer_load_dwordx4 v[200:203], v38, s[20:23], s65 offen offset:0 sc1
  v_mfma_f32_16x16x32_bf16 v[124:127], a[64:67], a[0:3], v[124:127]
  v_mfma_f32_16x16x32_bf16 v[128:131], a[68:71], a[0:3], v[128:131]
  v_mfma_f32_16x16x32_bf16 v[132:135], a[72:75], a[0:3], v[132:135]
  s_waitcnt lgkmcnt(10)
  ds_write_b128 v36, v[100:103] offset:16128
  v_mfma_f32_16x16x32_bf16 v[136:139], a[76:79], a[0:3], v[136:139]
  buffer_load_dwordx4 v[204:207], v38, s[20:23], s65 offen offset:1024 sc1
  ds_write_b128 v36, v[104:107] offset:16192
  s_waitcnt vmcnt(20)
  v_mfma_f32_16x16x32_bf16 v[140:143], a[60:63], a[4:7], v[140:143]
  ds_write_b128 v36, v[108:111] offset:16256
  v_mfma_f32_16x16x32_bf16 v[144:147], a[64:67], a[4:7], v[144:147]
  ds_write_b128 v36, v[112:115] offset:16320
  v_mfma_f32_16x16x32_bf16 v[148:151], a[68:71], a[4:7], v[148:151]
  ds_write_b128 v36, v[116:119] offset:16384
  v_mfma_f32_16x16x32_bf16 v[152:155], a[72:75], a[4:7], v[152:155]
  buffer_load_dwordx4 v[208:211], v38, s[20:23], s65 offen offset:2048 sc1
  v_mfma_f32_16x16x32_bf16 v[156:159], a[76:79], a[4:7], v[156:159]
  s_waitcnt vmcnt(20)
  v_mfma_f32_16x16x32_bf16 v[160:163], a[60:63], a[8:11], v[160:163]
  v_mfma_f32_16x16x32_bf16 v[164:167], a[64:67], a[8:11], v[164:167]
  v_mfma_f32_16x16x32_bf16 v[168:171], a[68:71], a[8:11], v[168:171]
  buffer_load_dwordx4 v[212:215], v38, s[20:23], s65 offen offset:3072 sc1
  s_waitcnt lgkmcnt(0)
  s_barrier
  v_mfma_f32_16x16x32_bf16 v[172:175], a[72:75], a[8:11], v[172:175]
  v_mfma_f32_16x16x32_bf16 v[176:179], a[76:79], a[8:11], v[176:179]
  s_waitcnt vmcnt(20)
  v_mfma_f32_16x16x32_bf16 v[180:183], a[60:63], a[12:15], v[180:183]
  v_mfma_f32_16x16x32_bf16 v[184:187], a[64:67], a[12:15], v[184:187]
  s_add_u32 s65, s67, 36864
  buffer_load_dwordx4 a[32:35], v38, s[20:23], s65 offen offset:0 sc1
  v_mfma_f32_16x16x32_bf16 v[188:191], a[68:71], a[12:15], v[188:191]
  v_mfma_f32_16x16x32_bf16 v[192:195], a[72:75], a[12:15], v[192:195]
  v_mfma_f32_16x16x32_bf16 v[196:199], a[76:79], a[12:15], v[196:199]
  s_waitcnt vmcnt(20)
  v_mfma_f32_16x16x32_bf16 v[120:123], a[80:83], v[18:21], v[120:123]
  buffer_load_dwordx4 a[36:39], v38, s[20:23], s65 offen offset:1024 sc1
  ds_read_b128 v[40:43], v6 offset:0
  ds_read_b128 v[44:47], v6 offset:21504
  ds_read_b128 v[48:51], v6 offset:43008
  v_mfma_f32_16x16x32_bf16 v[124:127], a[84:87], v[18:21], v[124:127]
  ds_read_b128 v[52:55], v6 offset:64512
  ds_read_b128 v[56:59], v7 offset:0
  v_mfma_f32_16x16x32_bf16 v[128:131], a[88:91], v[18:21], v[128:131]
  ds_read_b128 v[60:63], v7 offset:21504
  ds_read_b128 v[64:67], v7 offset:43008
  ds_read_b128 v[68:71], v7 offset:64512
  v_mfma_f32_16x16x32_bf16 v[132:135], a[92:95], v[18:21], v[132:135]
  ds_read_b128 v[72:75], v8 offset:0
  ds_read_b128 v[76:79], v8 offset:21504
  v_mfma_f32_16x16x32_bf16 v[136:139], a[96:99], v[18:21], v[136:139]
  buffer_load_dwordx4 a[40:43], v38, s[20:23], s65 offen offset:2048 sc1
  ds_read_b128 v[80:83], v8 offset:43008
  ds_read_b128 v[84:87], v8 offset:64512
  s_waitcnt lgkmcnt(10)
  v_add_f32 v40, v40, v44
  s_waitcnt vmcnt(21)
  v_mfma_f32_16x16x32_bf16 v[140:143], a[80:83], v[22:25], v[140:143]
  s_waitcnt lgkmcnt(8)
  v_add_f32 v48, v48, v52
  v_add_f32 v41, v41, v45
  v_mfma_f32_16x16x32_bf16 v[144:147], a[84:87], v[22:25], v[144:147]
  v_add_f32 v49, v49, v53
  v_add_f32 v42, v42, v46
  v_add_f32 v50, v50, v54
  v_mfma_f32_16x16x32_bf16 v[148:151], a[88:91], v[22:25], v[148:151]
  v_add_f32 v43, v43, v47
  v_add_f32 v51, v51, v55
  v_mfma_f32_16x16x32_bf16 v[152:155], a[92:95], v[22:25], v[152:155]
  buffer_load_dwordx4 a[44:47], v38, s[20:23], s65 offen offset:3072 sc1
  v_add_f32 v40, v40, v48
  v_add_f32 v41, v41, v49
  v_add_f32 v42, v42, v50
  v_mfma_f32_16x16x32_bf16 v[156:159], a[96:99], v[22:25], v[156:159]
  v_add_f32 v43, v43, v51
  v_cvt_pk_bf16_f32 v88, v40, v41
  s_waitcnt vmcnt(21)
  v_mfma_f32_16x16x32_bf16 v[160:163], a[80:83], v[26:29], v[160:163]
  v_cvt_pk_bf16_f32 v89, v42, v43
  ds_read_b128 v[40:43], v9 offset:0
  ds_read_b128 v[44:47], v9 offset:21504
  v_mfma_f32_16x16x32_bf16 v[164:167], a[84:87], v[26:29], v[164:167]
  ds_read_b128 v[48:51], v9 offset:43008
  ds_read_b128 v[52:55], v9 offset:64512
  s_waitcnt lgkmcnt(10)
  v_add_f32 v56, v56, v60
  v_mfma_f32_16x16x32_bf16 v[168:171], a[88:91], v[26:29], v[168:171]
  s_add_u32 s65, s67, 40960
  buffer_load_dwordx4 a[0:3], v38, s[20:23], s65 offen offset:0 sc1
  s_waitcnt lgkmcnt(8)
  v_add_f32 v64, v64, v68
  v_add_f32 v57, v57, v61
  v_mfma_f32_16x16x32_bf16 v[172:175], a[92:95], v[26:29], v[172:175]
  v_add_f32 v65, v65, v69
  v_add_f32 v58, v58, v62
  v_add_f32 v66, v66, v70
  v_mfma_f32_16x16x32_bf16 v[176:179], a[96:99], v[26:29], v[176:179]
  v_add_f32 v59, v59, v63
  v_add_f32 v67, v67, v71
  s_waitcnt vmcnt(21)
  v_mfma_f32_16x16x32_bf16 v[180:183], a[80:83], v[30:33], v[180:183]
  v_add_f32 v56, v56, v64
  v_add_f32 v57, v57, v65
  v_add_f32 v58, v58, v66
  v_mfma_f32_16x16x32_bf16 v[184:187], a[84:87], v[30:33], v[184:187]
  buffer_load_dwordx4 a[4:7], v38, s[20:23], s65 offen offset:1024 sc1
  v_add_f32 v59, v59, v67
  v_cvt_pk_bf16_f32 v90, v56, v57
  v_mfma_f32_16x16x32_bf16 v[188:191], a[88:91], v[30:33], v[188:191]
  v_cvt_pk_bf16_f32 v92, v58, v59
  v_mov_b32 v91, s92
  buffer_store_dwordx4 v[88:91], v17, s[20:23], s63 offen sc1
  v_mfma_f32_16x16x32_bf16 v[192:195], a[92:95], v[30:33], v[192:195]
  s_add_u32 s63, s63, 4096
  ds_read_b128 v[56:59], v10 offset:0
  v_mfma_f32_16x16x32_bf16 v[196:199], a[96:99], v[30:33], v[196:199]
  ds_read_b128 v[60:63], v10 offset:21504
  ds_read_b128 v[64:67], v10 offset:43008
  ds_read_b128 v[68:71], v10 offset:64512
  s_waitcnt vmcnt(22)
  v_mfma_f32_16x16x32_bf16 v[120:123], a[100:103], a[16:19], v[120:123]
  buffer_load_dwordx4 a[8:11], v38, s[20:23], s65 offen offset:2048 sc1
  s_waitcnt lgkmcnt(10)
  v_add_f32 v72, v72, v76
  s_waitcnt lgkmcnt(8)
  v_add_f32 v80, v80, v84
  v_add_f32 v73, v73, v77
  v_mfma_f32_16x16x32_bf16 v[124:127], a[104:107], a[16:19], v[124:127]
  v_add_f32 v81, v81, v85
  v_add_f32 v74, v74, v78
  v_mfma_f32_16x16x32_bf16 v[128:131], a[108:111], a[16:19], v[128:131]
  v_add_f32 v82, v82, v86
  v_add_f32 v75, v75, v79
  v_add_f32 v83, v83, v87
  v_mfma_f32_16x16x32_bf16 v[132:135], a[176:179], a[16:19], v[132:135]
  v_add_f32 v72, v72, v80
  v_add_f32 v73, v73, v81
  v_mfma_f32_16x16x32_bf16 v[136:139], a[212:215], a[16:19], v[136:139]
  buffer_load_dwordx4 a[12:15], v38, s[20:23], s65 offen offset:3072 sc1
  v_add_f32 v74, v74, v82
  v_add_f32 v75, v75, v83
  v_cvt_pk_bf16_f32 v93, v72, v73
  s_waitcnt vmcnt(23)
  v_mfma_f32_16x16x32_bf16 v[140:143], a[100:103], a[20:23], v[140:143]
  v_cvt_pk_bf16_f32 v94, v74, v75
  v_mov_b32 v95, s92
  v_mfma_f32_16x16x32_bf16 v[144:147], a[104:107], a[20:23], v[144:147]
  buffer_store_dwordx4 v[92:95], v17, s[20:23], s63 offen sc1
  s_add_u32 s63, s63, 4096
  s_waitcnt lgkmcnt(6)
  v_add_f32 v40, v40, v44
  v_mfma_f32_16x16x32_bf16 v[148:151], a[108:111], a[20:23], v[148:151]
  s_waitcnt lgkmcnt(4)
  v_add_f32 v48, v48, v52
  v_add_f32 v41, v41, v45
  v_mfma_f32_16x16x32_bf16 v[152:155], a[176:179], a[20:23], v[152:155]
  v_add_f32 v49, v49, v53
  v_add_f32 v42, v42, v46
  v_add_f32 v50, v50, v54
  v_mfma_f32_16x16x32_bf16 v[156:159], a[212:215], a[20:23], v[156:159]
  v_add_f32 v43, v43, v47
  v_add_f32 v51, v51, v55
  v_add_f32 v40, v40, v48
  s_waitcnt vmcnt(23)
  v_mfma_f32_16x16x32_bf16 v[160:163], a[100:103], a[24:27], v[160:163]
  v_add_f32 v41, v41, v49
  v_add_f32 v42, v42, v50
  v_mfma_f32_16x16x32_bf16 v[164:167], a[104:107], a[24:27], v[164:167]
  v_add_f32 v43, v43, v51
  v_cvt_pk_bf16_f32 v96, v40, v41
  v_cvt_pk_bf16_f32 v97, v42, v43
  v_mfma_f32_16x16x32_bf16 v[168:171], a[108:111], a[24:27], v[168:171]
  s_waitcnt lgkmcnt(2)
  v_add_f32 v56, v56, v60
  s_waitcnt lgkmcnt(0)
  v_add_f32 v64, v64, v68
  v_mfma_f32_16x16x32_bf16 v[172:175], a[176:179], a[24:27], v[172:175]
  v_add_f32 v57, v57, v61
  v_add_f32 v65, v65, v69
  v_add_f32 v58, v58, v62
  v_mfma_f32_16x16x32_bf16 v[176:179], a[212:215], a[24:27], v[176:179]
  v_add_f32 v66, v66, v70
  v_add_f32 v59, v59, v63
  s_waitcnt vmcnt(22)
  v_mfma_f32_16x16x32_bf16 v[180:183], a[100:103], a[28:31], v[180:183]
  v_add_f32 v67, v67, v71
  v_add_f32 v56, v56, v64
  v_add_f32 v57, v57, v65
  v_mfma_f32_16x16x32_bf16 v[184:187], a[104:107], a[28:31], v[184:187]
  v_add_f32 v58, v58, v66
  v_add_f32 v59, v59, v67
  v_mfma_f32_16x16x32_bf16 v[188:191], a[108:111], a[28:31], v[188:191]
  v_cvt_pk_bf16_f32 v98, v56, v57
  v_cvt_pk_bf16_f32 v100, v58, v59
  v_mov_b32 v99, s92
  v_mfma_f32_16x16x32_bf16 v[192:195], a[176:179], a[28:31], v[192:195]
  buffer_store_dwordx4 v[96:99], v17, s[20:23], s63 offen sc1
  s_add_u32 s63, s63, 4096
  v_mfma_f32_16x16x32_bf16 v[196:199], a[212:215], a[28:31], v[196:199]
  v_mov_b32 v101, s92
  v_lshrrev_b32 v16, 1, v17
  buffer_store_dwordx2 v[100:101], v16, s[20:23], s63 offen sc1
  s_waitcnt vmcnt(23)
  v_mfma_f32_16x16x32_bf16 v[120:123], a[216:219], a[220:223], v[120:123]
  s_add_u32 s70, s62, 0
  v_mfma_f32_16x16x32_bf16 v[124:127], a[240:243], a[220:223], v[124:127]
  s_add_u32 s71, s62, 4096
  v_mfma_f32_16x16x32_bf16 v[128:131], a[244:247], a[220:223], v[128:131]
  s_add_u32 s72, s62, 8192
  v_mfma_f32_16x16x32_bf16 v[132:135], a[248:251], a[220:223], v[132:135]
  s_add_u32 s73, s62, 12288
  v_mfma_f32_16x16x32_bf16 v[136:139], a[252:255], a[220:223], v[136:139]
  s_waitcnt vmcnt(22)
  v_mfma_f32_16x16x32_bf16 v[140:143], a[216:219], a[224:227], v[140:143]
  v_mfma_f32_16x16x32_bf16 v[144:147], a[240:243], a[224:227], v[144:147]
  v_mfma_f32_16x16x32_bf16 v[148:151], a[244:247], a[224:227], v[148:151]
  v_mfma_f32_16x16x32_bf16 v[152:155], a[248:251], a[224:227], v[152:155]
  v_mfma_f32_16x16x32_bf16 v[156:159], a[252:255], a[224:227], v[156:159]
  s_waitcnt vmcnt(21)
  v_mfma_f32_16x16x32_bf16 v[160:163], a[216:219], a[228:231], v[160:163]
  v_mfma_f32_16x16x32_bf16 v[164:167], a[240:243], a[228:231], v[164:167]
  v_mfma_f32_16x16x32_bf16 v[168:171], a[244:247], a[228:231], v[168:171]
  v_mfma_f32_16x16x32_bf16 v[172:175], a[248:251], a[228:231], v[172:175]
  v_mfma_f32_16x16x32_bf16 v[176:179], a[252:255], a[228:231], v[176:179]
  s_waitcnt vmcnt(20)
  v_mfma_f32_16x16x32_bf16 v[180:183], a[216:219], a[232:235], v[180:183]
  v_mfma_f32_16x16x32_bf16 v[184:187], a[240:243], a[232:235], v[184:187]
  v_mfma_f32_16x16x32_bf16 v[188:191], a[244:247], a[232:235], v[188:191]
  v_mfma_f32_16x16x32_bf16 v[192:195], a[248:251], a[232:235], v[192:195]
  v_mfma_f32_16x16x32_bf16 v[196:199], a[252:255], a[232:235], v[196:199]
  s_waitcnt vmcnt(19)
  v_mfma_f32_16x16x32_bf16 v[120:123], a[112:115], a[196:199], v[120:123]
  v_mfma_f32_16x16x32_bf16 v[124:127], a[116:119], a[196:199], v[124:127]
  v_mfma_f32_16x16x32_bf16 v[128:131], a[120:123], a[196:199], v[128:131]
  v_mfma_f32_16x16x32_bf16 v[132:135], a[124:127], a[196:199], v[132:135]
  v_mfma_f32_16x16x32_bf16 v[136:139], a[128:131], a[196:199], v[136:139]
  s_waitcnt vmcnt(18)
  v_mfma_f32_16x16x32_bf16 v[140:143], a[112:115], a[200:203], v[140:143]
  v_mfma_f32_16x16x32_bf16 v[144:147], a[116:119], a[200:203], v[144:147]
  v_mfma_f32_16x16x32_bf16 v[148:151], a[120:123], a[200:203], v[148:151]
  v_mfma_f32_16x16x32_bf16 v[152:155], a[124:127], a[200:203], v[152:155]
  v_mfma_f32_16x16x32_bf16 v[156:159], a[128:131], a[200:203], v[156:159]
  s_waitcnt vmcnt(17)
  v_mfma_f32_16x16x32_bf16 v[160:163], a[112:115], a[204:207], v[160:163]
  v_mfma_f32_16x16x32_bf16 v[164:167], a[116:119], a[204:207], v[164:167]
  v_mfma_f32_16x16x32_bf16 v[168:171], a[120:123], a[204:207], v[168:171]
  v_mfma_f32_16x16x32_bf16 v[172:175], a[124:127], a[204:207], v[172:175]
  v_mfma_f32_16x16x32_bf16 v[176:179], a[128:131], a[204:207], v[176:179]
  s_waitcnt vmcnt(16)
  v_mfma_f32_16x16x32_bf16 v[180:183], a[112:115], a[208:211], v[180:183]
  v_mfma_f32_16x16x32_bf16 v[184:187], a[116:119], a[208:211], v[184:187]
  v_mfma_f32_16x16x32_bf16 v[188:191], a[120:123], a[208:211], v[188:191]
  v_mfma_f32_16x16x32_bf16 v[192:195], a[124:127], a[208:211], v[192:195]
  v_mfma_f32_16x16x32_bf16 v[196:199], a[128:131], a[208:211], v[196:199]
  s_waitcnt vmcnt(15)
  v_mfma_f32_16x16x32_bf16 v[120:123], a[132:135], v[200:203], v[120:123]
  v_mfma_f32_16x16x32_bf16 v[124:127], a[136:139], v[200:203], v[124:127]
  v_mfma_f32_16x16x32_bf16 v[128:131], a[140:143], v[200:203], v[128:131]
  v_mfma_f32_16x16x32_bf16 v[132:135], a[144:147], v[200:203], v[132:135]
  v_mfma_f32_16x16x32_bf16 v[136:139], a[148:151], v[200:203], v[136:139]
  s_waitcnt vmcnt(14)
  v_mfma_f32_16x16x32_bf16 v[140:143], a[132:135], v[204:207], v[140:143]
  v_mfma_f32_16x16x32_bf16 v[144:147], a[136:139], v[204:207], v[144:147]
  v_mfma_f32_16x16x32_bf16 v[148:151], a[140:143], v[204:207], v[148:151]
  v_mfma_f32_16x16x32_bf16 v[152:155], a[144:147], v[204:207], v[152:155]
  v_mfma_f32_16x16x32_bf16 v[156:159], a[148:151], v[204:207], v[156:159]
  s_waitcnt vmcnt(13)
  v_mfma_f32_16x16x32_bf16 v[160:163], a[132:135], v[208:211], v[160:163]
  v_mfma_f32_16x16x32_bf16 v[164:167], a[136:139], v[208:211], v[164:167]
  v_mfma_f32_16x16x32_bf16 v[168:171], a[140:143], v[208:211], v[168:171]
  v_mfma_f32_16x16x32_bf16 v[172:175], a[144:147], v[208:211], v[172:175]
  v_mfma_f32_16x16x32_bf16 v[176:179], a[148:151], v[208:211], v[176:179]
  s_waitcnt vmcnt(12)
  v_mfma_f32_16x16x32_bf16 v[180:183], a[132:135], v[212:215], v[180:183]
  v_mfma_f32_16x16x32_bf16 v[184:187], a[136:139], v[212:215], v[184:187]
  v_mfma_f32_16x16x32_bf16 v[188:191], a[140:143], v[212:215], v[188:191]
  v_mfma_f32_16x16x32_bf16 v[192:195], a[144:147], v[212:215], v[192:195]
  v_mfma_f32_16x16x32_bf16 v[196:199], a[148:151], v[212:215], v[196:199]
  s_waitcnt vmcnt(11)
  v_mfma_f32_16x16x32_bf16 v[120:123], a[152:155], a[32:35], v[120:123]
  s_barrier
  buffer_load_dwordx4 v[40:43], v17, s[20:23], s70 offen sc1
  v_mfma_f32_16x16x32_bf16 v[124:127], a[156:159], a[32:35], v[124:127]
  buffer_load_dwordx4 v[44:47], v17, s[20:23], s71 offen sc1
  v_mfma_f32_16x16x32_bf16 v[128:131], a[160:163], a[32:35], v[128:131]
  buffer_load_dwordx4 v[48:51], v17, s[20:23], s72 offen sc1
  v_mfma_f32_16x16x32_bf16 v[132:135], a[164:167], a[32:35], v[132:135]
  buffer_load_dwordx2 v[52:53], v16, s[20:23], s73 offen sc1
  v_mfma_f32_16x16x32_bf16 v[136:139], a[168:171], a[32:35], v[136:139]
  s_waitcnt vmcnt(11)
  v_mfma_f32_16x16x32_bf16 v[120:123], a[172:175], a[0:3], v[120:123]
  v_mfma_f32_16x16x32_bf16 v[124:127], a[180:183], a[0:3], v[124:127]
  v_mfma_f32_16x16x32_bf16 v[128:131], a[184:187], a[0:3], v[128:131]
  v_mfma_f32_16x16x32_bf16 v[132:135], a[188:191], a[0:3], v[132:135]
  v_mfma_f32_16x16x32_bf16 v[136:139], a[192:195], a[0:3], v[136:139]
  v_mfma_f32_16x16x32_bf16 v[140:143], a[152:155], a[36:39], v[140:143]
  v_mfma_f32_16x16x32_bf16 v[144:147], a[156:159], a[36:39], v[144:147]
  v_mfma_f32_16x16x32_bf16 v[148:151], a[160:163], a[36:39], v[148:151]
  v_mfma_f32_16x16x32_bf16 v[152:155], a[164:167], a[36:39], v[152:155]
  ds_write_b128 v36, v[120:123] offset:0
  v_mfma_f32_16x16x32_bf16 v[156:159], a[168:171], a[36:39], v[156:159]
  ds_write_b128 v36, v[124:127] offset:64
  s_waitcnt vmcnt(10)
  v_mfma_f32_16x16x32_bf16 v[140:143], a[172:175], a[4:7], v[140:143]
  ds_write_b128 v36, v[128:131] offset:128
  v_mfma_f32_16x16x32_bf16 v[144:147], a[180:183], a[4:7], v[144:147]
  ds_write_b128 v36, v[132:135] offset:192
  v_mfma_f32_16x16x32_bf16 v[148:151], a[184:187], a[4:7], v[148:151]
  ds_write_b128 v36, v[136:139] offset:256
  v_mfma_f32_16x16x32_bf16 v[152:155], a[188:191], a[4:7], v[152:155]
  v_mfma_f32_16x16x32_bf16 v[156:159], a[192:195], a[4:7], v[156:159]
  v_mfma_f32_16x16x32_bf16 v[160:163], a[152:155], a[40:43], v[160:163]
  v_mfma_f32_16x16x32_bf16 v[164:167], a[156:159], a[40:43], v[164:167]
  v_mfma_f32_16x16x32_bf16 v[168:171], a[160:163], a[40:43], v[168:171]
  v_mfma_f32_16x16x32_bf16 v[172:175], a[164:167], a[40:43], v[172:175]
  ds_write_b128 v36, v[140:143] offset:5376
  v_mfma_f32_16x16x32_bf16 v[176:179], a[168:171], a[40:43], v[176:179]
  ds_write_b128 v36, v[144:147] offset:5440
  s_waitcnt vmcnt(8)
  v_mfma_f32_16x16x32_bf16 v[160:163], a[172:175], a[8:11], v[160:163]
  ds_write_b128 v36, v[148:151] offset:5504
  v_mfma_f32_16x16x32_bf16 v[164:167], a[180:183], a[8:11], v[164:167]
  ds_write_b128 v36, v[152:155] offset:5568
  v_mfma_f32_16x16x32_bf16 v[168:171], a[184:187], a[8:11], v[168:171]
  ds_write_b128 v36, v[156:159] offset:5632
  v_mfma_f32_16x16x32_bf16 v[172:175], a[188:191], a[8:11], v[172:175]
  v_mfma_f32_16x16x32_bf16 v[176:179], a[192:195], a[8:11], v[176:179]
  v_mfma_f32_16x16x32_bf16 v[180:183], a[152:155], a[44:47], v[180:183]
  v_mfma_f32_16x16x32_bf16 v[184:187], a[156:159], a[44:47], v[184:187]
  v_mfma_f32_16x16x32_bf16 v[188:191], a[160:163], a[44:47], v[188:191]
  v_mfma_f32_16x16x32_bf16 v[192:195], a[164:167], a[44:47], v[192:195]
  ds_write_b128 v36, v[160:163] offset:10752
  v_mfma_f32_16x16x32_bf16 v[196:199], a[168:171], a[44:47], v[196:199]
  ds_write_b128 v36, v[164:167] offset:10816
  s_waitcnt vmcnt(7)
  v_mfma_f32_16x16x32_bf16 v[180:183], a[172:175], a[12:15], v[180:183]
  ds_write_b128 v36, v[168:171] offset:10880
  v_mfma_f32_16x16x32_bf16 v[184:187], a[180:183], a[12:15], v[184:187]
  ds_write_b128 v36, v[172:175] offset:10944
  v_mfma_f32_16x16x32_bf16 v[188:191], a[184:187], a[12:15], v[188:191]
  ds_write_b128 v36, v[176:179] offset:11008
  v_mfma_f32_16x16x32_bf16 v[192:195], a[188:191], a[12:15], v[192:195]
  v_mfma_f32_16x16x32_bf16 v[196:199], a[192:195], a[12:15], v[196:199]
  s_waitcnt lgkmcnt(10)
  ds_write_b128 v36, v[180:183] offset:16128
  s_nop 0
  ds_write_b128 v36, v[184:187] offset:16192
  s_nop 0
  ds_write_b128 v36, v[188:191] offset:16256
  s_nop 0
  ds_write_b128 v36, v[192:195] offset:16320
  ds_write_b128 v36, v[196:199] offset:16384
  s_waitcnt lgkmcnt(0)
  s_barrier
  ds_read_b128 v[120:123], v6 offset:0
  ds_read_b128 v[124:127], v6 offset:21504
  ds_read_b128 v[128:131], v6 offset:43008
  ds_read_b128 v[132:135], v6 offset:64512
  ds_read_b128 v[136:139], v7 offset:0
  ds_read_b128 v[140:143], v7 offset:21504
  ds_read_b128 v[144:147], v7 offset:43008
  ds_read_b128 v[148:151], v7 offset:64512
  ds_read_b128 v[152:155], v8 offset:0
  ds_read_b128 v[156:159], v8 offset:21504
  ds_read_b128 v[160:163], v8 offset:43008
  ds_read_b128 v[164:167], v8 offset:64512
  s_waitcnt vmcnt(0)
  v_xor_b32 v39, s92, v53
  v_bitop3_b32 v39, v39, v51, s92 bitop3:0xf6
  v_bitop3_b32 v39, v39, v47, s92 bitop3:0xf6
  v_bitop3_b32 v39, v39, v43, s92 bitop3:0xf6
  v_cmp_ne_u32 vcc, 0, v39
  s_nop 3
  s_cbranch_vccnz X_poll8_slow
X_poll8_ret:
  v_lshlrev_b32 v56, 16, v40
  v_and_b32 v40, s52, v40
  v_lshlrev_b32 v57, 16, v41
  v_and_b32 v41, s52, v41
  v_lshlrev_b32 v58, 16, v42
  v_and_b32 v42, s52, v42
  v_lshlrev_b32 v59, 16, v44
  v_and_b32 v44, s52, v44
  v_lshlrev_b32 v60, 16, v45
  v_and_b32 v45, s52, v45
  v_lshlrev_b32 v61, 16, v46
  v_and_b32 v46, s52, v46
  v_lshlrev_b32 v62, 16, v48
  v_and_b32 v48, s52, v48
  v_lshlrev_b32 v63, 16, v49
  v_and_b32 v49, s52, v49
  v_lshlrev_b32 v64, 16, v50
  v_and_b32 v50, s52, v50
  v_lshlrev_b32 v65, 16, v52
  v_and_b32 v52, s52, v52
  v_add_f32 v216, v216, v56
  v_add_f32 v217, v217, v40
  v_add_f32 v226, v226, v57
  v_add_f32 v227, v227, v41
  v_add_f32 v218, v218, v58
  v_add_f32 v219, v219, v42
  v_add_f32 v228, v228, v59
  v_add_f32 v229, v229, v44
  v_add_f32 v220, v220, v60
  v_add_f32 v221, v221, v45
  v_add_f32 v230, v230, v61
  v_add_f32 v231, v231, v46
  v_add_f32 v222, v222, v62
  v_add_f32 v223, v223, v48
  v_add_f32 v232, v232, v63
  v_add_f32 v233, v233, v49
  v_add_f32 v224, v224, v64
  v_add_f32 v225, v225, v50
  v_add_f32 v234, v234, v65
  v_add_f32 v235, v235, v52
  ds_read_b128 v[168:171], v9 offset:0
  ds_read_b128 v[172:175], v9 offset:21504
  ds_read_b128 v[176:179], v9 offset:43008
  s_waitcnt lgkmcnt(10)
  ds_read_b128 v[180:183], v9 offset:64512
  ds_read_b128 v[184:187], v10 offset:0
  ds_read_b128 v[188:191], v10 offset:21504
  ds_read_b128 v[192:195], v10 offset:43008
  ds_read_b128 v[196:199], v10 offset:64512
  v_add_f32 v120, v120, v124
  v_add_f32 v128, v128, v132
  v_add_f32 v121, v121, v125
  v_add_f32 v129, v129, v133
  v_add_f32 v122, v122, v126
  v_add_f32 v130, v130, v134
  v_add_f32 v123, v123, v127
  v_add_f32 v131, v131, v135
  v_add_f32 v120, v120, v216
  v_add_f32 v121, v121, v217
  v_add_f32 v122, v122, v226
  v_add_f32 v123, v123, v227
  v_add_f32 v120, v120, v128
  v_add_f32 v121, v121, v129
  v_add_f32 v122, v122, v130
  v_add_f32 v123, v123, v131
  buffer_store_dwordx4 v[120:123], v11, s[12:15], s61 offen sc1
  s_waitcnt lgkmcnt(14)
  v_add_f32 v136, v136, v140
  s_waitcnt lgkmcnt(12)
  v_add_f32 v144, v144, v148
  v_add_f32 v137, v137, v141
  v_add_f32 v145, v145, v149
  v_add_f32 v138, v138, v142
  v_add_f32 v146, v146, v150
  v_add_f32 v139, v139, v143
  v_add_f32 v147, v147, v151
  v_add_f32 v136, v136, v218
  v_add_f32 v137, v137, v219
  v_add_f32 v138, v138, v228
  v_add_f32 v139, v139, v229
  v_add_f32 v136, v136, v144
  v_add_f32 v137, v137, v145
  v_add_f32 v138, v138, v146
  v_add_f32 v139, v139, v147
  buffer_store_dwordx4 v[136:139], v12, s[12:15], s61 offen sc1
  s_waitcnt lgkmcnt(10)
  v_add_f32 v152, v152, v156
  s_waitcnt lgkmcnt(8)
  v_add_f32 v160, v160, v164
  v_add_f32 v153, v153, v157
  v_add_f32 v161, v161, v165
  v_add_f32 v154, v154, v158
  v_add_f32 v162, v162, v166
  v_add_f32 v155, v155, v159
  v_add_f32 v163, v163, v167
  v_add_f32 v152, v152, v220
  v_add_f32 v153, v153, v221
  v_add_f32 v154, v154, v230
  v_add_f32 v155, v155, v231
  v_add_f32 v152, v152, v160
  v_add_f32 v153, v153, v161
  v_add_f32 v154, v154, v162
  v_add_f32 v155, v155, v163
  buffer_store_dwordx4 v[152:155], v13, s[12:15], s61 offen sc1
  s_waitcnt lgkmcnt(6)
  v_add_f32 v168, v168, v172
  s_waitcnt lgkmcnt(4)
  v_add_f32 v176, v176, v180
  v_add_f32 v169, v169, v173
  v_add_f32 v177, v177, v181
  v_add_f32 v170, v170, v174
  v_add_f32 v178, v178, v182
  v_add_f32 v171, v171, v175
  v_add_f32 v179, v179, v183
  v_add_f32 v168, v168, v222
  v_add_f32 v169, v169, v223
  v_add_f32 v170, v170, v232
  v_add_f32 v171, v171, v233
  v_add_f32 v168, v168, v176
  v_add_f32 v169, v169, v177
  v_add_f32 v170, v170, v178
  v_add_f32 v171, v171, v179
  buffer_store_dwordx4 v[168:171], v14, s[12:15], s61 offen sc1
  s_waitcnt lgkmcnt(2)
  v_add_f32 v184, v184, v188
  s_waitcnt lgkmcnt(0)
  v_add_f32 v192, v192, v196
  v_add_f32 v185, v185, v189
  v_add_f32 v193, v193, v197
  v_add_f32 v186, v186, v190
  v_add_f32 v194, v194, v198
  v_add_f32 v187, v187, v191
  v_add_f32 v195, v195, v199
  v_add_f32 v184, v184, v224
  v_add_f32 v185, v185, v225
  v_add_f32 v186, v186, v234
  v_add_f32 v187, v187, v235
  v_add_f32 v184, v184, v192
  v_add_f32 v185, v185, v193
  v_add_f32 v186, v186, v194
  v_add_f32 v187, v187, v195
  buffer_store_dwordx4 v[184:187], v15, s[12:15], s61 offen sc1
X_end:
  s_endpgm
X_poll0_slow:
  s_mov_b32 s89, 0x40000
X_poll0_lp:
  s_sleep 1
  s_sub_u32 s89, s89, 1
  s_cmp_eq_u32 s89, 0
  s_cbranch_scc1 X_poll0_ret
  buffer_load_dwordx4 v[28:31], v212, s[20:23], s100 offen sc1
  s_waitcnt vmcnt(0)
  v_xor_b32 v39, s92, v31
  v_bitop3_b32 v39, v39, v30, s92 bitop3:0xf6
  v_cmp_ne_u32 vcc, 0, v39
  s_nop 3
  s_cbranch_vccnz X_poll0_lp
  s_branch X_poll0_ret
X_poll1_slow:
  s_mov_b32 s89, 0x40000
X_poll1_lp:
  s_sleep 1
  s_sub_u32 s89, s89, 1
  s_cmp_eq_u32 s89, 0
  s_cbranch_scc1 X_poll1_ret
  buffer_load_dwordx2 v[120:121], v209, s[20:23], s83 offen offset:0 sc1
  buffer_load_dwordx2 v[122:123], v209, s[20:23], s83 offen offset:1280 sc1
  buffer_load_dwordx2 v[124:125], v209, s[20:23], s83 offen offset:2560 sc1
  buffer_load_dwordx2 v[126:127], v209, s[20:23], s82 offen offset:0 sc1
  buffer_load_dwordx2 v[128:129], v209, s[20:23], s82 offen offset:1280 sc1
  s_waitcnt vmcnt(0)
  v_xor_b32 v39, s92, v129
  v_bitop3_b32 v39, v39, v127, s92 bitop3:0xf6
  v_bitop3_b32 v39, v39, v125, s92 bitop3:0xf6
  v_bitop3_b32 v39, v39, v123, s92 bitop3:0xf6
  v_bitop3_b32 v39, v39, v121, s92 bitop3:0xf6
  v_cmp_ne_u32 vcc, 0, v39
  s_nop 3
  s_cbranch_vccnz X_poll1_lp
  s_branch X_poll1_ret
X_poll2_slow:
  s_mov_b32 s89, 0x40000
X_poll2_lp:
  s_sleep 1
  buffer_load_dword v249, v248, s[20:23], s69 offen sc1
  s_waitcnt vmcnt(0)
  v_xor_b32 v250, s92, v249
  v_cmp_ne_u32 s[86:87], 0, v250
  s_nop 3
  s_cmp_lg_u64 s[86:87], 0
  s_cbranch_scc0 X_poll2_ret
  s_sub_u32 s89, s89, 1
  s_cmp_lg_u32 s89, 0
  s_cbranch_scc1 X_poll2_lp
  s_branch X_poll2_ret
X_poll3_slow:
  s_mov_b32 s89, 0x40000
X_poll3_lp:
  s_sleep 1
  s_sub_u32 s89, s89, 1
  s_cmp_eq_u32 s89, 0
  s_cbranch_scc1 X_poll3_ret
  buffer_load_dword v211, v210, s[32:35], 0 offen sc1
  s_waitcnt vmcnt(0)
  v_cmp_eq_u32 vcc, 0, v211
  s_nop 3
  s_cbranch_vccnz X_poll3_lp
  s_branch X_poll3_ret
X_poll4_slow:
  s_mov_b32 s89, 0x40000
X_poll4_lp:
  s_sleep 1
  s_sub_u32 s89, s89, 1
  s_cmp_eq_u32 s89, 0
  s_cbranch_scc1 X_poll4_ret
  buffer_load_dwordx2 v[184:185], v209, s[20:23], s83 offen offset:0 sc1
  buffer_load_dwordx2 v[186:187], v209, s[20:23], s83 offen offset:1280 sc1
  buffer_load_dwordx2 v[188:189], v209, s[20:23], s83 offen offset:2560 sc1
  buffer_load_dwordx2 v[190:191], v209, s[20:23], s82 offen offset:0 sc1
  buffer_load_dwordx2 v[192:193], v209, s[20:23], s82 offen offset:1280 sc1
  s_waitcnt vmcnt(0)
  v_xor_b32 v39, s92, v193
  v_bitop3_b32 v39, v39, v191, s92 bitop3:0xf6
  v_bitop3_b32 v39, v39, v189, s92 bitop3:0xf6
  v_bitop3_b32 v39, v39, v187, s92 bitop3:0xf6
  v_bitop3_b32 v39, v39, v185, s92 bitop3:0xf6
  v_cmp_ne_u32 vcc, 0, v39
  s_nop 3
  s_cbranch_vccnz X_poll4_lp
  s_branch X_poll4_ret
X_poll5_slow:
  s_mov_b32 s89, 0x40000
X_poll5_lp:
  s_sleep 1
  s_sub_u32 s89, s89, 1
  s_cmp_eq_u32 s89, 0
  s_cbranch_scc1 X_poll5_ret
  buffer_load_dword v249, v248, s[20:23], s87 offen sc1
  s_waitcnt vmcnt(0)
  v_xor_b32 v39, s92, v249
  v_cmp_ne_u32 vcc, 0, v39
  s_nop 3
  s_cbranch_vccnz X_poll5_lp
  s_branch X_poll5_ret
X_poll6_slow:
  s_mov_b32 s89, 0x40000
X_poll6_lp:
  s_sleep 1
  s_sub_u32 s89, s89, 1
  s_cmp_eq_u32 s89, 0
  s_cbranch_scc1 X_poll6_ret
  buffer_load_dwordx4 v[252:255], v3, s[20:23], s49 offen sc1
  s_waitcnt vmcnt(0)
  v_xor_b32 v39, s92, v255
  v_bitop3_b32 v39, v39, v254, s92 bitop3:0xf6
  v_cmp_ne_u32 vcc, 0, v39
  s_nop 3
  s_cbranch_vccnz X_poll6_lp
  s_branch X_poll6_ret
X_poll7_slow:
  s_mov_b32 s89, 0x40000
X_poll7_lp:
  s_sleep 1
  s_sub_u32 s89, s89, 1
  s_cmp_eq_u32 s89, 0
  s_cbranch_scc1 X_poll7_ret
  buffer_load_dword v250, v248, s[20:23], s87 offen offset:128 sc1
  s_waitcnt vmcnt(0)
  v_xor_b32 v39, s92, v250
  v_cmp_ne_u32 vcc, 0, v39
  s_nop 3
  s_cbranch_vccnz X_poll7_lp
  s_branch X_poll7_ret
X_poll8_slow:
  s_mov_b32 s89, 0x40000
X_poll8_lp:
  s_sleep 1
  s_sub_u32 s89, s89, 1
  s_cmp_eq_u32 s89, 0
  s_cbranch_scc1 X_poll8_ret
  buffer_load_dwordx4 v[40:43], v17, s[20:23], s70 offen sc1
  buffer_load_dwordx4 v[44:47], v17, s[20:23], s71 offen sc1
  buffer_load_dwordx4 v[48:51], v17, s[20:23], s72 offen sc1
  buffer_load_dwordx2 v[52:53], v16, s[20:23], s73 offen sc1
  s_waitcnt vmcnt(0)
  v_xor_b32 v39, s92, v53
  v_bitop3_b32 v39, v39, v51, s92 bitop3:0xf6
  v_bitop3_b32 v39, v39, v47, s92 bitop3:0xf6
  v_bitop3_b32 v39, v39, v43, s92 bitop3:0xf6
  v_cmp_ne_u32 vcc, 0, v39
  s_nop 3
  s_cbranch_vccnz X_poll8_lp
  s_branch X_poll8_ret
K_Y:
  buffer_load_dwordx2 v[216:217], v36, s[4:7], s100 offen offset:0
  buffer_load_dwordx2 v[218:219], v36, s[4:7], s100 offen offset:256
  buffer_load_dwordx2 v[220:221], v36, s[4:7], s100 offen offset:512
  buffer_load_dwordx2 v[222:223], v36, s[4:7], s100 offen offset:768
  buffer_load_dwordx2 v[224:225], v36, s[4:7], s100 offen offset:1024
  v_lshrrev_b32 v136, 5, v0
  v_lshlrev_b32 v136, 4, v136
  v_bfe_u32 v137, v0, 1, 4
  v_add_u32 v136, v136, v137
  v_add_u32 v136, s45, v136
  v_min_u32 v136, 639, v136
  v_lshlrev_b32 v136, 1, v136
  global_load_ushort v137, v136, s[66:67]
  global_load_ushort v138, v136, s[68:69]
  global_load_ushort v139, v136, s[78:79]
  v_bfe_u32 v34, v1, 4, 1
  v_lshlrev_b32 v34, 1, v34
  v_xor_b32 v34, v33, v34
  v_lshlrev_b32 v34, 4, v34
  v_mul_u32_u24 v35, 3072, v32
  v_add_u32 v10, v34, v35
  v_xor_b32 v11, 64, v10
  s_mov_b32 s8, s84
  s_mov_b32 s9, s85
  s_mov_b32 s10, 1966080
  s_mov_b32 s11, 0x20000
  s_sub_u32 s12, s86, 1024
  s_subb_u32 s13, s87, 0
  s_mov_b32 s14, 1967104
  s_mov_b32 s15, 0x20000
  s_mul_i32 s98, s42, 49152
  s_mul_i32 s44, s43, 384
  s_add_u32 s98, s98, s44
  s_add_u32 s98, s98, 256
  v_bfe_u32 v34, v1, 2, 1
  v_lshlrev_b32 v34, 4, v34
  v_bfe_u32 v35, v1, 3, 2
  v_lshl_add_u32 v34, v35, 2, v34
  v_and_b32 v35, 3, v1
  v_add_u32 v34, v34, v35
  v_lshlrev_b32 v212, 4, v34
  v_bfe_u32 v35, v34, 1, 3
  v_lshrrev_b32 v6, 5, v1
  v_xor_b32 v35, v35, v6
  v_lshlrev_b32 v35, 4, v35
  v_lshl_add_u32 v35, v34, 7, v35
  v_add_u32 v6, s54, v35
  v_xor_b32 v7, 32, v6
  v_xor_b32 v8, 64, v6
  v_xor_b32 v9, 96, v6
  v_bfe_u32 v34, v1, 2, 1
  v_lshlrev_b32 v34, 10, v34
  v_bfe_u32 v35, v1, 3, 3
  v_lshl_add_u32 v34, v35, 6, v34
  v_and_b32 v35, 3, v1
  v_lshl_add_u32 v23, v35, 4, v34
  v_mov_b32 v24, 0x3f803f80
  v_mov_b32 v25, 0x3f803f80
  v_mov_b32 v26, 0x3f803f80
  v_mov_b32 v27, 0x3f803f80
  s_mov_b32 s20, s94
  s_mov_b32 s21, s95
  s_mov_b32 s22, 23298048
  s_mov_b32 s23, 0x20000
  s_lshl_b32 s44, s40, 1
  s_lshr_b32 s45, s42, 1
  s_add_u32 s44, s44, s45
  s_mul_i32 s44, s44, 88
  s_mul_i32 s45, s43, 11
  s_add_u32 s44, s44, s45
  s_lshl_b32 s57, s44, 12
  s_and_b32 s45, s42, 1
  s_lshl_b32 s45, s45, 11
  s_add_u32 s57, s57, s45
  v_and_b32 v32, 1, v1
  v_bfe_u32 v33, v1, 1, 4
  v_lshl_add_u32 v33, v32, 4, v33
  v_bfe_u32 v34, v33, 1, 3
  v_xor_b32 v34, v34, v32
  v_lshrrev_b32 v35, 5, v1
  v_xor_b32 v34, v34, v35
  v_lshlrev_b32 v34, 4, v34
  v_and_b32 v35, 7, v33
  v_lshl_add_u32 v34, v35, 7, v34
  v_lshrrev_b32 v35, 3, v33
  v_mul_u32_u24 v35, 5120, v35
  v_add_u32 v34, v34, v35
  v_add_u32 v14, 57344, v34
  v_xor_b32 v15, 32, v14
  v_xor_b32 v16, 64, v14
  v_xor_b32 v17, 96, v14
  v_bfe_u32 v32, v1, 4, 1
  v_lshrrev_b32 v33, 5, v1
  v_lshlrev_b32 v33, 11, v33
  v_lshl_add_u32 v33, v32, 10, v33
  v_bfe_u32 v34, v1, 2, 2
  v_lshl_add_u32 v33, v34, 7, v33
  v_and_b32 v35, 3, v1
  v_lshl_add_u32 v33, v35, 3, v33
  v_bfe_u32 v34, v1, 3, 1
  v_lshl_add_u32 v34, v32, 1, v34
  v_lshl_add_u32 v33, v34, 5, v33
  v_add_u32 v18, 57344, v33
  v_xor_b32 v19, 32, v18
  v_xor_b32 v20, 64, v18
  v_xor_b32 v21, 96, v18
  v_lshlrev_b32 v252, 5, v0
  v_mul_u32_u24 v242, 48, v0
  s_add_u32 s36, s94, 15171584
  s_addc_u32 s37, s95, 0
  s_mov_b32 s38, 40960
  s_mov_b32 s39, 0x20000
  s_mul_i32 s44, s43, 40960
  s_add_u32 s36, s36, s44
  s_addc_u32 s37, s37, 0
  v_subrev_u32 v32, 160, v0
  v_min_u32 v32, v32, v0
  v_lshlrev_b32 v254, 3, v32
  v_mov_b32 v33, 2130706432
  v_cmp_gt_u32 vcc, 160, v0
  s_nop 1
  v_cndmask_b32 v255, v33, v254, vcc
  v_add_u32 v4, s96, v2
  v_add_u32 v5, s96, v3
  s_add_u32 m0, s54, 16384
  s_nop 0
  buffer_load_dwordx4 v4, s[4:7], s48 offen offset:0 lds
  buffer_load_dwordx4 v5, s[4:7], s49 offen offset:1024 lds
  buffer_load_dwordx4 v4, s[4:7], s50 offen offset:2048 lds
  buffer_load_dwordx4 v5, s[4:7], s51 offen offset:3072 lds
  s_add_u32 s96, s96, 128
  s_cmp_eq_u32 s96, 1280
  s_cselect_b32 s96, 0, s96
  s_lshl_b32 s55, s97, 7
  v_add_u32 v13, s55, v12
  s_add_u32 m0, s58, 77824
  s_nop 0
  buffer_load_dwordx4 v13, s[16:19], s59 offen offset:0 lds
  buffer_load_dwordx4 v13, s[16:19], s60 offen offset:1024 lds
  buffer_load_dwordx4 v13, s[16:19], s61 offen offset:2048 lds
  buffer_load_dwordx4 v13, s[16:19], s62 offen offset:3072 lds
  s_add_u32 m0, s58, 81920
  s_nop 0
  buffer_load_dwordx4 v13, s[16:19], s63 offen lds
  s_add_u32 s97, s97, 1
  s_cmp_eq_u32 s97, 10
  s_cselect_b32 s97, 0, s97
  buffer_load_dword v211, v210, s[32:35], 0 offen sc1
  s_waitcnt vmcnt(22)
  ds_read_b128 a[0:3], v6 offset:0
  ds_read_b128 a[4:7], v7 offset:0
  ds_read_b128 a[8:11], v8 offset:0
  ds_read_b128 a[12:15], v9 offset:0
  s_waitcnt vmcnt(19)
  s_barrier
  ds_read_b128 a[160:163], v14 offset:0
  ds_read_b128 a[164:167], v14 offset:1024
  ds_read_b128 a[168:171], v14 offset:2048
  ds_read_b128 a[172:175], v14 offset:3072
  ds_read_b128 a[176:179], v14 offset:4096
  ds_read_b128 a[180:183], v15 offset:0
  ds_read_b128 a[184:187], v15 offset:1024
  ds_read_b128 a[188:191], v15 offset:2048
  ds_read_b128 a[192:195], v15 offset:3072
  s_waitcnt lgkmcnt(0)
  ds_read_b128 a[196:199], v15 offset:4096
  v_mfma_f32_32x32x16_bf16 v[40:55], a[0:3], a[160:163], 0
  ds_read_b128 a[200:203], v16 offset:0
  v_add_u32 v4, s96, v2
  v_add_u32 v5, s96, v3
  s_add_u32 m0, s54, 32768
  s_nop 0
  buffer_load_dwordx4 v4, s[4:7], s48 offen offset:0 lds
  s_lshl_b32 s44, s42, 10
  v_add_u32 v32, s44, v14
  ds_read_b128 a[240:243], v32
  v_mfma_f32_32x32x16_bf16 v[56:71], a[0:3], a[164:167], 0
  ds_read_b128 a[204:207], v16 offset:1024
  buffer_load_dwordx4 v5, s[4:7], s49 offen offset:1024 lds
  v_add_u32 v33, s44, v15
  ds_read_b128 a[244:247], v33
  v_add_u32 v34, s44, v16
  v_mfma_f32_32x32x16_bf16 v[72:87], a[0:3], a[168:171], 0
  ds_read_b128 a[208:211], v16 offset:2048
  buffer_load_dwordx4 v4, s[4:7], s50 offen offset:2048 lds
  ds_read_b128 a[248:251], v34
  v_add_u32 v35, s44, v17
  ds_read_b128 a[252:255], v35
  v_mfma_f32_32x32x16_bf16 v[88:103], a[0:3], a[172:175], 0
  ds_read_b128 a[212:215], v16 offset:3072
  buffer_load_dwordx4 v5, s[4:7], s51 offen offset:3072 lds
  s_add_u32 s96, s96, 128
  s_cmp_eq_u32 s96, 1280
  s_cselect_b32 s96, 0, s96
  ds_read_b128 a[220:223], v14 offset:4096
  ds_read_b128 a[224:227], v15 offset:4096
  ds_read_b128 a[228:231], v16 offset:4096
  v_mfma_f32_32x32x16_bf16 v[104:119], a[0:3], a[176:179], 0
  s_waitcnt lgkmcnt(11)
  ds_read_b128 a[216:219], v16 offset:4096
  s_lshl_b32 s55, s97, 7
  v_add_u32 v13, s55, v12
  s_add_u32 m0, s58, 98304
  s_nop 0
  buffer_load_dwordx4 v13, s[16:19], s59 offen offset:0 lds
  ds_read_b128 a[232:235], v17 offset:4096
  v_mov_b32 v201, 0
  v_mov_b32 v200, 0
  v_mfma_f32_32x32x16_bf16 v[40:55], a[4:7], a[180:183], v[40:55]
  ds_read_b128 a[160:163], v17 offset:0
  s_waitcnt vmcnt(11)
  ds_read_b128 a[16:19], v6 offset:16384
  s_waitcnt lgkmcnt(10)
  ds_read_b128 a[20:23], v7 offset:16384
  ds_read_b128 a[24:27], v8 offset:16384
  ds_read_b128 a[28:31], v9 offset:16384
  buffer_load_dwordx4 v13, s[16:19], s60 offen offset:1024 lds
  v_dot2c_f32_bf16 v201, v24, v216
  v_dot2c_f32_bf16 v200, v216, v216
  v_dot2c_f32_bf16 v201, v24, v217
  v_mfma_f32_32x32x16_bf16 v[56:71], a[4:7], a[184:187], v[56:71]
  ds_read_b128 a[164:167], v17 offset:1024
  buffer_load_dwordx4 v13, s[16:19], s61 offen offset:2048 lds
  v_dot2c_f32_bf16 v200, v217, v217
  v_dot2c_f32_bf16 v201, v24, v218
  v_dot2c_f32_bf16 v200, v218, v218
  v_mfma_f32_32x32x16_bf16 v[72:87], a[4:7], a[188:191], v[72:87]
  ds_read_b128 a[168:171], v17 offset:2048
  buffer_load_dwordx4 v13, s[16:19], s62 offen offset:3072 lds
  v_dot2c_f32_bf16 v201, v24, v219
  v_dot2c_f32_bf16 v200, v219, v219
  v_dot2c_f32_bf16 v201, v24, v220
  v_mfma_f32_32x32x16_bf16 v[88:103], a[4:7], a[192:195], v[88:103]
  s_waitcnt lgkmcnt(10)
  ds_read_b128 a[172:175], v17 offset:3072
  s_add_u32 m0, s58, 102400
  s_nop 0
  buffer_load_dwordx4 v13, s[16:19], s63 offen lds
  s_add_u32 s97, s97, 1
  s_cmp_eq_u32 s97, 10
  s_cselect_b32 s97, 0, s97
  v_dot2c_f32_bf16 v200, v220, v220
  v_dot2c_f32_bf16 v201, v24, v221
  v_dot2c_f32_bf16 v200, v221, v221
  v_mfma_f32_32x32x16_bf16 v[104:119], a[4:7], a[196:199], v[104:119]
  s_waitcnt lgkmcnt(9)
  ds_read_b128 a[176:179], v17 offset:4096
  v_dot2c_f32_bf16 v201, v24, v222
  v_dot2c_f32_bf16 v200, v222, v222
  v_dot2c_f32_bf16 v201, v24, v223
  v_mfma_f32_32x32x16_bf16 v[40:55], a[8:11], a[200:203], v[40:55]
  s_waitcnt vmcnt(10)
  s_barrier
  ds_read_b128 a[180:183], v14 offset:20480
  v_add_u32 v4, s96, v2
  v_add_u32 v5, s96, v3
  s_add_u32 m0, s54, 0
  s_nop 0
  buffer_load_dwordx4 v4, s[4:7], s48 offen offset:0 lds
  v_dot2c_f32_bf16 v200, v223, v223
  v_dot2c_f32_bf16 v201, v24, v224
  v_dot2c_f32_bf16 v200, v224, v224
  v_mfma_f32_32x32x16_bf16 v[56:71], a[8:11], a[204:207], v[56:71]
  ds_read_b128 a[184:187], v14 offset:21504
  v_dot2c_f32_bf16 v201, v24, v225
  v_dot2c_f32_bf16 v200, v225, v225
  s_nop 2
  v_mfma_f32_32x32x16_bf16 v[72:87], a[8:11], a[208:211], v[72:87]
  ds_read_b128 a[188:191], v14 offset:22528
  buffer_load_dwordx4 v5, s[4:7], s49 offen offset:1024 lds
  v_add_f32_dpp v201, v201, v201 quad_perm:[1,0,3,2] row_mask:0xf bank_mask:0xf
  v_add_f32_dpp v200, v200, v200 quad_perm:[1,0,3,2] row_mask:0xf bank_mask:0xf
  s_nop 0
  v_add_f32_dpp v201, v201, v201 quad_perm:[2,3,0,1] row_mask:0xf bank_mask:0xf
  v_mfma_f32_32x32x16_bf16 v[88:103], a[8:11], a[212:215], v[88:103]
  ds_read_b128 a[192:195], v14 offset:23552
  v_add_f32_dpp v200, v200, v200 quad_perm:[2,3,0,1] row_mask:0xf bank_mask:0xf
  v_add_f32_dpp v201, v201, v201 row_half_mirror row_mask:0xf bank_mask:0xf
  s_nop 0
  v_add_f32_dpp v200, v200, v200 row_half_mirror row_mask:0xf bank_mask:0xf
  v_mfma_f32_32x32x16_bf16 v[104:119], a[8:11], a[216:219], v[104:119]
  s_waitcnt lgkmcnt(4)
  ds_read_b128 a[196:199], v14 offset:24576
  buffer_load_dwordx4 v4, s[4:7], s50 offen offset:2048 lds
  v_add_f32_dpp v201, v201, v201 row_mirror row_mask:0xf bank_mask:0xf
  v_add_f32_dpp v200, v200, v200 row_mirror row_mask:0xf bank_mask:0xf
  s_nop 0
  v_add_f32_dpp v201, v201, v201 row_bcast:15 row_mask:0xa bank_mask:0xf
  v_mfma_f32_32x32x16_bf16 v[40:55], a[12:15], a[160:163], v[40:55]
  ds_read_b128 a[200:203], v15 offset:20480
  v_add_f32_dpp v200, v200, v200 row_bcast:15 row_mask:0xa bank_mask:0xf
  v_mul_f32 v201, 986500301, v201
  v_mul_f32 v200, 986500301, v200
  v_mfma_f32_32x32x16_bf16 v[56:71], a[12:15], a[164:167], v[56:71]
  ds_read_b128 a[204:207], v15 offset:21504
  buffer_load_dwordx4 v5, s[4:7], s51 offen offset:3072 lds
  s_add_u32 s96, s96, 128
  s_cmp_eq_u32 s96, 1280
  s_cselect_b32 s96, 0, s96
  v_fma_f32 v200, -v201, v201, v200
  v_max_f32 v200, 0, v200
  v_sub_f32 v201, 0, v201
  v_mfma_f32_32x32x16_bf16 v[72:87], a[12:15], a[168:171], v[72:87]
  ds_read_b128 a[208:211], v15 offset:22528
  s_lshl_b32 s55, s97, 7
  v_add_u32 v13, s55, v12
  s_add_u32 m0, s58, 118784
  s_nop 0
  buffer_load_dwordx4 v13, s[16:19], s59 offen offset:0 lds
  v_cvt_pk_bf16_f32 v201, v201, v201
  v_cvt_pk_bf16_f32 v200, v200, v200
  v_and_b32 v200, s52, v200
  v_mfma_f32_32x32x16_bf16 v[88:103], a[12:15], a[172:175], v[88:103]
  ds_read_b128 a[212:215], v15 offset:23552
  buffer_load_dwordx4 v13, s[16:19], s60 offen offset:1024 lds
  v_add_f32 v200, 925353388, v200
  v_cvt_pk_bf16_f32 v200, v200, v200
  v_and_b32 v200, s52, v200
  v_mfma_f32_32x32x16_bf16 v[104:119], a[12:15], a[176:179], v[104:119]
  s_waitcnt lgkmcnt(4)
  ds_read_b128 a[216:219], v15 offset:24576
  buffer_load_dwordx4 v13, s[16:19], s61 offen offset:2048 lds
  v_sqrt_f32 v200, v200
  s_nop 0
  v_cvt_pk_bf16_f32 v200, v200, v200
  v_mfma_f32_32x32x16_bf16 v[40:55], a[16:19], a[180:183], v[40:55]
  ds_read_b128 a[160:163], v16 offset:20480
  buffer_load_dwordx4 v13, s[16:19], s62 offen offset:3072 lds
  v_and_b32 v200, s52, v200
  v_rcp_f32 v200, v200
  v_mfma_f32_32x32x16_bf16 v[56:71], a[16:19], a[184:187], v[56:71]
  ds_read_b128 a[164:167], v16 offset:21504
  s_add_u32 m0, s58, 122880
  s_nop 0
  buffer_load_dwordx4 v13, s[16:19], s63 offen lds
  s_add_u32 s97, s97, 1
  s_cmp_eq_u32 s97, 10
  s_cselect_b32 s97, 0, s97
  v_and_b32 v216, 31, v1
  v_cmp_eq_u32 vcc, 16, v216
  v_lshrrev_b32 v216, 1, v1
  v_mfma_f32_32x32x16_bf16 v[72:87], a[16:19], a[188:191], v[72:87]
  ds_read_b128 a[168:171], v16 offset:22528
  v_and_b32 v216, 16, v216
  v_mov_b32 v217, 2130706432
  v_cndmask_b32 v216, v217, v216, vcc
  v_mfma_f32_32x32x16_bf16 v[88:103], a[16:19], a[192:195], v[88:103]
  ds_read_b128 a[172:175], v16 offset:23552
  v_add_u32 v4, s96, v2
  v_add_u32 v5, s96, v3
  s_add_u32 m0, s54, 16384
  s_nop 0
  buffer_load_dwordx4 v4, s[4:7], s48 offen offset:0 lds
  s_waitcnt vmcnt(19)
  v_cmp_eq_u32 vcc, 0, v211
  s_nop 3
  s_cbranch_vccnz Y_poll3_slow
Y_poll3_ret:
  v_readfirstlane_b32 s92, v211
  v_mfma_f32_32x32x16_bf16 v[104:119], a[16:19], a[196:199], v[104:119]
  s_waitcnt lgkmcnt(4)
  ds_read_b128 a[176:179], v16 offset:24576
  s_add_u32 s44, s43, 24
  s_mul_i32 s83, s44, 12800
  s_add_u32 s83, s83, 15499264
  v_mfma_f32_32x32x16_bf16 v[40:55], a[20:23], a[200:203], v[40:55]
  ds_read_b128 a[180:183], v17 offset:20480
  s_waitcnt vmcnt(15)
  ds_read_b128 a[32:35], v6 offset:32768
  ds_read_b128 a[36:39], v7 offset:32768
  ds_read_b128 a[40:43], v8 offset:32768
  ds_read_b128 a[44:47], v9 offset:32768
  buffer_load_dwordx4 v5, s[4:7], s49 offen offset:1024 lds
  s_mul_i32 s44, s99, 1280
  s_add_u32 s82, s83, s44
  s_lshl_b32 s44, s42, 8
  v_mfma_f32_32x32x16_bf16 v[56:71], a[20:23], a[204:207], v[56:71]
  ds_read_b128 a[184:187], v17 offset:21504
  s_add_u32 s82, s82, s44
  s_add_u32 s83, s83, s44
  s_cmp_lt_u32 s40, 10
  s_cselect_b32 s44, 32, 0
  v_mfma_f32_32x32x16_bf16 v[72:87], a[20:23], a[208:211], v[72:87]
  ds_read_b128 a[188:191], v17 offset:22528
  buffer_load_dwordx4 v4, s[4:7], s50 offen offset:2048 lds
  v_cmp_gt_u32 vcc, s44, v1
  v_lshlrev_b32 v36, 3, v1
  v_mfma_f32_32x32x16_bf16 v[88:103], a[20:23], a[212:215], v[88:103]
  ds_read_b128 a[192:195], v17 offset:23552
  v_mov_b32 v37, 2130706432
  v_cndmask_b32 v36, v37, v36, vcc
  v_mfma_f32_32x32x16_bf16 v[168:183], v[24:27], a[240:243], 0
  v_mfma_f32_32x32x16_bf16 v[104:119], a[20:23], a[216:219], v[104:119]
  s_waitcnt lgkmcnt(8)
  ds_read_b128 a[196:199], v17 offset:24576
  buffer_load_dwordx4 v5, s[4:7], s51 offen offset:3072 lds
  s_add_u32 s96, s96, 128
  s_cmp_eq_u32 s96, 1280
  s_cselect_b32 s96, 0, s96
  v_mfma_f32_32x32x16_bf16 v[168:183], v[24:27], a[244:247], v[168:183]
  v_mfma_f32_32x32x16_bf16 v[168:183], v[24:27], a[248:251], v[168:183]
  v_mfma_f32_32x32x16_bf16 v[168:183], v[24:27], a[252:255], v[168:183]
  v_mfma_f32_32x32x16_bf16 v[40:55], a[24:27], a[160:163], v[40:55]
  s_waitcnt vmcnt(13)
  s_barrier
  ds_read_b128 a[200:203], v14 offset:40960
  s_lshl_b32 s55, s97, 7
  v_add_u32 v13, s55, v12
  s_add_u32 m0, s58, 139264
  s_nop 0
  buffer_load_dwordx4 v13, s[16:19], s59 offen offset:0 lds
  v_mfma_f32_32x32x16_bf16 v[120:135], v[24:27], a[220:223], 0
  v_mfma_f32_32x32x16_bf16 v[120:135], v[24:27], a[224:227], v[120:135]
  v_mfma_f32_32x32x16_bf16 v[120:135], v[24:27], a[228:231], v[120:135]
  v_mfma_f32_32x32x16_bf16 v[56:71], a[24:27], a[164:167], v[56:71]
  ds_read_b128 a[204:207], v14 offset:41984
  buffer_load_dwordx4 v13, s[16:19], s60 offen offset:1024 lds
  v_mfma_f32_32x32x16_bf16 v[120:135], v[24:27], a[232:235], v[120:135]
  v_mfma_f32_32x32x16_bf16 v[72:87], a[24:27], a[168:171], v[72:87]
  ds_read_b128 a[208:211], v14 offset:43008
  buffer_load_dwordx4 v13, s[16:19], s61 offen offset:2048 lds
  v_mfma_f32_32x32x16_bf16 v[88:103], a[24:27], a[172:175], v[88:103]
  ds_read_b128 a[212:215], v14 offset:44032
  buffer_load_dwordx4 v13, s[16:19], s62 offen offset:3072 lds
  v_mfma_f32_32x32x16_bf16 v[104:119], a[24:27], a[176:179], v[104:119]
  s_waitcnt lgkmcnt(4)
  ds_read_b128 a[216:219], v14 offset:45056
  s_add_u32 m0, s58, 143360
  s_nop 0
  buffer_load_dwordx4 v13, s[16:19], s63 offen lds
  s_add_u32 s97, s97, 1
  s_cmp_eq_u32 s97, 10
  s_cselect_b32 s97, 0, s97
  v_mfma_f32_32x32x16_bf16 v[40:55], a[28:31], a[180:183], v[40:55]
  ds_read_b128 a[160:163], v15 offset:40960
  v_mfma_f32_32x32x16_bf16 v[56:71], a[28:31], a[184:187], v[56:71]
  ds_read_b128 a[164:167], v15 offset:41984
  s_lshl_b32 s55, s97, 7
  v_add_u32 v13, s55, v12
  s_add_u32 m0, s58, 57344
  s_nop 0
  buffer_load_dwordx4 v13, s[16:19], s59 offen offset:0 lds
  v_mfma_f32_32x32x16_bf16 v[72:87], a[28:31], a[188:191], v[72:87]
  ds_read_b128 a[168:171], v15 offset:43008
  v_mfma_f32_32x32x16_bf16 v[88:103], a[28:31], a[192:195], v[88:103]
  ds_read_b128 a[172:175], v15 offset:44032
  buffer_load_dwordx4 v13, s[16:19], s60 offen offset:1024 lds
  v_mfma_f32_32x32x16_bf16 v[104:119], a[28:31], a[196:199], v[104:119]
  s_waitcnt lgkmcnt(4)
  ds_read_b128 a[176:179], v15 offset:45056
  v_mfma_f32_32x32x16_bf16 v[40:55], a[32:35], a[200:203], v[40:55]
  ds_read_b128 a[180:183], v16 offset:40960
  buffer_load_dwordx4 v13, s[16:19], s61 offen offset:2048 lds
  v_mfma_f32_32x32x16_bf16 v[56:71], a[32:35], a[204:207], v[56:71]
  ds_read_b128 a[184:187], v16 offset:41984
  v_mfma_f32_32x32x16_bf16 v[72:87], a[32:35], a[208:211], v[72:87]
  ds_read_b128 a[188:191], v16 offset:43008
  buffer_load_dwordx4 v13, s[16:19], s62 offen offset:3072 lds
  v_mfma_f32_32x32x16_bf16 v[88:103], a[32:35], a[212:215], v[88:103]
  ds_read_b128 a[192:195], v16 offset:44032
  v_mfma_f32_32x32x16_bf16 v[104:119], a[32:35], a[216:219], v[104:119]
  s_waitcnt lgkmcnt(4)
  ds_read_b128 a[196:199], v16 offset:45056
  s_add_u32 m0, s58, 61440
  s_nop 0
  buffer_load_dwordx4 v13, s[16:19], s63 offen lds
  s_add_u32 s97, s97, 1
  s_cmp_eq_u32 s97, 10
  s_cselect_b32 s97, 0, s97
  v_mfma_f32_32x32x16_bf16 v[40:55], a[36:39], a[160:163], v[40:55]
  ds_read_b128 a[200:203], v17 offset:40960
  s_waitcnt vmcnt(19)
  ds_read_b128 a[48:51], v6 offset:0
  ds_read_b128 a[52:55], v7 offset:0
  ds_read_b128 a[56:59], v8 offset:0
  ds_read_b128 a[60:63], v9 offset:0
  v_mfma_f32_32x32x16_bf16 v[56:71], a[36:39], a[164:167], v[56:71]
  ds_read_b128 a[204:207], v17 offset:41984
  v_add_u32 v4, s96, v2
  v_add_u32 v5, s96, v3
  s_add_u32 m0, s54, 32768
  s_nop 0
  buffer_load_dwordx4 v4, s[4:7], s48 offen offset:0 lds
  v_mfma_f32_32x32x16_bf16 v[72:87], a[36:39], a[168:171], v[72:87]
  ds_read_b128 a[208:211], v17 offset:43008
  v_mfma_f32_32x32x16_bf16 v[88:103], a[36:39], a[172:175], v[88:103]
  ds_read_b128 a[212:215], v17 offset:44032
  buffer_load_dwordx4 v5, s[4:7], s49 offen offset:1024 lds
  v_mfma_f32_32x32x16_bf16 v[104:119], a[36:39], a[176:179], v[104:119]
  s_waitcnt lgkmcnt(8)
  ds_read_b128 a[216:219], v17 offset:45056
  v_mfma_f32_32x32x16_bf16 v[40:55], a[40:43], a[180:183], v[40:55]
  s_waitcnt vmcnt(16)
  s_barrier
  v_add_u32 v14, 61440, v14
  v_add_u32 v15, 61440, v15
  v_add_u32 v16, 61440, v16
  v_add_u32 v17, 61440, v17
  ds_read_b128 a[160:163], v14 offset:0
  buffer_load_dwordx4 v4, s[4:7], s50 offen offset:2048 lds
  v_mov_b32 v202, s92
  v_mov_b32 v203, s92
  v_mfma_f32_32x32x16_bf16 v[56:71], a[40:43], a[184:187], v[56:71]
  ds_read_b128 a[164:167], v14 offset:1024
  buffer_store_dwordx4 v[200:203], v216, s[20:23], s101 offen sc1
  v_mov_b32 v169, s92
  v_mov_b32 v121, s92
  v_mfma_f32_32x32x16_bf16 v[72:87], a[40:43], a[188:191], v[72:87]
  ds_read_b128 a[168:171], v14 offset:2048
  buffer_load_dwordx4 v5, s[4:7], s51 offen offset:3072 lds
  s_add_u32 s96, s96, 128
  s_cmp_eq_u32 s96, 1280
  s_cselect_b32 s96, 0, s96
  v_mfma_f32_32x32x16_bf16 v[88:103], a[40:43], a[192:195], v[88:103]
  ds_read_b128 a[172:175], v14 offset:3072
  buffer_store_dwordx2 v[168:169], v36, s[20:23], s82 offen sc1
  s_lshl_b32 s44, s42, 8
  s_sub_u32 s44, s82, s44
  v_mfma_f32_32x32x16_bf16 v[104:119], a[40:43], a[196:199], v[104:119]
  s_waitcnt lgkmcnt(4)
  ds_read_b128 a[176:179], v14 offset:4096
  s_lshl_b32 s55, s97, 7
  v_add_u32 v13, s55, v12
  s_add_u32 m0, s58, 77824
  s_nop 0
  buffer_load_dwordx4 v13, s[16:19], s59 offen offset:0 lds
  v_mfma_f32_32x32x16_bf16 v[40:55], a[44:47], a[200:203], v[40:55]
  ds_read_b128 a[180:183], v15 offset:0
  buffer_store_dwordx2 v[120:121], v36, s[20:23], s44 offen offset:1024 sc1
  s_add_u32 s44, s40, 16
  s_mul_i32 s44, s44, 1280
  v_mfma_f32_32x32x16_bf16 v[56:71], a[44:47], a[204:207], v[56:71]
  ds_read_b128 a[184:187], v15 offset:1024
  buffer_load_dwordx4 v13, s[16:19], s60 offen offset:1024 lds
  v_mfma_f32_32x32x16_bf16 v[72:87], a[44:47], a[208:211], v[72:87]
  ds_read_b128 a[188:191], v15 offset:2048
  buffer_store_dwordx2 v[210:211], v255, s[36:39], s44 offen sc1
  v_lshlrev_b32 v137, 16, v137
  v_lshlrev_b32 v138, 16, v138
  v_lshlrev_b32 v139, 16, v139
  v_mul_f32 v139, 1069066811, v139
  v_mfma_f32_32x32x16_bf16 v[88:103], a[44:47], a[212:215], v[88:103]
  ds_read_b128 a[192:195], v15 offset:3072
  buffer_load_dwordx4 v13, s[16:19], s61 offen offset:2048 lds
  v_exp_f32 v139, v139
  s_nop 0
  v_cvt_pk_bf16_f32 v139, v139, v139
  v_mfma_f32_32x32x16_bf16 v[104:119], a[44:47], a[216:219], v[104:119]
  s_waitcnt lgkmcnt(4)
  ds_read_b128 a[196:199], v15 offset:4096
  v_and_b32 v139, s52, v139
  v_mul_f32 v140, v139, v137
  v_mul_f32 v141, v139, v138
  v_mfma_f32_32x32x16_bf16 v[40:55], a[48:51], a[160:163], v[40:55]
  ds_read_b128 a[200:203], v16 offset:0
  buffer_load_dwordx4 v13, s[16:19], s62 offen offset:3072 lds
  v_mul_f32 v140, 1069066811, v140
  v_mul_f32 v141, 1042479491, v141
  v_exp_f32 v152, v140
  v_mfma_f32_32x32x16_bf16 v[56:71], a[48:51], a[164:167], v[56:71]
  ds_read_b128 a[204:207], v16 offset:1024
  v_fract_f32 v153, v141
  v_cos_f32 v154, v153
  v_mfma_f32_32x32x16_bf16 v[72:87], a[48:51], a[168:171], v[72:87]
  ds_read_b128 a[208:211], v16 offset:2048
  s_add_u32 m0, s58, 81920
  s_nop 0
  buffer_load_dwordx4 v13, s[16:19], s63 offen lds
  s_add_u32 s97, s97, 1
  s_cmp_eq_u32 s97, 10
  s_cselect_b32 s97, 0, s97
  v_sin_f32 v155, v153
  v_mfma_f32_32x32x16_bf16 v[88:103], a[48:51], a[172:175], v[88:103]
  ds_read_b128 a[212:215], v16 offset:3072
  v_mul_f32 v144, v152, v154
  v_mul_f32 v145, v152, v155
  v_mul_f32 v152, 1098907648, v140
  v_mfma_f32_32x32x16_bf16 v[104:119], a[48:51], a[176:179], v[104:119]
  s_waitcnt lgkmcnt(4)
  ds_read_b128 a[216:219], v16 offset:4096
  v_add_u32 v4, s96, v2
  v_add_u32 v5, s96, v3
  s_add_u32 m0, s54, 0
  s_nop 0
  buffer_load_dwordx4 v4, s[4:7], s48 offen offset:0 lds
  v_mul_f32 v153, 1098907648, v141
  v_exp_f32 v152, v152
  v_mfma_f32_32x32x16_bf16 v[40:55], a[52:55], a[180:183], v[40:55]
  ds_read_b128 a[160:163], v17 offset:0
  s_waitcnt vmcnt(24)
  ds_read_b128 a[64:67], v6 offset:16384
  ds_read_b128 a[68:71], v7 offset:16384
  ds_read_b128 a[72:75], v8 offset:16384
  ds_read_b128 a[76:79], v9 offset:16384
  v_fract_f32 v153, v153
  v_cos_f32 v154, v153
  v_mfma_f32_32x32x16_bf16 v[56:71], a[52:55], a[184:187], v[56:71]
  ds_read_b128 a[164:167], v17 offset:1024
  buffer_load_dwordx4 v5, s[4:7], s49 offen offset:1024 lds
  v_sin_f32 v155, v153
  v_mul_f32 v146, v152, v154
  v_mfma_f32_32x32x16_bf16 v[72:87], a[52:55], a[188:191], v[72:87]
  ds_read_b128 a[168:171], v17 offset:2048
  v_mul_f32 v147, v152, v155
  v_mul_f32 v152, 1124073472, v140
  v_mul_f32 v153, 1124073472, v141
  v_mfma_f32_32x32x16_bf16 v[88:103], a[52:55], a[192:195], v[88:103]
  ds_read_b128 a[172:175], v17 offset:3072
  buffer_load_dwordx4 v4, s[4:7], s50 offen offset:2048 lds
  v_exp_f32 v152, v152
  v_fract_f32 v153, v153
  v_mfma_f32_32x32x16_bf16 v[104:119], a[52:55], a[196:199], v[104:119]
  s_waitcnt lgkmcnt(8)
  ds_read_b128 a[176:179], v17 offset:4096
  v_cos_f32 v154, v153
  v_sin_f32 v155, v153
  v_mfma_f32_32x32x16_bf16 v[40:55], a[56:59], a[200:203], v[40:55]
  s_waitcnt vmcnt(21)
  s_barrier
  ds_read_b128 a[180:183], v14 offset:20480
  buffer_load_dwordx4 v5, s[4:7], s51 offen offset:3072 lds
  s_add_u32 s96, s96, 128
  s_cmp_eq_u32 s96, 1280
  s_cselect_b32 s96, 0, s96
  s_and_b32 s78, s40, 11
  v_mul_f32 v148, v152, v154
  v_mul_f32 v149, v152, v155
  v_mfma_f32_32x32x16_bf16 v[56:71], a[56:59], a[204:207], v[56:71]
  ds_read_b128 a[184:187], v14 offset:21504
  s_and_b32 s85, s41, 4
  s_or_b32 s78, s78, s85
  v_and_b32 v136, 1, v0
  v_lshlrev_b32 v136, 31, v136
  v_xor_b32 v136, 0x80000000, v136
  v_mfma_f32_32x32x16_bf16 v[72:87], a[56:59], a[208:211], v[72:87]
  ds_read_b128 a[188:191], v14 offset:22528
  s_lshl_b32 s55, s97, 7
  v_add_u32 v13, s55, v12
  s_add_u32 m0, s58, 98304
  s_nop 0
  buffer_load_dwordx4 v13, s[16:19], s59 offen offset:0 lds
  s_and_b32 s79, s41, 3
  v_xor_b32 v145, v136, v145
  v_xor_b32 v147, v136, v147
  v_xor_b32 v149, v136, v149
  v_mfma_f32_32x32x16_bf16 v[88:103], a[56:59], a[212:215], v[88:103]
  ds_read_b128 a[192:195], v14 offset:23552
  s_lshl_b32 s79, s79, 1
  ds_write_b64 v252, v[144:145] offset:49152
  ds_write_b128 v252, v[146:149] offset:49168
  v_mfma_f32_32x32x16_bf16 v[104:119], a[56:59], a[216:219], v[104:119]
  s_waitcnt lgkmcnt(6)
  ds_read_b128 a[196:199], v14 offset:24576
  buffer_load_dwordx4 v13, s[16:19], s60 offen offset:1024 lds
  s_bfe_u32 s85, s40, 0x10002
  s_add_u32 s79, s79, s85
  v_mfma_f32_32x32x16_bf16 v[40:55], a[60:63], a[160:163], v[40:55]
  ds_read_b128 a[200:203], v15 offset:20480
  s_and_b32 s85, s41, 8
  v_mfma_f32_32x32x16_bf16 v[56:71], a[60:63], a[164:167], v[56:71]
  ds_read_b128 a[204:207], v15 offset:21504
  buffer_load_dwordx4 v13, s[16:19], s61 offen offset:2048 lds
  s_add_u32 s79, s79, s85
  v_mfma_f32_32x32x16_bf16 v[72:87], a[60:63], a[168:171], v[72:87]
  ds_read_b128 a[208:211], v15 offset:22528
  s_lshr_b32 s86, s79, 3
  s_lshl_b32 s85, s86, 2
  v_mfma_f32_32x32x16_bf16 v[88:103], a[60:63], a[172:175], v[88:103]
  ds_read_b128 a[212:215], v15 offset:23552
  buffer_load_dwordx4 v13, s[16:19], s62 offen offset:3072 lds
  s_add_u32 s85, s85, s42
  v_mfma_f32_32x32x16_bf16 v[104:119], a[60:63], a[176:179], v[104:119]
  s_waitcnt lgkmcnt(4)
  ds_read_b128 a[216:219], v15 offset:24576
  s_and_b32 s87, s79, 7
  s_mul_i32 s87, s87, 5
  v_mfma_f32_32x32x16_bf16 v[40:55], a[64:67], a[180:183], v[40:55]
  ds_read_b128 a[160:163], v16 offset:20480
  s_add_u32 m0, s58, 102400
  s_nop 0
  buffer_load_dwordx4 v13, s[16:19], s63 offen lds
  s_add_u32 s97, s97, 1
  s_cmp_eq_u32 s97, 10
  s_cselect_b32 s97, 0, s97
  s_mov_b32 s69, 15941632
  v_mfma_f32_32x32x16_bf16 v[56:71], a[64:67], a[184:187], v[56:71]
  ds_read_b128 a[164:167], v16 offset:21504
  s_mul_i32 s88, s85, 6
  v_mfma_f32_32x32x16_bf16 v[72:87], a[64:67], a[188:191], v[72:87]
  ds_read_b128 a[168:171], v16 offset:22528
  v_add_u32 v4, s96, v2
  v_add_u32 v5, s96, v3
  s_add_u32 m0, s54, 16384
  s_nop 0
  buffer_load_dwordx4 v4, s[4:7], s48 offen offset:0 lds
  s_mul_i32 s85, s85, 5
  s_sub_u32 s84, s87, 6
  v_mfma_f32_32x32x16_bf16 v[88:103], a[64:67], a[192:195], v[88:103]
  ds_read_b128 a[172:175], v16 offset:23552
  v_min_u32 v250, 21, v1
  v_mfma_f32_32x32x16_bf16 v[104:119], a[64:67], a[196:199], v[104:119]
  s_waitcnt lgkmcnt(4)
  ds_read_b128 a[176:179], v16 offset:24576
  buffer_load_dwordx4 v5, s[4:7], s49 offen offset:1024 lds
  v_cmp_gt_u32 s[64:65], 12, v250
  v_mfma_f32_32x32x16_bf16 v[40:55], a[68:71], a[200:203], v[40:55]
  ds_read_b128 a[180:183], v17 offset:20480
  s_waitcnt vmcnt(19)
  ds_read_b128 a[80:83], v6 offset:32768
  ds_read_b128 a[84:87], v7 offset:32768
  ds_read_b128 a[88:91], v8 offset:32768
  ds_read_b128 a[92:95], v9 offset:32768
  v_mov_b32 v248, s84
  v_mov_b32 v249, s88
  v_mfma_f32_32x32x16_bf16 v[56:71], a[68:71], a[204:207], v[56:71]
  ds_read_b128 a[184:187], v17 offset:21504
  buffer_load_dwordx4 v4, s[4:7], s50 offen offset:2048 lds
  v_cndmask_b32 v248, v248, v249, s[64:65]
  v_mfma_f32_32x32x16_bf16 v[72:87], a[68:71], a[208:211], v[72:87]
  ds_read_b128 a[188:191], v17 offset:22528
  v_mov_b32 v249, s85
  v_mfma_f32_32x32x16_bf16 v[88:103], a[68:71], a[212:215], v[88:103]
  ds_read_b128 a[192:195], v17 offset:23552
  buffer_load_dwordx4 v5, s[4:7], s51 offen offset:3072 lds
  s_add_u32 s96, s96, 128
  s_cmp_eq_u32 s96, 1280
  s_cselect_b32 s96, 0, s96
  v_mov_b32 v243, s87
  v_cndmask_b32 v249, v249, v243, s[64:65]
  v_mfma_f32_32x32x16_bf16 v[104:119], a[68:71], a[216:219], v[104:119]
  s_waitcnt lgkmcnt(8)
  ds_read_b128 a[196:199], v17 offset:24576
  v_lshrrev_b32 v243, 1, v250
  v_mfma_f32_32x32x16_bf16 v[40:55], a[72:75], a[160:163], v[40:55]
  s_barrier
  v_add_u32 v14, 4294905856, v14
  v_add_u32 v15, 4294905856, v15
  v_add_u32 v16, 4294905856, v16
  v_add_u32 v17, 4294905856, v17
  ds_read_b128 a[200:203], v14 offset:0
  s_lshl_b32 s55, s97, 7
  v_add_u32 v13, s55, v12
  s_add_u32 m0, s58, 118784
  s_nop 0
  buffer_load_dwordx4 v13, s[16:19], s59 offen offset:0 lds
  v_add_u32 v248, v248, v243
  v_mfma_f32_32x32x16_bf16 v[56:71], a[72:75], a[164:167], v[56:71]
  ds_read_b128 a[204:207], v14 offset:1024
  v_and_b32 v250, 1, v250
  v_lshl_add_u32 v249, v250, 2, v249
  v_mfma_f32_32x32x16_bf16 v[72:87], a[72:75], a[168:171], v[72:87]
  ds_read_b128 a[208:211], v14 offset:2048
  buffer_load_dwordx4 v13, s[16:19], s60 offen offset:1024 lds
  v_lshrrev_b32 v249, 2, v249
  v_mfma_f32_32x32x16_bf16 v[88:103], a[72:75], a[172:175], v[88:103]
  ds_read_b128 a[212:215], v14 offset:3072
  v_mad_u32_u24 v248, v248, 10, v249
  v_mfma_f32_32x32x16_bf16 v[104:119], a[72:75], a[176:179], v[104:119]
  s_waitcnt lgkmcnt(4)
  ds_read_b128 a[216:219], v14 offset:4096
  buffer_load_dwordx4 v13, s[16:19], s61 offen offset:2048 lds
  v_lshrrev_b32 v248, 2, v248
  v_lshlrev_b32 v248, 7, v248
  v_mfma_f32_32x32x16_bf16 v[40:55], a[76:79], a[180:183], v[40:55]
  ds_read_b128 a[160:163], v15 offset:0
  s_lshr_b32 s86, s79, 3
  v_mfma_f32_32x32x16_bf16 v[56:71], a[76:79], a[184:187], v[56:71]
  ds_read_b128 a[164:167], v15 offset:1024
  buffer_load_dwordx4 v13, s[16:19], s62 offen offset:3072 lds
  s_lshl_b32 s85, s86, 2
  v_mfma_f32_32x32x16_bf16 v[72:87], a[76:79], a[188:191], v[72:87]
  ds_read_b128 a[168:171], v15 offset:2048
  s_add_u32 s85, s85, s42
  s_mul_i32 s85, s85, 11
  v_mfma_f32_32x32x16_bf16 v[88:103], a[76:79], a[192:195], v[88:103]
  ds_read_b128 a[172:175], v15 offset:3072
  s_add_u32 m0, s58, 122880
  s_nop 0
  buffer_load_dwordx4 v13, s[16:19], s63 offen lds
  s_add_u32 s97, s97, 1
  s_cmp_eq_u32 s97, 10
  s_cselect_b32 s97, 0, s97
  s_and_b32 s87, s79, 7
  v_mfma_f32_32x32x16_bf16 v[104:119], a[76:79], a[196:199], v[104:119]
  s_waitcnt lgkmcnt(4)
  ds_read_b128 a[176:179], v15 offset:4096
  s_mul_i32 s87, s87, 88
  s_add_u32 s87, s87, s85
  v_mfma_f32_32x32x16_bf16 v[40:55], a[80:83], a[200:203], v[40:55]
  ds_read_b128 a[180:183], v16 offset:0
  v_add_u32 v4, s96, v2
  v_add_u32 v5, s96, v3
  s_add_u32 m0, s54, 32768
  s_nop 0
  buffer_load_dwordx4 v4, s[4:7], s48 offen offset:0 lds
  s_mul_i32 s66, s87, 5120
  v_mfma_f32_32x32x16_bf16 v[56:71], a[80:83], a[204:207], v[56:71]
  ds_read_b128 a[184:187], v16 offset:1024
  s_add_u32 s66, s66, 11534336
  v_mfma_f32_32x32x16_bf16 v[72:87], a[80:83], a[208:211], v[72:87]
  ds_read_b128 a[188:191], v16 offset:2048
  buffer_load_dwordx4 v5, s[4:7], s49 offen offset:1024 lds
  s_lshl_b32 s87, s78, 1
  s_add_u32 s88, s87, s86
  v_mfma_f32_32x32x16_bf16 v[88:103], a[80:83], a[212:215], v[88:103]
  ds_read_b128 a[192:195], v16 offset:3072
  s_mul_i32 s88, s88, 88
  v_mfma_f32_32x32x16_bf16 v[104:119], a[80:83], a[216:219], v[104:119]
  s_waitcnt lgkmcnt(4)
  ds_read_b128 a[196:199], v16 offset:4096
  buffer_load_dwordx4 v4, s[4:7], s50 offen offset:2048 lds
  s_add_u32 s88, s88, s85
  v_mfma_f32_32x32x16_bf16 v[40:55], a[84:87], a[160:163], v[40:55]
  ds_read_b128 a[200:203], v17 offset:0
  s_waitcnt vmcnt(17)
  ds_read_b128 a[96:99], v6 offset:0
  ds_read_b128 a[100:103], v7 offset:0
  ds_read_b128 a[104:107], v8 offset:0
  ds_read_b128 a[108:111], v9 offset:0
  s_lshl_b32 s67, s88, 12
  s_xor_b32 s86, s86, 1
  v_mfma_f32_32x32x16_bf16 v[56:71], a[84:87], a[164:167], v[56:71]
  ds_read_b128 a[204:207], v17 offset:1024
  buffer_load_dwordx4 v5, s[4:7], s51 offen offset:3072 lds
  s_add_u32 s96, s96, 128
  s_cmp_eq_u32 s96, 1280
  s_cselect_b32 s96, 0, s96
  s_add_u32 s88, s87, s86
  v_mfma_f32_32x32x16_bf16 v[72:87], a[84:87], a[168:171], v[72:87]
  ds_read_b128 a[208:211], v17 offset:2048
  s_mul_i32 s88, s88, 88
  v_mfma_f32_32x32x16_bf16 v[88:103], a[84:87], a[172:175], v[88:103]
  ds_read_b128 a[212:215], v17 offset:3072
  s_add_u32 s88, s88, s85
  s_lshl_b32 s68, s88, 12
  v_mfma_f32_32x32x16_bf16 v[104:119], a[84:87], a[176:179], v[104:119]
  s_waitcnt lgkmcnt(8)
  ds_read_b128 a[216:219], v17 offset:4096
  s_lshl_b32 s88, s42, 10
  v_mfma_f32_32x32x16_bf16 v[40:55], a[88:91], a[180:183], v[40:55]
  s_barrier
  ds_read_b128 a[160:163], v14 offset:20480
  s_lshl_b32 s55, s97, 7
  v_add_u32 v13, s55, v12
  s_add_u32 m0, s58, 139264
  s_nop 0
  buffer_load_dwordx4 v13, s[16:19], s59 offen offset:0 lds
  s_lshl_b32 s87, s40, 11
  s_lshl_b32 s86, s42, 9
  v_mfma_f32_32x32x16_bf16 v[56:71], a[88:91], a[184:187], v[56:71]
  ds_read_b128 a[164:167], v14 offset:21504
  s_add_u32 s87, s87, s86
  s_add_u32 s100, s87, 15138816
  buffer_load_dwordx4 v[28:31], v212, s[20:23], s100 offen sc1
  v_mfma_f32_32x32x16_bf16 v[72:87], a[88:91], a[188:191], v[72:87]
  ds_read_b128 a[168:171], v14 offset:22528
  buffer_load_dwordx4 v13, s[16:19], s60 offen offset:1024 lds
  v_lshrrev_b32 v209, 5, v1
  v_mul_u32_u24 v209, 6400, v209
  v_and_b32 v37, 31, v1
  v_mfma_f32_32x32x16_bf16 v[88:103], a[88:91], a[192:195], v[88:103]
  ds_read_b128 a[172:175], v14 offset:23552
  v_lshl_add_u32 v209, v37, 3, v209
  s_add_u32 s82, s83, 3840
  v_mfma_f32_32x32x16_bf16 v[104:119], a[88:91], a[196:199], v[104:119]
  s_waitcnt lgkmcnt(4)
  ds_read_b128 a[176:179], v14 offset:24576
  buffer_load_dwordx4 v13, s[16:19], s61 offen offset:2048 lds
  s_lshl_b32 s86, s42, 8
  s_sub_u32 s86, 1024, s86
  v_add_u32 v22, s86, v209
  v_mfma_f32_32x32x16_bf16 v[40:55], a[92:95], a[200:203], v[40:55]
  ds_read_b128 a[180:183], v15 offset:20480
  buffer_load_dwordx2 v[120:121], v209, s[20:23], s83 offen offset:0 sc1
  v_mfma_f32_32x32x16_bf16 v[56:71], a[92:95], a[204:207], v[56:71]
  ds_read_b128 a[184:187], v15 offset:21504
  buffer_load_dwordx4 v13, s[16:19], s62 offen offset:3072 lds
  v_mfma_f32_32x32x16_bf16 v[72:87], a[92:95], a[208:211], v[72:87]
  ds_read_b128 a[188:191], v15 offset:22528
  buffer_load_dwordx2 v[122:123], v209, s[20:23], s83 offen offset:1280 sc1
  v_mfma_f32_32x32x16_bf16 v[88:103], a[92:95], a[212:215], v[88:103]
  ds_read_b128 a[192:195], v15 offset:23552
  s_add_u32 m0, s58, 143360
  s_nop 0
  buffer_load_dwordx4 v13, s[16:19], s63 offen lds
  s_add_u32 s97, s97, 1
  s_cmp_eq_u32 s97, 10
  s_cselect_b32 s97, 0, s97
  v_mfma_f32_32x32x16_bf16 v[104:119], a[92:95], a[216:219], v[104:119]
  s_waitcnt lgkmcnt(4)
  ds_read_b128 a[196:199], v15 offset:24576
  buffer_load_dwordx2 v[124:125], v209, s[20:23], s83 offen offset:2560 sc1
  v_mfma_f32_32x32x16_bf16 v[40:55], a[96:99], a[160:163], v[40:55]
  ds_read_b128 a[200:203], v16 offset:20480
  v_add_u32 v4, s96, v2
  v_add_u32 v5, s96, v3
  s_add_u32 m0, s54, 0
  s_nop 0
  buffer_load_dwordx4 v4, s[4:7], s48 offen offset:0 lds
  v_mfma_f32_32x32x16_bf16 v[56:71], a[96:99], a[164:167], v[56:71]
  ds_read_b128 a[204:207], v16 offset:21504
  buffer_load_dwordx2 v[126:127], v209, s[20:23], s82 offen offset:0 sc1
  v_mfma_f32_32x32x16_bf16 v[72:87], a[96:99], a[168:171], v[72:87]
  ds_read_b128 a[208:211], v16 offset:22528
  buffer_load_dwordx4 v5, s[4:7], s49 offen offset:1024 lds
  v_mfma_f32_32x32x16_bf16 v[88:103], a[96:99], a[172:175], v[88:103]
  ds_read_b128 a[212:215], v16 offset:23552
  buffer_load_dwordx2 v[128:129], v209, s[20:23], s82 offen offset:1280 sc1
  v_mfma_f32_32x32x16_bf16 v[104:119], a[96:99], a[176:179], v[104:119]
  s_waitcnt lgkmcnt(4)
  ds_read_b128 a[216:219], v16 offset:24576
  buffer_load_dwordx4 v4, s[4:7], s50 offen offset:2048 lds
  v_mfma_f32_32x32x16_bf16 v[40:55], a[100:103], a[180:183], v[40:55]
  ds_read_b128 a[160:163], v17 offset:20480
  s_waitcnt vmcnt(23)
  ds_read_b128 a[112:115], v6 offset:16384
  ds_read_b128 a[116:119], v7 offset:16384
  ds_read_b128 a[120:123], v8 offset:16384
  ds_read_b128 a[124:127], v9 offset:16384
  buffer_load_dwordx2 v[130:131], v22, s[20:23], s83 offen offset:0 sc1
  v_mfma_f32_32x32x16_bf16 v[56:71], a[100:103], a[184:187], v[56:71]
  ds_read_b128 a[164:167], v17 offset:21504
  buffer_load_dwordx4 v5, s[4:7], s51 offen offset:3072 lds
  s_add_u32 s96, s96, 128
  s_cmp_eq_u32 s96, 1280
  s_cselect_b32 s96, 0, s96
  v_mfma_f32_32x32x16_bf16 v[72:87], a[100:103], a[188:191], v[72:87]
  ds_read_b128 a[168:171], v17 offset:22528
  buffer_load_dwordx2 v[132:133], v22, s[20:23], s83 offen offset:1280 sc1
  v_mfma_f32_32x32x16_bf16 v[88:103], a[100:103], a[192:195], v[88:103]
  ds_read_b128 a[172:175], v17 offset:23552
  buffer_load_dwordx2 v[134:135], v22, s[20:23], s83 offen offset:2560 sc1
  v_mfma_f32_32x32x16_bf16 v[104:119], a[100:103], a[196:199], v[104:119]
  s_waitcnt lgkmcnt(8)
  ds_read_b128 a[176:179], v17 offset:24576
  buffer_load_dwordx2 v[136:137], v22, s[20:23], s82 offen offset:0 sc1
  v_mfma_f32_32x32x16_bf16 v[40:55], a[104:107], a[200:203], v[40:55]
  s_barrier
  ds_read_b128 a[180:183], v14 offset:40960
  s_mul_i32 s55, s97, 196608
  s_add_u32 s55, s55, s98
  s_add_u32 s56, s55, 22528
  s_add_u32 m0, s54, 57344
  s_nop 0
  buffer_load_dwordx4 v10, s[8:11], s55 offen lds
  v_mfma_f32_32x32x16_bf16 v[56:71], a[104:107], a[204:207], v[56:71]
  ds_read_b128 a[184:187], v14 offset:41984
  buffer_load_dwordx2 v[138:139], v22, s[20:23], s82 offen offset:1280 sc1
  v_mfma_f32_32x32x16_bf16 v[72:87], a[104:107], a[208:211], v[72:87]
  ds_read_b128 a[188:191], v14 offset:43008
  buffer_load_dwordx4 v11, s[12:15], s55 offen offset:1024 lds
  v_mfma_f32_32x32x16_bf16 v[88:103], a[104:107], a[212:215], v[88:103]
  ds_read_b128 a[192:195], v14 offset:44032
  v_mfma_f32_32x32x16_bf16 v[104:119], a[104:107], a[216:219], v[104:119]
  s_waitcnt lgkmcnt(4)
  ds_read_b128 a[196:199], v14 offset:45056
  buffer_load_dwordx4 v10, s[8:11], s56 offen offset:2048 lds
  v_mfma_f32_32x32x16_bf16 v[40:55], a[108:111], a[160:163], v[40:55]
  ds_read_b128 a[200:203], v15 offset:40960
  v_mfma_f32_32x32x16_bf16 v[56:71], a[108:111], a[164:167], v[56:71]
  ds_read_b128 a[204:207], v15 offset:41984
  buffer_load_dwordx4 v11, s[12:15], s56 offen offset:3072 lds
  s_add_u32 s97, s97, 1
  s_cmp_eq_u32 s97, 10
  s_cselect_b32 s97, 0, s97
  v_mfma_f32_32x32x16_bf16 v[72:87], a[108:111], a[168:171], v[72:87]
  ds_read_b128 a[208:211], v15 offset:43008
  v_mfma_f32_32x32x16_bf16 v[88:103], a[108:111], a[172:175], v[88:103]
  ds_read_b128 a[212:215], v15 offset:44032
  v_mfma_f32_32x32x16_bf16 v[104:119], a[108:111], a[176:179], v[104:119]
  s_waitcnt lgkmcnt(4)
  ds_read_b128 a[216:219], v15 offset:45056
  v_mfma_f32_32x32x16_bf16 v[40:55], a[112:115], a[180:183], v[40:55]
  ds_read_b128 a[160:163], v16 offset:40960
  v_mfma_f32_32x32x16_bf16 v[56:71], a[112:115], a[184:187], v[56:71]
  ds_read_b128 a[164:167], v16 offset:41984
  v_mfma_f32_32x32x16_bf16 v[72:87], a[112:115], a[188:191], v[72:87]
  ds_read_b128 a[168:171], v16 offset:43008
  v_mfma_f32_32x32x16_bf16 v[88:103], a[112:115], a[192:195], v[88:103]
  ds_read_b128 a[172:175], v16 offset:44032
  v_mfma_f32_32x32x16_bf16 v[104:119], a[112:115], a[196:199], v[104:119]
  s_waitcnt lgkmcnt(4)
  ds_read_b128 a[176:179], v16 offset:45056
  v_mfma_f32_32x32x16_bf16 v[40:55], a[116:119], a[200:203], v[40:55]
  ds_read_b128 a[180:183], v17 offset:40960
  s_waitcnt vmcnt(24)
  ds_read_b128 a[128:131], v6 offset:32768
  ds_read_b128 a[132:135], v7 offset:32768
  ds_read_b128 a[136:139], v8 offset:32768
  ds_read_b128 a[140:143], v9 offset:32768
  v_mfma_f32_32x32x16_bf16 v[56:71], a[116:119], a[204:207], v[56:71]
  ds_read_b128 a[184:187], v17 offset:41984
  v_mfma_f32_32x32x16_bf16 v[72:87], a[116:119], a[208:211], v[72:87]
  ds_read_b128 a[188:191], v17 offset:43008
  v_mfma_f32_32x32x16_bf16 v[88:103], a[116:119], a[212:215], v[88:103]
  ds_read_b128 a[192:195], v17 offset:44032
  v_mfma_f32_32x32x16_bf16 v[104:119], a[116:119], a[216:219], v[104:119]
  s_waitcnt lgkmcnt(8)
  ds_read_b128 a[196:199], v17 offset:45056
  v_mfma_f32_32x32x16_bf16 v[40:55], a[120:123], a[160:163], v[40:55]
  s_barrier
  v_add_u32 v14, 61440, v14
  v_add_u32 v15, 61440, v15
  v_add_u32 v16, 61440, v16
  v_add_u32 v17, 61440, v17
  ds_read_b128 a[200:203], v14 offset:0
  s_mul_i32 s55, s97, 196608
  s_add_u32 s55, s55, s98
  s_add_u32 s56, s55, 22528
  s_add_u32 m0, s54, 77824
  s_nop 0
  buffer_load_dwordx4 v10, s[8:11], s55 offen lds
  v_mfma_f32_32x32x16_bf16 v[56:71], a[120:123], a[164:167], v[56:71]
  ds_read_b128 a[204:207], v14 offset:1024
  v_mfma_f32_32x32x16_bf16 v[72:87], a[120:123], a[168:171], v[72:87]
  ds_read_b128 a[208:211], v14 offset:2048
  buffer_load_dwordx4 v11, s[12:15], s55 offen offset:1024 lds
  v_mfma_f32_32x32x16_bf16 v[88:103], a[120:123], a[172:175], v[88:103]
  ds_read_b128 a[212:215], v14 offset:3072
  v_mfma_f32_32x32x16_bf16 v[104:119], a[120:123], a[176:179], v[104:119]
  s_waitcnt lgkmcnt(4)
  ds_read_b128 a[216:219], v14 offset:4096
  buffer_load_dwordx4 v10, s[8:11], s56 offen offset:2048 lds
  v_mfma_f32_32x32x16_bf16 v[40:55], a[124:127], a[180:183], v[40:55]
  ds_read_b128 a[160:163], v15 offset:0
  s_waitcnt vmcnt(25)
  v_xor_b32 v39, s92, v31
  v_bitop3_b32 v39, v39, v30, s92 bitop3:0xf6
  v_cmp_ne_u32 vcc, 0, v39
  v_mfma_f32_32x32x16_bf16 v[56:71], a[124:127], a[184:187], v[56:71]
  ds_read_b128 a[164:167], v15 offset:1024
  buffer_load_dwordx4 v11, s[12:15], s56 offen offset:3072 lds
  s_add_u32 s97, s97, 1
  s_cmp_eq_u32 s97, 10
  s_cselect_b32 s97, 0, s97
  s_cbranch_vccnz Y_poll0_slow
Y_poll0_ret:
  s_lshl_b32 s44, s42, 7
  s_add_u32 s44, s44, 159744
  v_mfma_f32_32x32x16_bf16 v[72:87], a[124:127], a[188:191], v[72:87]
  ds_read_b128 a[168:171], v15 offset:2048
  v_lshrrev_b32 v35, 2, v212
  v_add_u32 v35, s44, v35
  ds_write_b32 v35, v28
  v_mfma_f32_32x32x16_bf16 v[88:103], a[124:127], a[192:195], v[88:103]
  ds_read_b128 a[172:175], v15 offset:3072
  v_lshrrev_b32 v34, 5, v1
  v_lshlrev_b32 v34, 6, v34
  v_add_u32 v34, s44, v34
  v_mfma_f32_32x32x16_bf16 v[104:119], a[124:127], a[196:199], v[104:119]
  s_waitcnt lgkmcnt(5)
  ds_read_b128 a[176:179], v15 offset:4096
  ds_read_b128 v[216:219], v34 offset:0
  ds_read_b128 v[220:223], v34 offset:16
  ds_read_b128 v[224:227], v34 offset:32
  v_mfma_f32_32x32x16_bf16 v[40:55], a[128:131], a[200:203], v[40:55]
  ds_read_b128 a[180:183], v16 offset:0
  ds_read_b128 v[228:231], v34 offset:48
  v_mul_f32 v212, 3216550459, v28
  v_rcp_f32 v213, v28
  v_mfma_f32_32x32x16_bf16 v[56:71], a[128:131], a[204:207], v[56:71]
  ds_read_b128 a[184:187], v16 offset:1024
  v_mov_b32 v28, v29
  v_mov_b32 v30, v29
  v_mfma_f32_32x32x16_bf16 v[72:87], a[128:131], a[208:211], v[72:87]
  ds_read_b128 a[188:191], v16 offset:2048
  v_mov_b32 v31, v29
  v_mul_f32 v213, v213, v213
  s_waitcnt vmcnt(7)
  v_xor_b32 v39, s92, v139
  v_mfma_f32_32x32x16_bf16 v[88:103], a[128:131], a[212:215], v[88:103]
  ds_read_b128 a[192:195], v16 offset:3072
  v_bitop3_b32 v39, v39, v137, s92 bitop3:0xf6
  v_bitop3_b32 v39, v39, v135, s92 bitop3:0xf6
  v_bitop3_b32 v39, v39, v133, s92 bitop3:0xf6
  v_mfma_f32_32x32x16_bf16 v[104:119], a[128:131], a[216:219], v[104:119]
  s_waitcnt lgkmcnt(8)
  ds_read_b128 a[196:199], v16 offset:4096
  v_bitop3_b32 v39, v39, v131, s92 bitop3:0xf6
  v_bitop3_b32 v39, v39, v129, s92 bitop3:0xf6
  v_bitop3_b32 v39, v39, v127, s92 bitop3:0xf6
  v_mfma_f32_32x32x16_bf16 v[40:55], a[132:135], a[160:163], v[40:55]
  ds_read_b128 a[200:203], v17 offset:0
  ds_read_b128 a[144:147], v6 offset:0
  ds_read_b128 a[148:151], v7 offset:0
  ds_read_b128 a[152:155], v8 offset:0
  ds_read_b128 a[156:159], v9 offset:0
  v_bitop3_b32 v39, v39, v125, s92 bitop3:0xf6
  v_bitop3_b32 v39, v39, v123, s92 bitop3:0xf6
  v_bitop3_b32 v39, v39, v121, s92 bitop3:0xf6
  v_mfma_f32_32x32x16_bf16 v[56:71], a[132:135], a[164:167], v[56:71]
  ds_read_b128 a[204:207], v17 offset:1024
  v_cmp_ne_u32 vcc, 0, v39
  s_nop 3
  s_cbranch_vccnz Y_poll1_slow
Y_poll1_ret:
  v_cmp_gt_u32 vcc, 32, v1
  v_mfma_f32_32x32x16_bf16 v[72:87], a[132:135], a[168:171], v[72:87]
  s_waitcnt lgkmcnt(10)
  ds_read_b128 a[208:211], v17 offset:2048
  v_add_f32 v120, v120, v122
  v_add_f32 v124, v124, v126
  v_add_f32 v120, v120, v128
  v_mfma_f32_32x32x16_bf16 v[88:103], a[132:135], a[172:175], v[88:103]
  ds_read_b128 a[212:215], v17 offset:3072
  v_add_f32 v120, v120, v124
  v_mov_b32 v121, v120
  v_mov_b32 v126, 0
  v_mfma_f32_32x32x16_bf16 v[104:119], a[132:135], a[176:179], v[104:119]
  s_waitcnt lgkmcnt(8)
  ds_read_b128 a[216:219], v17 offset:4096
  v_mov_b32 v127, 0
  v_permlane32_swap_b32 v120, v121
  v_add_f32 v120, v120, v121
  v_mfma_f32_32x32x16_bf16 v[40:55], a[136:139], a[180:183], v[40:55]
  s_barrier
  ds_read_b128 a[160:163], v14 offset:20480
  s_mul_i32 s55, s97, 196608
  s_add_u32 s55, s55, s98
  s_add_u32 s56, s55, 22528
  s_add_u32 m0, s54, 98304
  s_nop 0
  buffer_load_dwordx4 v10, s[8:11], s55 offen lds
  v_cndmask_b32 v120, 0, v120, vcc
  v_cvt_pk_bf16_f32 v121, v120, v120
  v_and_b32 v121, s52, v121
  v_mfma_f32_32x32x16_bf16 v[56:71], a[136:139], a[184:187], v[56:71]
  ds_read_b128 a[164:167], v14 offset:21504
  s_lshr_b32 s48, s79, 3
  v_sub_f32 v120, v120, v121
  v_cvt_pk_bf16_f32 v124, v121, v120
  v_and_b32 v122, s52, v124
  v_mfma_f32_32x32x16_bf16 v[72:87], a[136:139], a[188:191], v[72:87]
  ds_read_b128 a[168:171], v14 offset:22528
  buffer_load_dwordx4 v11, s[12:15], s55 offen offset:1024 lds
  v_sub_f32 v120, v120, v122
  v_cvt_pk_bf16_f32 v125, v120, 0
  s_lshr_b32 s86, s54, 2
  v_mfma_f32_32x32x16_bf16 v[88:103], a[136:139], a[192:195], v[88:103]
  ds_read_b128 a[172:175], v14 offset:23552
  v_add_u32 v37, s86, v38
  ds_write_b128 v37, v[124:127] offset:16384
  v_add_f32 v130, v130, v132
  v_mfma_f32_32x32x16_bf16 v[104:119], a[136:139], a[196:199], v[104:119]
  s_waitcnt lgkmcnt(5)
  ds_read_b128 a[176:179], v14 offset:24576
  buffer_load_dwordx4 v10, s[8:11], s56 offen offset:2048 lds
  s_lshl_b32 s49, s78, 1
  v_add_f32 v134, v134, v136
  v_add_f32 v130, v130, v138
  v_add_f32 v130, v130, v134
  v_mfma_f32_32x32x16_bf16 v[40:55], a[140:143], a[200:203], v[40:55]
  ds_read_b128 a[180:183], v15 offset:20480
  v_mov_b32 v131, v130
  v_mov_b32 v136, 0
  v_mov_b32 v137, 0
  v_mfma_f32_32x32x16_bf16 v[56:71], a[140:143], a[204:207], v[56:71]
  ds_read_b128 a[184:187], v15 offset:21504
  buffer_load_dwordx4 v11, s[12:15], s56 offen offset:3072 lds
  s_add_u32 s97, s97, 1
  s_cmp_eq_u32 s97, 10
  s_cselect_b32 s97, 0, s97
  v_permlane32_swap_b32 v130, v131
  v_add_f32 v130, v130, v131
  v_cndmask_b32 v130, 0, v130, vcc
  v_mfma_f32_32x32x16_bf16 v[72:87], a[140:143], a[208:211], v[72:87]
  ds_read_b128 a[188:191], v15 offset:22528
  s_add_u32 s48, s48, s49
  v_cvt_pk_bf16_f32 v131, v130, v130
  v_and_b32 v131, s52, v131
  v_sub_f32 v130, v130, v131
  v_mfma_f32_32x32x16_bf16 v[88:103], a[140:143], a[212:215], v[88:103]
  ds_read_b128 a[192:195], v15 offset:23552
  v_cvt_pk_bf16_f32 v134, v131, v130
  v_and_b32 v132, s52, v134
  v_sub_f32 v130, v130, v132
  v_mfma_f32_32x32x16_bf16 v[104:119], a[140:143], a[216:219], v[104:119]
  s_waitcnt lgkmcnt(4)
  ds_read_b128 a[196:199], v15 offset:24576
  v_cvt_pk_bf16_f32 v135, v130, 0
  ds_write_b128 v38, v[134:137] offset:20480
  v_mfma_f32_32x32x16_bf16 v[40:55], a[144:147], a[160:163], v[40:55]
  ds_read_b128 a[200:203], v16 offset:20480
  s_lshl_b32 s48, s48, 2
  v_mfma_f32_32x32x16_bf16 v[56:71], a[144:147], a[164:167], v[56:71]
  ds_read_b128 a[204:207], v16 offset:21504
  v_mfma_f32_32x32x16_bf16 v[72:87], a[144:147], a[168:171], v[72:87]
  ds_read_b128 a[208:211], v16 offset:22528
  v_mfma_f32_32x32x16_bf16 v[88:103], a[144:147], a[172:175], v[88:103]
  ds_read_b128 a[212:215], v16 offset:23552
  v_mfma_f32_32x32x16_bf16 v[104:119], a[144:147], a[176:179], v[104:119]
  s_waitcnt lgkmcnt(5)
  ds_read_b128 a[216:219], v16 offset:24576
  s_add_u32 s48, s48, s42
  v_mfma_f32_32x32x16_bf16 v[40:55], a[148:151], a[180:183], v[40:55]
  ds_read_b128 a[160:163], v17 offset:20480
  v_mfma_f32_32x32x16_bf16 v[56:71], a[148:151], a[184:187], v[56:71]
  ds_read_b128 a[164:167], v17 offset:21504
  v_mfma_f32_32x32x16_bf16 v[72:87], a[148:151], a[188:191], v[72:87]
  ds_read_b128 a[168:171], v17 offset:22528
  s_lshl_b32 s48, s48, 4
  v_mfma_f32_32x32x16_bf16 v[88:103], a[148:151], a[192:195], v[88:103]
  ds_read_b128 a[172:175], v17 offset:23552
  v_mfma_f32_32x32x16_bf16 v[104:119], a[148:151], a[196:199], v[104:119]
  s_waitcnt lgkmcnt(4)
  ds_read_b128 a[176:179], v17 offset:24576
  v_mfma_f32_32x32x16_bf16 v[40:55], a[152:155], a[200:203], v[40:55]
  s_waitcnt vmcnt(8)
  s_barrier
  ds_read_b64_tr_b16 a[180:181], v18 offset:0
  ds_read_b64_tr_b16 a[182:183], v18 offset:512
  s_mul_i32 s55, s97, 196608
  s_add_u32 s55, s55, s98
  s_add_u32 s56, s55, 22528
  s_add_u32 m0, s54, 118784
  s_nop 0
  buffer_load_dwordx4 v10, s[8:11], s55 offen lds
  s_and_b32 s49, s79, 7
  ds_read_b128 a[220:223], v38 offset:16384
  ds_read_b128 a[224:227], v38 offset:17408
  ds_read_b128 a[228:231], v38 offset:18432
  v_mfma_f32_32x32x16_bf16 v[56:71], a[152:155], a[204:207], v[56:71]
  ds_read_b64_tr_b16 a[184:185], v19 offset:0
  ds_read_b64_tr_b16 a[186:187], v19 offset:512
  ds_read_b128 a[232:235], v38 offset:19456
  ds_read_b128 a[236:239], v38 offset:20480
  v_and_b32 v32, 31, v1
  v_mfma_f32_32x32x16_bf16 v[72:87], a[152:155], a[208:211], v[72:87]
  ds_read_b64_tr_b16 a[188:189], v20 offset:0
  s_waitcnt lgkmcnt(10)
  ds_read_b64_tr_b16 a[190:191], v20 offset:512
  buffer_load_dwordx4 v11, s[12:15], s55 offen offset:1024 lds
  v_mul_u32_u24 v34, 48, v32
  v_lshlrev_b32 v32, 5, v32
  v_lshrrev_b32 v33, 5, v0
  v_mfma_f32_32x32x16_bf16 v[88:103], a[152:155], a[212:215], v[88:103]
  ds_read_b64_tr_b16 a[192:193], v21 offset:0
  ds_read_b64_tr_b16 a[194:195], v21 offset:512
  s_mul_i32 s49, s49, 160
  v_lshl_add_u32 v253, v33, 2, v34
  ds_read_b64 v[232:233], v32 offset:49152
  ds_read_b64 v[234:235], v32 offset:50176
  v_mfma_f32_32x32x16_bf16 v[104:119], a[152:155], a[216:219], v[104:119]
  buffer_load_dwordx4 v10, s[8:11], s56 offen offset:2048 lds
  s_waitcnt lgkmcnt(10)
  ds_read_b64 v[236:237], v32 offset:51200
  ds_read_b64 v[238:239], v32 offset:52224
  ds_read_b64 v[240:241], v32 offset:53248
  v_mfma_f32_32x32x16_bf16 v[40:55], a[156:159], a[160:163], v[40:55]
  ds_read_b64_tr_b16 a[196:197], v18 offset:4096
  ds_read_b64_tr_b16 a[198:199], v18 offset:4608
  v_mfma_f32_32x32x16_bf16 v[56:71], a[156:159], a[164:167], v[56:71]
  s_waitcnt lgkmcnt(10)
  ds_read_b64_tr_b16 a[200:201], v19 offset:4096
  ds_read_b64_tr_b16 a[202:203], v19 offset:4608
  buffer_load_dwordx4 v11, s[12:15], s56 offen offset:3072 lds
  s_add_u32 s97, s97, 1
  s_cmp_eq_u32 s97, 10
  s_cselect_b32 s97, 0, s97
  v_mfma_f32_32x32x16_bf16 v[72:87], a[156:159], a[168:171], v[72:87]
  ds_read_b64_tr_b16 a[204:205], v20 offset:4096
  ds_read_b64_tr_b16 a[206:207], v20 offset:4608
  s_mul_i32 s51, s48, 1280
  v_mfma_f32_32x32x16_bf16 v[88:103], a[156:159], a[172:175], v[88:103]
  s_waitcnt lgkmcnt(11)
  ds_read_b64_tr_b16 a[208:209], v21 offset:4096
  ds_read_b64_tr_b16 a[210:211], v21 offset:4608
  v_mfma_f32_32x32x16_bf16 v[104:119], a[156:159], a[176:179], v[104:119]
  v_mfma_f32_32x32x16_bf16 v[40:55], v[28:31], a[220:223], v[40:55]
  s_andn2_b32 s50, s49, 127
  v_mfma_f32_32x32x16_bf16 v[56:71], v[28:31], a[224:227], v[56:71]
  v_mfma_f32_32x32x16_bf16 v[72:87], v[28:31], a[228:231], v[72:87]
  v_mfma_f32_32x32x16_bf16 v[88:103], v[28:31], a[232:235], v[88:103]
  s_add_u32 s51, s51, s50
  v_mfma_f32_32x32x16_bf16 v[104:119], v[28:31], a[236:239], v[104:119]
  v_mfma_f32_32x32x16_bf16 v[120:135], a[180:183], a[0:3], 0
  ds_read_b64_tr_b16 a[160:161], v18 offset:8192
  ds_read_b64_tr_b16 a[162:163], v18 offset:8704
  s_lshl_b32 s44, s42, 5
  v_xor_b32 v22, s44, v18
  s_waitcnt lgkmcnt(10)
  ds_read_b64_tr_b16 a[240:241], v22 offset:0
  ds_read_b64_tr_b16 a[242:243], v22 offset:512
  ds_read_b64_tr_b16 a[244:245], v22 offset:4096
  ds_read_b64_tr_b16 a[246:247], v22 offset:4608
  ds_read_b64_tr_b16 a[248:249], v22 offset:8192
  s_waitcnt lgkmcnt(10)
  ds_read_b64_tr_b16 a[250:251], v22 offset:8704
  ds_read_b64_tr_b16 a[252:253], v22 offset:12288
  ds_read_b64_tr_b16 a[254:255], v22 offset:12800
  s_mul_i32 s44, s43, 3
  v_mfma_f32_32x32x16_bf16 v[136:151], a[184:187], a[0:3], 0
  ds_read_b64_tr_b16 a[164:165], v19 offset:8192
  ds_read_b64_tr_b16 a[166:167], v19 offset:8704
  s_add_u32 s44, s44, 2
  s_mul_i32 s83, s44, 12800
  s_add_u32 s83, s83, 15499264
  s_mul_i32 s44, s99, 1280
  s_add_u32 s82, s83, s44
  s_lshl_b32 s44, s42, 8
  s_add_u32 s82, s82, s44
  s_add_u32 s83, s83, s44
  s_cmp_lt_u32 s40, 10
  s_cselect_b32 s44, 32, 0
  v_cmp_gt_u32 vcc, s44, v1
  v_mfma_f32_32x32x16_bf16 v[152:167], a[188:191], a[0:3], 0
  s_waitcnt lgkmcnt(10)
  ds_read_b64_tr_b16 a[168:169], v20 offset:8192
  ds_read_b64_tr_b16 a[170:171], v20 offset:8704
  s_mul_i32 s50, s42, 4608
  v_lshlrev_b32 v36, 3, v1
  v_mov_b32 v37, 2130706432
  v_cndmask_b32 v36, v37, v36, vcc
  s_waitcnt lgkmcnt(10)
  v_mfma_f32_32x32x16_bf16 v[184:199], v[24:27], a[240:243], 0
  s_waitcnt lgkmcnt(8)
  v_mfma_f32_32x32x16_bf16 v[184:199], v[24:27], a[244:247], v[184:199]
  s_waitcnt lgkmcnt(6)
  v_mfma_f32_32x32x16_bf16 v[184:199], v[24:27], a[248:251], v[184:199]
  s_waitcnt lgkmcnt(4)
  v_mfma_f32_32x32x16_bf16 v[184:199], v[24:27], a[252:255], v[184:199]
  v_mul_f32 v40, v216, v40
  v_mul_f32 v56, v216, v56
  v_mul_f32 v72, v216, v72
  v_mul_f32 v88, v216, v88
  v_mfma_f32_32x32x16_bf16 v[168:183], a[192:195], a[0:3], 0
  ds_read_b64_tr_b16 a[172:173], v21 offset:8192
  ds_read_b64_tr_b16 a[174:175], v21 offset:8704
  v_mul_f32 v104, v216, v104
  v_mul_f32 v41, v217, v41
  v_mul_f32 v57, v217, v57
  v_mul_f32 v73, v217, v73
  v_mul_f32 v89, v217, v89
  v_mul_f32 v105, v217, v105
  v_mov_b32 v185, s92
  buffer_store_dwordx2 v[184:185], v36, s[20:23], s82 offen sc1
  ds_read_b128 v[244:247], v252 offset:49168
  v_fma_f32 v198, v232, v40, v41
  v_fma_f32 v200, v234, v56, v57
  v_fma_f32 v202, v236, v72, v73
  v_mfma_f32_32x32x16_bf16 v[120:135], a[196:199], a[4:7], v[120:135]
  ds_read_b64_tr_b16 a[180:181], v18 offset:12288
  ds_read_b64_tr_b16 a[182:183], v18 offset:12800
  s_add_u32 s50, s50, 32768
  v_lshrrev_b32 v6, 4, v1
  v_fma_f32 v204, v238, v88, v89
  v_fma_f32 v206, v240, v104, v105
  v_mul_f32 v42, v218, v42
  v_mul_f32 v58, v218, v58
  v_mul_f32 v74, v218, v74
  v_mul_f32 v90, v218, v90
  v_mul_f32 v106, v218, v106
  v_fmac_f32_dpp v198, v40, v233 quad_perm:[1,0,3,2] row_mask:0xf bank_mask:0xf
  v_fmac_f32_dpp v200, v56, v235 quad_perm:[1,0,3,2] row_mask:0xf bank_mask:0xf
  v_fmac_f32_dpp v202, v72, v237 quad_perm:[1,0,3,2] row_mask:0xf bank_mask:0xf
  v_fmac_f32_dpp v204, v88, v239 quad_perm:[1,0,3,2] row_mask:0xf bank_mask:0xf
  v_mfma_f32_32x32x16_bf16 v[136:151], a[200:203], a[4:7], v[136:151]
  ds_read_b64_tr_b16 a[184:185], v19 offset:12288
  ds_read_b64_tr_b16 a[186:187], v19 offset:12800
  v_mul_u32_u24 v6, 1280, v6
  v_fmac_f32_dpp v206, v104, v241 quad_perm:[1,0,3,2] row_mask:0xf bank_mask:0xf
  v_fma_f32 v199, v232, v198, v42
  v_fma_f32 v201, v234, v200, v58
  v_fma_f32 v203, v236, v202, v74
  v_fma_f32 v205, v238, v204, v90
  v_fma_f32 v207, v240, v206, v106
  v_mul_f32 v43, v219, v43
  v_mul_f32 v59, v219, v59
  v_mul_f32 v75, v219, v75
  v_mul_f32 v91, v219, v91
  v_mul_f32 v107, v219, v107
  v_mfma_f32_32x32x16_bf16 v[152:167], a[204:207], a[4:7], v[152:167]
  ds_read_b64_tr_b16 a[188:189], v20 offset:12288
  ds_read_b64_tr_b16 a[190:191], v20 offset:12800
  v_and_b32 v7, 15, v1
  v_fmac_f32_dpp v199, v198, v233 quad_perm:[1,0,3,2] row_mask:0xf bank_mask:0xf
  v_fmac_f32_dpp v201, v200, v235 quad_perm:[1,0,3,2] row_mask:0xf bank_mask:0xf
  v_fmac_f32_dpp v203, v202, v237 quad_perm:[1,0,3,2] row_mask:0xf bank_mask:0xf
  v_fmac_f32_dpp v205, v204, v239 quad_perm:[1,0,3,2] row_mask:0xf bank_mask:0xf
  v_fmac_f32_dpp v207, v206, v241 quad_perm:[1,0,3,2] row_mask:0xf bank_mask:0xf
  v_fma_f32 v198, v232, v199, v43
  v_fma_f32 v200, v234, v201, v59
  v_fma_f32 v202, v236, v203, v75
  v_fma_f32 v204, v238, v205, v91
  v_fma_f32 v206, v240, v207, v107
  v_mul_f32 v44, v220, v44
  v_mfma_f32_32x32x16_bf16 v[168:183], a[208:211], a[4:7], v[168:183]
  s_waitcnt lgkmcnt(7)
  ds_read_b64_tr_b16 a[192:193], v21 offset:12288
  ds_read_b64_tr_b16 a[194:195], v21 offset:12800
  v_lshl_add_u32 v6, v7, 4, v6
  buffer_load_dword v249, v248, s[20:23], s69 offen sc1
  v_mul_f32 v60, v220, v60
  v_mul_f32 v76, v220, v76
  v_mul_f32 v92, v220, v92
  v_mul_f32 v108, v220, v108
  v_fmac_f32_dpp v198, v199, v233 quad_perm:[1,0,3,2] row_mask:0xf bank_mask:0xf
  v_fmac_f32_dpp v200, v201, v235 quad_perm:[1,0,3,2] row_mask:0xf bank_mask:0xf
  v_fmac_f32_dpp v202, v203, v237 quad_perm:[1,0,3,2] row_mask:0xf bank_mask:0xf
  v_fmac_f32_dpp v204, v205, v239 quad_perm:[1,0,3,2] row_mask:0xf bank_mask:0xf
  v_fmac_f32_dpp v206, v207, v241 quad_perm:[1,0,3,2] row_mask:0xf bank_mask:0xf
  v_fma_f32 v199, v232, v198, v44
  v_fma_f32 v201, v234, v200, v60
  v_mfma_f32_32x32x16_bf16 v[120:135], a[160:163], a[8:11], v[120:135]
  s_waitcnt vmcnt(10)
  s_barrier
  ds_read_b64_tr_b16 a[196:197], v18 offset:20480
  ds_read_b64_tr_b16 a[198:199], v18 offset:20992
  s_mul_i32 s55, s97, 196608
  s_add_u32 s55, s55, s98
  s_add_u32 s56, s55, 22528
  s_add_u32 m0, s54, 139264
  s_nop 0
  buffer_load_dwordx4 v10, s[8:11], s55 offen lds
  v_fma_f32 v203, v236, v202, v76
  v_fma_f32 v205, v238, v204, v92
  v_fma_f32 v207, v240, v206, v108
  v_mul_f32 v45, v221, v45
  v_mul_f32 v61, v221, v61
  v_mul_f32 v77, v221, v77
  v_mul_f32 v93, v221, v93
  v_mul_f32 v109, v221, v109
  v_fmac_f32_dpp v199, v198, v233 quad_perm:[1,0,3,2] row_mask:0xf bank_mask:0xf
  v_fmac_f32_dpp v201, v200, v235 quad_perm:[1,0,3,2] row_mask:0xf bank_mask:0xf
  v_fmac_f32_dpp v203, v202, v237 quad_perm:[1,0,3,2] row_mask:0xf bank_mask:0xf
  v_mfma_f32_32x32x16_bf16 v[136:151], a[164:167], a[8:11], v[136:151]
  ds_read_b64_tr_b16 a[200:201], v19 offset:20480
  ds_read_b64_tr_b16 a[202:203], v19 offset:20992
  v_fmac_f32_dpp v205, v204, v239 quad_perm:[1,0,3,2] row_mask:0xf bank_mask:0xf
  v_fmac_f32_dpp v207, v206, v241 quad_perm:[1,0,3,2] row_mask:0xf bank_mask:0xf
  v_fma_f32 v198, v232, v199, v45
  v_fma_f32 v200, v234, v201, v61
  v_fma_f32 v202, v236, v203, v77
  v_fma_f32 v204, v238, v205, v93
  v_fma_f32 v206, v240, v207, v109
  v_mul_f32 v46, v222, v46
  v_mul_f32 v62, v222, v62
  v_mul_f32 v78, v222, v78
  v_mul_f32 v94, v222, v94
  v_mfma_f32_32x32x16_bf16 v[152:167], a[168:171], a[8:11], v[152:167]
  ds_read_b64_tr_b16 a[204:205], v20 offset:20480
  ds_read_b64_tr_b16 a[206:207], v20 offset:20992
  buffer_load_dwordx4 v11, s[12:15], s55 offen offset:1024 lds
  v_mul_f32 v110, v222, v110
  v_fmac_f32_dpp v198, v199, v233 quad_perm:[1,0,3,2] row_mask:0xf bank_mask:0xf
  v_fmac_f32_dpp v200, v201, v235 quad_perm:[1,0,3,2] row_mask:0xf bank_mask:0xf
  v_fmac_f32_dpp v202, v203, v237 quad_perm:[1,0,3,2] row_mask:0xf bank_mask:0xf
  v_fmac_f32_dpp v204, v205, v239 quad_perm:[1,0,3,2] row_mask:0xf bank_mask:0xf
  v_fmac_f32_dpp v206, v207, v241 quad_perm:[1,0,3,2] row_mask:0xf bank_mask:0xf
  v_fma_f32 v199, v232, v198, v46
  v_fma_f32 v201, v234, v200, v62
  v_fma_f32 v203, v236, v202, v78
  v_fma_f32 v205, v238, v204, v94
  v_fma_f32 v207, v240, v206, v110
  v_mfma_f32_32x32x16_bf16 v[168:183], a[172:175], a[8:11], v[168:183]
  s_waitcnt lgkmcnt(6)
  ds_read_b64_tr_b16 a[208:209], v21 offset:20480
  ds_read_b64_tr_b16 a[210:211], v21 offset:20992
  v_mul_f32 v47, v223, v47
  v_mul_f32 v63, v223, v63
  v_mul_f32 v79, v223, v79
  v_mul_f32 v95, v223, v95
  v_mul_f32 v111, v223, v111
  v_fmac_f32_dpp v199, v198, v233 quad_perm:[1,0,3,2] row_mask:0xf bank_mask:0xf
  v_fmac_f32_dpp v201, v200, v235 quad_perm:[1,0,3,2] row_mask:0xf bank_mask:0xf
  v_fmac_f32_dpp v203, v202, v237 quad_perm:[1,0,3,2] row_mask:0xf bank_mask:0xf
  v_fmac_f32_dpp v205, v204, v239 quad_perm:[1,0,3,2] row_mask:0xf bank_mask:0xf
  v_fmac_f32_dpp v207, v206, v241 quad_perm:[1,0,3,2] row_mask:0xf bank_mask:0xf
  v_fma_f32 v198, v232, v199, v47
  v_fma_f32 v200, v234, v201, v63
  v_mfma_f32_32x32x16_bf16 v[120:135], a[180:183], a[12:15], v[120:135]
  ds_read_b64_tr_b16 a[160:161], v18 offset:24576
  ds_read_b64_tr_b16 a[162:163], v18 offset:25088
  buffer_load_dwordx4 v10, s[8:11], s56 offen offset:2048 lds
  v_fma_f32 v202, v236, v203, v79
  v_fma_f32 v204, v238, v205, v95
  v_fma_f32 v206, v240, v207, v111
  v_mul_f32 v48, v224, v48
  v_mul_f32 v64, v224, v64
  v_mul_f32 v80, v224, v80
  v_mul_f32 v96, v224, v96
  v_mul_f32 v112, v224, v112
  v_fmac_f32_dpp v198, v199, v233 quad_perm:[1,0,3,2] row_mask:0xf bank_mask:0xf
  v_fmac_f32_dpp v200, v201, v235 quad_perm:[1,0,3,2] row_mask:0xf bank_mask:0xf
  v_fmac_f32_dpp v202, v203, v237 quad_perm:[1,0,3,2] row_mask:0xf bank_mask:0xf
  v_mfma_f32_32x32x16_bf16 v[136:151], a[184:187], a[12:15], v[136:151]
  ds_read_b64_tr_b16 a[164:165], v19 offset:24576
  ds_read_b64_tr_b16 a[166:167], v19 offset:25088
  v_fmac_f32_dpp v204, v205, v239 quad_perm:[1,0,3,2] row_mask:0xf bank_mask:0xf
  v_fmac_f32_dpp v206, v207, v241 quad_perm:[1,0,3,2] row_mask:0xf bank_mask:0xf
  v_fma_f32 v199, v232, v198, v48
  v_fma_f32 v201, v234, v200, v64
  v_fma_f32 v203, v236, v202, v80
  v_fma_f32 v205, v238, v204, v96
  v_fma_f32 v207, v240, v206, v112
  v_mul_f32 v49, v225, v49
  v_mul_f32 v65, v225, v65
  v_mul_f32 v81, v225, v81
  v_mul_f32 v97, v225, v97
  v_mfma_f32_32x32x16_bf16 v[152:167], a[188:191], a[12:15], v[152:167]
  ds_read_b64_tr_b16 a[168:169], v20 offset:24576
  ds_read_b64_tr_b16 a[170:171], v20 offset:25088
  buffer_load_dwordx4 v11, s[12:15], s56 offen offset:3072 lds
  s_add_u32 s97, s97, 1
  s_cmp_eq_u32 s97, 10
  s_cselect_b32 s97, 0, s97
  v_mul_f32 v113, v225, v113
  v_fmac_f32_dpp v199, v198, v233 quad_perm:[1,0,3,2] row_mask:0xf bank_mask:0xf
  v_fmac_f32_dpp v201, v200, v235 quad_perm:[1,0,3,2] row_mask:0xf bank_mask:0xf
  v_fmac_f32_dpp v203, v202, v237 quad_perm:[1,0,3,2] row_mask:0xf bank_mask:0xf
  v_fmac_f32_dpp v205, v204, v239 quad_perm:[1,0,3,2] row_mask:0xf bank_mask:0xf
  v_fmac_f32_dpp v207, v206, v241 quad_perm:[1,0,3,2] row_mask:0xf bank_mask:0xf
  v_fma_f32 v198, v232, v199, v49
  v_fma_f32 v200, v234, v201, v65
  v_fma_f32 v202, v236, v203, v81
  v_fma_f32 v204, v238, v205, v97
  v_fma_f32 v206, v240, v207, v113
  v_mfma_f32_32x32x16_bf16 v[168:183], a[192:195], a[12:15], v[168:183]
  s_waitcnt lgkmcnt(6)
  ds_read_b64_tr_b16 a[172:173], v21 offset:24576
  ds_read_b64_tr_b16 a[174:175], v21 offset:25088
  v_mul_f32 v50, v226, v50
  v_mul_f32 v66, v226, v66
  v_mul_f32 v82, v226, v82
  v_mul_f32 v98, v226, v98
  v_mul_f32 v114, v226, v114
  v_fmac_f32_dpp v198, v199, v233 quad_perm:[1,0,3,2] row_mask:0xf bank_mask:0xf
  v_fmac_f32_dpp v200, v201, v235 quad_perm:[1,0,3,2] row_mask:0xf bank_mask:0xf
  v_fmac_f32_dpp v202, v203, v237 quad_perm:[1,0,3,2] row_mask:0xf bank_mask:0xf
  v_fmac_f32_dpp v204, v205, v239 quad_perm:[1,0,3,2] row_mask:0xf bank_mask:0xf
  v_fmac_f32_dpp v206, v207, v241 quad_perm:[1,0,3,2] row_mask:0xf bank_mask:0xf
  v_fma_f32 v199, v232, v198, v50
  v_mfma_f32_32x32x16_bf16 v[120:135], a[196:199], a[16:19], v[120:135]
  ds_read_b64_tr_b16 a[180:181], v18 offset:28672
  ds_read_b64_tr_b16 a[182:183], v18 offset:29184
  v_fma_f32 v201, v234, v200, v66
  v_fma_f32 v203, v236, v202, v82
  v_fma_f32 v205, v238, v204, v98
  v_fma_f32 v207, v240, v206, v114
  v_mul_f32 v51, v227, v51
  v_mul_f32 v67, v227, v67
  v_mul_f32 v83, v227, v83
  v_mul_f32 v99, v227, v99
  v_mul_f32 v115, v227, v115
  v_fmac_f32_dpp v199, v198, v233 quad_perm:[1,0,3,2] row_mask:0xf bank_mask:0xf
  v_fmac_f32_dpp v201, v200, v235 quad_perm:[1,0,3,2] row_mask:0xf bank_mask:0xf
  v_mfma_f32_32x32x16_bf16 v[136:151], a[200:203], a[16:19], v[136:151]
  ds_read_b64_tr_b16 a[184:185], v19 offset:28672
  ds_read_b64_tr_b16 a[186:187], v19 offset:29184
  v_fmac_f32_dpp v203, v202, v237 quad_perm:[1,0,3,2] row_mask:0xf bank_mask:0xf
  v_fmac_f32_dpp v205, v204, v239 quad_perm:[1,0,3,2] row_mask:0xf bank_mask:0xf
  v_fmac_f32_dpp v207, v206, v241 quad_perm:[1,0,3,2] row_mask:0xf bank_mask:0xf
  v_fma_f32 v198, v232, v199, v51
  v_fma_f32 v200, v234, v201, v67
  v_fma_f32 v202, v236, v203, v83
  v_fma_f32 v204, v238, v205, v99
  v_fma_f32 v206, v240, v207, v115
  v_mul_f32 v52, v228, v52
  v_mul_f32 v68, v228, v68
  v_mul_f32 v84, v228, v84
  v_mfma_f32_32x32x16_bf16 v[152:167], a[204:207], a[16:19], v[152:167]
  ds_read_b64_tr_b16 a[188:189], v20 offset:28672
  ds_read_b64_tr_b16 a[190:191], v20 offset:29184
  v_mul_f32 v100, v228, v100
  v_mul_f32 v116, v228, v116
  v_fmac_f32_dpp v198, v199, v233 quad_perm:[1,0,3,2] row_mask:0xf bank_mask:0xf
  v_fmac_f32_dpp v200, v201, v235 quad_perm:[1,0,3,2] row_mask:0xf bank_mask:0xf
  v_fmac_f32_dpp v202, v203, v237 quad_perm:[1,0,3,2] row_mask:0xf bank_mask:0xf
  v_fmac_f32_dpp v204, v205, v239 quad_perm:[1,0,3,2] row_mask:0xf bank_mask:0xf
  v_fmac_f32_dpp v206, v207, v241 quad_perm:[1,0,3,2] row_mask:0xf bank_mask:0xf
  v_fma_f32 v199, v232, v198, v52
  v_fma_f32 v201, v234, v200, v68
  v_fma_f32 v203, v236, v202, v84
  v_fma_f32 v205, v238, v204, v100
  v_mfma_f32_32x32x16_bf16 v[168:183], a[208:211], a[16:19], v[168:183]
  s_waitcnt lgkmcnt(6)
  ds_read_b64_tr_b16 a[192:193], v21 offset:28672
  ds_read_b64_tr_b16 a[194:195], v21 offset:29184
  v_fma_f32 v207, v240, v206, v116
  v_mul_f32 v53, v229, v53
  v_mul_f32 v69, v229, v69
  v_mul_f32 v85, v229, v85
  v_mul_f32 v101, v229, v101
  v_mul_f32 v117, v229, v117
  v_fmac_f32_dpp v199, v198, v233 quad_perm:[1,0,3,2] row_mask:0xf bank_mask:0xf
  v_fmac_f32_dpp v201, v200, v235 quad_perm:[1,0,3,2] row_mask:0xf bank_mask:0xf
  v_fmac_f32_dpp v203, v202, v237 quad_perm:[1,0,3,2] row_mask:0xf bank_mask:0xf
  v_fmac_f32_dpp v205, v204, v239 quad_perm:[1,0,3,2] row_mask:0xf bank_mask:0xf
  v_fmac_f32_dpp v207, v206, v241 quad_perm:[1,0,3,2] row_mask:0xf bank_mask:0xf
  v_fma_f32 v198, v232, v199, v53
  v_mfma_f32_32x32x16_bf16 v[120:135], a[160:163], a[20:23], v[120:135]
  ds_read_b64_tr_b16 a[196:197], v18 offset:32768
  ds_read_b64_tr_b16 a[198:199], v18 offset:33280
  s_waitcnt vmcnt(4)
  v_xor_b32 v250, s92, v249
  v_fma_f32 v200, v234, v201, v69
  v_fma_f32 v202, v236, v203, v85
  v_fma_f32 v204, v238, v205, v101
  v_fma_f32 v206, v240, v207, v117
  v_mul_f32 v54, v230, v54
  v_mul_f32 v70, v230, v70
  v_mul_f32 v86, v230, v86
  v_mul_f32 v102, v230, v102
  v_mul_f32 v118, v230, v118
  v_fmac_f32_dpp v198, v199, v233 quad_perm:[1,0,3,2] row_mask:0xf bank_mask:0xf
  v_fmac_f32_dpp v200, v201, v235 quad_perm:[1,0,3,2] row_mask:0xf bank_mask:0xf
  v_mfma_f32_32x32x16_bf16 v[136:151], a[164:167], a[20:23], v[136:151]
  ds_read_b64_tr_b16 a[200:201], v19 offset:32768
  ds_read_b64_tr_b16 a[202:203], v19 offset:33280
  v_cmp_ne_u32 s[86:87], 0, v250
  v_fmac_f32_dpp v202, v203, v237 quad_perm:[1,0,3,2] row_mask:0xf bank_mask:0xf
  v_fmac_f32_dpp v204, v205, v239 quad_perm:[1,0,3,2] row_mask:0xf bank_mask:0xf
  v_fmac_f32_dpp v206, v207, v241 quad_perm:[1,0,3,2] row_mask:0xf bank_mask:0xf
  v_fma_f32 v199, v232, v198, v54
  v_fma_f32 v201, v234, v200, v70
  v_fma_f32 v203, v236, v202, v86
  v_fma_f32 v205, v238, v204, v102
  v_fma_f32 v207, v240, v206, v118
  v_mul_f32 v55, v231, v55
  v_mul_f32 v71, v231, v71
  v_mul_f32 v87, v231, v87
  v_mfma_f32_32x32x16_bf16 v[152:167], a[168:171], a[20:23], v[152:167]
  ds_read_b64_tr_b16 a[204:205], v20 offset:32768
  ds_read_b64_tr_b16 a[206:207], v20 offset:33280
  s_cmp_lg_u64 s[86:87], 0
  s_cbranch_scc1 Y_poll2_slow
Y_poll2_ret:
  v_mul_f32 v103, v231, v103
  v_mul_f32 v119, v231, v119
  v_fmac_f32_dpp v199, v198, v233 quad_perm:[1,0,3,2] row_mask:0xf bank_mask:0xf
  v_fmac_f32_dpp v201, v200, v235 quad_perm:[1,0,3,2] row_mask:0xf bank_mask:0xf
  v_fmac_f32_dpp v203, v202, v237 quad_perm:[1,0,3,2] row_mask:0xf bank_mask:0xf
  v_fmac_f32_dpp v205, v204, v239 quad_perm:[1,0,3,2] row_mask:0xf bank_mask:0xf
  v_fmac_f32_dpp v207, v206, v241 quad_perm:[1,0,3,2] row_mask:0xf bank_mask:0xf
  v_fma_f32 v198, v232, v199, v55
  v_fma_f32 v200, v234, v201, v71
  v_fma_f32 v202, v236, v203, v87
  v_fma_f32 v204, v238, v205, v103
  v_mfma_f32_32x32x16_bf16 v[168:183], a[172:175], a[20:23], v[168:183]
  s_waitcnt lgkmcnt(6)
  ds_read_b64_tr_b16 a[208:209], v21 offset:32768
  ds_read_b64_tr_b16 a[210:211], v21 offset:33280
  v_fma_f32 v206, v240, v207, v119
  v_fmac_f32_dpp v198, v199, v233 quad_perm:[1,0,3,2] row_mask:0xf bank_mask:0xf
  v_fmac_f32_dpp v200, v201, v235 quad_perm:[1,0,3,2] row_mask:0xf bank_mask:0xf
  v_fmac_f32_dpp v202, v203, v237 quad_perm:[1,0,3,2] row_mask:0xf bank_mask:0xf
  v_fmac_f32_dpp v204, v205, v239 quad_perm:[1,0,3,2] row_mask:0xf bank_mask:0xf
  v_fmac_f32_dpp v206, v207, v241 quad_perm:[1,0,3,2] row_mask:0xf bank_mask:0xf
  ds_write_b32 v253, v198 offset:16
  ds_write_b32 v253, v200 offset:1552
  ds_write_b32 v253, v202 offset:3088
  ds_write_b32 v253, v204 offset:4624
  ds_write_b32 v253, v206 offset:6160
  v_mfma_f32_32x32x16_bf16 v[120:135], a[180:183], a[24:27], v[120:135]
  s_waitcnt lgkmcnt(0)
  s_barrier
  ds_read_b64_tr_b16 a[160:161], v18 offset:40960
  ds_read_b64_tr_b16 a[162:163], v18 offset:41472
  s_mul_i32 s55, s97, 196608
  s_add_u32 s55, s55, s98
  s_add_u32 s56, s55, 22528
  s_add_u32 m0, s54, 57344
  s_nop 0
  buffer_load_dwordx4 v10, s[8:11], s55 offen lds
  ds_read_b128 v[220:223], v242 offset:16
  ds_read_b128 v[224:227], v242 offset:32
  s_sub_u32 s59, 15, s40
  v_mfma_f32_32x32x16_bf16 v[136:151], a[184:187], a[24:27], v[136:151]
  ds_read_b64_tr_b16 a[164:165], v19 offset:40960
  ds_read_b64_tr_b16 a[166:167], v19 offset:41472
  s_mul_i32 s59, s59, 1280
  s_waitcnt lgkmcnt(3)
  v_fma_f32 v228, v244, v220, v221
  s_add_u32 s24, s59, 1280
  v_mfma_f32_32x32x16_bf16 v[152:167], a[188:191], a[24:27], v[152:167]
  ds_read_b64_tr_b16 a[168:169], v20 offset:40960
  ds_read_b64_tr_b16 a[170:171], v20 offset:41472
  buffer_load_dwordx4 v11, s[12:15], s55 offen offset:1024 lds
  v_fmac_f32_dpp v228, v220, v245 quad_perm:[1,0,3,2] row_mask:0xf bank_mask:0xf
  v_fma_f32 v229, v244, v228, v222
  s_add_u32 s25, s59, 5120
  v_fmac_f32_dpp v229, v228, v245 quad_perm:[1,0,3,2] row_mask:0xf bank_mask:0xf
  v_mfma_f32_32x32x16_bf16 v[168:183], a[192:195], a[24:27], v[168:183]
  ds_read_b64_tr_b16 a[172:173], v21 offset:40960
  ds_read_b64_tr_b16 a[174:175], v21 offset:41472
  v_fma_f32 v228, v244, v229, v223
  s_add_u32 s26, s59, 8960
  v_fmac_f32_dpp v228, v229, v245 quad_perm:[1,0,3,2] row_mask:0xf bank_mask:0xf
  v_mfma_f32_32x32x16_bf16 v[120:135], a[196:199], a[28:31], v[120:135]
  ds_read_b64_tr_b16 a[180:181], v18 offset:45056
  ds_read_b64_tr_b16 a[182:183], v18 offset:45568
  buffer_load_dwordx4 v10, s[8:11], s56 offen offset:2048 lds
  s_waitcnt lgkmcnt(8)
  v_fma_f32 v229, v244, v228, v224
  s_add_u32 s27, s59, 12800
  v_fmac_f32_dpp v229, v228, v245 quad_perm:[1,0,3,2] row_mask:0xf bank_mask:0xf
  v_fma_f32 v228, v244, v229, v225
  v_mfma_f32_32x32x16_bf16 v[136:151], a[200:203], a[28:31], v[136:151]
  ds_read_b64_tr_b16 a[184:185], v19 offset:45056
  ds_read_b64_tr_b16 a[186:187], v19 offset:45568
  s_add_u32 s28, s59, 16640
  v_fmac_f32_dpp v228, v229, v245 quad_perm:[1,0,3,2] row_mask:0xf bank_mask:0xf
  v_fma_f32 v229, v244, v228, v226
  v_mfma_f32_32x32x16_bf16 v[152:167], a[204:207], a[28:31], v[152:167]
  ds_read_b64_tr_b16 a[188:189], v20 offset:45056
  ds_read_b64_tr_b16 a[190:191], v20 offset:45568
  buffer_load_dwordx4 v11, s[12:15], s56 offen offset:3072 lds
  s_add_u32 s97, s97, 1
  s_cmp_eq_u32 s97, 10
  s_cselect_b32 s97, 0, s97
  s_add_u32 s63, s57, 24576
  v_fmac_f32_dpp v229, v228, v245 quad_perm:[1,0,3,2] row_mask:0xf bank_mask:0xf
  v_fma_f32 v228, v244, v229, v227
  s_nop 0
  v_mfma_f32_32x32x16_bf16 v[168:183], a[208:211], a[28:31], v[168:183]
  s_waitcnt lgkmcnt(6)
  ds_read_b64_tr_b16 a[192:193], v21 offset:45056
  ds_read_b64_tr_b16 a[194:195], v21 offset:45568
  v_fmac_f32_dpp v228, v229, v245 quad_perm:[1,0,3,2] row_mask:0xf bank_mask:0xf
  v_mov_b32 v229, s92
  buffer_store_dwordx2 v[228:229], v255, s[36:39], s59 offen sc1
  v_mfma_f32_32x32x16_bf16 v[120:135], a[160:163], a[32:35], v[120:135]
  ds_read_b64_tr_b16 a[196:197], v18 offset:49152
  ds_read_b64_tr_b16 a[198:199], v18 offset:49664
  s_add_u32 m0, s50, 0
  s_add_u32 s65, s51, 0
  buffer_load_dwordx4 v6, s[4:7], s65 offen lds
  v_and_b32 v32, 1, v1
  v_bfe_u32 v33, v1, 1, 4
  v_lshl_add_u32 v33, v32, 4, v33
  v_mfma_f32_32x32x16_bf16 v[136:151], a[164:167], a[32:35], v[136:151]
  ds_read_b64_tr_b16 a[200:201], v19 offset:49152
  ds_read_b64_tr_b16 a[202:203], v19 offset:49664
  v_bfe_u32 v34, v1, 4, 1
  v_xor_b32 v32, v32, v34
  v_lshrrev_b32 v34, 5, v1
  v_mfma_f32_32x32x16_bf16 v[152:167], a[168:171], a[32:35], v[152:167]
  ds_read_b64_tr_b16 a[204:205], v20 offset:49152
  ds_read_b64_tr_b16 a[206:207], v20 offset:49664
  s_add_u32 m0, s50, 1024
  s_add_u32 s65, s51, 5120
  buffer_load_dwordx4 v6, s[4:7], s65 offen lds
  v_xor_b32 v32, v32, v34
  v_bfe_u32 v34, v1, 2, 1
  v_lshl_add_u32 v32, v32, 1, v34
  v_mfma_f32_32x32x16_bf16 v[168:183], a[172:175], a[32:35], v[168:183]
  s_waitcnt lgkmcnt(6)
  ds_read_b64_tr_b16 a[208:209], v21 offset:49152
  ds_read_b64_tr_b16 a[210:211], v21 offset:49664
  v_lshlrev_b32 v32, 4, v32
  v_lshl_add_u32 v33, v33, 6, v32
  s_mul_i32 s44, s42, 10240
  v_mfma_f32_32x32x16_bf16 v[120:135], a[180:183], a[36:39], v[120:135]
  ds_read_b64_tr_b16 a[160:161], v18 offset:53248
  ds_read_b64_tr_b16 a[162:163], v18 offset:53760
  s_add_u32 m0, s50, 2048
  s_add_u32 s65, s51, 10240
  buffer_load_dwordx4 v6, s[4:7], s65 offen lds
  s_add_u32 s44, s44, 98304
  v_add_u32 v2, s44, v33
  v_xor_b32 v229, 16, v2
  v_mfma_f32_32x32x16_bf16 v[136:151], a[184:187], a[36:39], v[136:151]
  ds_read_b64_tr_b16 a[164:165], v19 offset:53248
  ds_read_b64_tr_b16 a[166:167], v19 offset:53760
  v_lshrrev_b32 v32, 4, v1
  v_lshlrev_b32 v33, 9, v32
  v_bfe_u32 v34, v1, 2, 2
  v_mfma_f32_32x32x16_bf16 v[152:167], a[188:191], a[36:39], v[152:167]
  ds_read_b64_tr_b16 a[168:169], v20 offset:53248
  ds_read_b64_tr_b16 a[170:171], v20 offset:53760
  s_add_u32 m0, s50, 3072
  s_add_u32 s65, s51, 15360
  buffer_load_dwordx4 v6, s[4:7], s65 offen lds
  v_lshl_add_u32 v33, v34, 6, v33
  v_lshrrev_b32 v34, 1, v32
  v_xor_b32 v32, v32, v34
  v_mfma_f32_32x32x16_bf16 v[168:183], a[192:195], a[36:39], v[168:183]
  s_waitcnt lgkmcnt(6)
  ds_read_b64_tr_b16 a[172:173], v21 offset:53248
  ds_read_b64_tr_b16 a[174:175], v21 offset:53760
  v_and_b32 v32, 1, v32
  v_bfe_u32 v34, v1, 3, 1
  v_lshl_add_u32 v32, v32, 1, v34
  v_mfma_f32_32x32x16_bf16 v[120:135], a[196:199], a[40:43], v[120:135]
  s_barrier
  v_add_u32 v18, 61440, v18
  v_add_u32 v19, 61440, v19
  v_add_u32 v20, 61440, v20
  v_add_u32 v21, 61440, v21
  ds_read_b64_tr_b16 a[180:181], v18 offset:0
  ds_read_b64_tr_b16 a[182:183], v18 offset:512
  s_mul_i32 s55, s97, 196608
  s_add_u32 s55, s55, s98
  s_add_u32 s56, s55, 22528
  s_add_u32 m0, s54, 77824
  s_nop 0
  buffer_load_dwordx4 v10, s[8:11], s55 offen lds
  v_bfe_u32 v34, v1, 1, 1
  v_xor_b32 v32, v32, v34
  v_lshl_add_u32 v33, v32, 4, v33
  v_mfma_f32_32x32x16_bf16 v[136:151], a[200:203], a[40:43], v[136:151]
  ds_read_b64_tr_b16 a[184:185], v19 offset:0
  ds_read_b64_tr_b16 a[186:187], v19 offset:512
  v_and_b32 v32, 1, v1
  v_lshl_add_u32 v33, v32, 3, v33
  v_add_u32 v3, s44, v33
  v_mfma_f32_32x32x16_bf16 v[152:167], a[204:207], a[40:43], v[152:167]
  ds_read_b64_tr_b16 a[188:189], v20 offset:0
  ds_read_b64_tr_b16 a[190:191], v20 offset:512
  buffer_load_dwordx4 v11, s[12:15], s55 offen offset:1024 lds
  v_xor_b32 v230, 32, v3
  v_mfma_f32_32x32x16_bf16 v[168:183], a[208:211], a[40:43], v[168:183]
  s_waitcnt lgkmcnt(6)
  ds_read_b64_tr_b16 a[192:193], v21 offset:0
  ds_read_b64_tr_b16 a[194:195], v21 offset:512
  v_mfma_f32_32x32x16_bf16 v[120:135], a[160:163], a[44:47], v[120:135]
  ds_read_b64_tr_b16 a[196:197], v18 offset:4096
  ds_read_b64_tr_b16 a[198:199], v18 offset:4608
  buffer_load_dwordx4 v10, s[8:11], s56 offen offset:2048 lds
  v_mfma_f32_32x32x16_bf16 v[136:151], a[164:167], a[44:47], v[136:151]
  ds_read_b64_tr_b16 a[200:201], v19 offset:4096
  ds_read_b64_tr_b16 a[202:203], v19 offset:4608
  v_mfma_f32_32x32x16_bf16 v[152:167], a[168:171], a[44:47], v[152:167]
  ds_read_b64_tr_b16 a[204:205], v20 offset:4096
  ds_read_b64_tr_b16 a[206:207], v20 offset:4608
  buffer_load_dwordx4 v11, s[12:15], s56 offen offset:3072 lds
  s_add_u32 s97, s97, 1
  s_cmp_eq_u32 s97, 10
  s_cselect_b32 s97, 0, s97
  v_mfma_f32_32x32x16_bf16 v[168:183], a[172:175], a[44:47], v[168:183]
  s_waitcnt lgkmcnt(6)
  ds_read_b64_tr_b16 a[208:209], v21 offset:4096
  ds_read_b64_tr_b16 a[210:211], v21 offset:4608
  v_mfma_f32_32x32x16_bf16 v[120:135], a[180:183], a[48:51], v[120:135]
  ds_read_b64_tr_b16 a[160:161], v18 offset:8192
  ds_read_b64_tr_b16 a[162:163], v18 offset:8704
  s_add_u32 m0, s88, 24576
  s_add_u32 s65, s66, 35840
  buffer_load_dwordx4 v38, s[20:23], s65 offen sc1 lds
  v_lshrrev_b32 v209, 5, v1
  v_mfma_f32_32x32x16_bf16 v[136:151], a[184:187], a[48:51], v[136:151]
  ds_read_b64_tr_b16 a[164:165], v19 offset:8192
  ds_read_b64_tr_b16 a[166:167], v19 offset:8704
  v_mul_u32_u24 v209, 6400, v209
  v_mfma_f32_32x32x16_bf16 v[152:167], a[188:191], a[48:51], v[152:167]
  ds_read_b64_tr_b16 a[168:169], v20 offset:8192
  ds_read_b64_tr_b16 a[170:171], v20 offset:8704
  s_add_u32 m0, s88, 28672
  s_add_u32 s65, s66, 36864
  buffer_load_dwordx4 v38, s[20:23], s65 offen sc1 lds
  v_and_b32 v37, 31, v1
  v_lshl_add_u32 v209, v37, 3, v209
  v_mfma_f32_32x32x16_bf16 v[168:183], a[192:195], a[48:51], v[168:183]
  s_waitcnt lgkmcnt(6)
  ds_read_b64_tr_b16 a[172:173], v21 offset:8192
  ds_read_b64_tr_b16 a[174:175], v21 offset:8704
  s_add_u32 s82, s83, 3840
  v_mfma_f32_32x32x16_bf16 v[120:135], a[196:199], a[52:55], v[120:135]
  ds_read_b64_tr_b16 a[180:181], v18 offset:12288
  ds_read_b64_tr_b16 a[182:183], v18 offset:12800
  buffer_load_dwordx2 v[184:185], v209, s[20:23], s83 offen offset:0 sc1
  v_mfma_f32_32x32x16_bf16 v[136:151], a[200:203], a[52:55], v[136:151]
  ds_read_b64_tr_b16 a[184:185], v19 offset:12288
  ds_read_b64_tr_b16 a[186:187], v19 offset:12800
  buffer_load_dwordx2 v[186:187], v209, s[20:23], s83 offen offset:1280 sc1
  v_mfma_f32_32x32x16_bf16 v[152:167], a[204:207], a[52:55], v[152:167]
  ds_read_b64_tr_b16 a[188:189], v20 offset:12288
  ds_read_b64_tr_b16 a[190:191], v20 offset:12800
  buffer_load_dwordx2 v[188:189], v209, s[20:23], s83 offen offset:2560 sc1
  v_mfma_f32_32x32x16_bf16 v[168:183], a[208:211], a[52:55], v[168:183]
  s_waitcnt lgkmcnt(6)
  ds_read_b64_tr_b16 a[192:193], v21 offset:12288
  ds_read_b64_tr_b16 a[194:195], v21 offset:12800
  buffer_load_dwordx2 v[190:191], v209, s[20:23], s82 offen offset:0 sc1
  v_mfma_f32_32x32x16_bf16 v[120:135], a[160:163], a[56:59], v[120:135]
  s_waitcnt vmcnt(19)
  s_barrier
  ds_read_b64_tr_b16 a[196:197], v18 offset:20480
  ds_read_b64_tr_b16 a[198:199], v18 offset:20992
  s_mul_i32 s55, s97, 196608
  s_add_u32 s55, s55, s98
  s_add_u32 s56, s55, 22528
  s_add_u32 m0, s54, 98304
  s_nop 0
  buffer_load_dwordx4 v10, s[8:11], s55 offen lds
  v_mfma_f32_32x32x16_bf16 v[136:151], a[164:167], a[56:59], v[136:151]
  ds_read_b64_tr_b16 a[200:201], v19 offset:20480
  ds_read_b64_tr_b16 a[202:203], v19 offset:20992
  buffer_load_dwordx2 v[192:193], v209, s[20:23], s82 offen offset:1280 sc1
  v_mfma_f32_32x32x16_bf16 v[152:167], a[168:171], a[56:59], v[152:167]
  ds_read_b64_tr_b16 a[204:205], v20 offset:20480
  ds_read_b64_tr_b16 a[206:207], v20 offset:20992
  buffer_load_dwordx4 v11, s[12:15], s55 offen offset:1024 lds
  v_mfma_f32_32x32x16_bf16 v[168:183], a[172:175], a[56:59], v[168:183]
  s_waitcnt lgkmcnt(6)
  ds_read_b64_tr_b16 a[208:209], v21 offset:20480
  ds_read_b64_tr_b16 a[210:211], v21 offset:20992
  v_mfma_f32_32x32x16_bf16 v[120:135], a[180:183], a[60:63], v[120:135]
  ds_read_b64_tr_b16 a[160:161], v18 offset:24576
  ds_read_b64_tr_b16 a[162:163], v18 offset:25088
  buffer_load_dwordx4 v10, s[8:11], s56 offen offset:2048 lds
  v_mfma_f32_32x32x16_bf16 v[136:151], a[184:187], a[60:63], v[136:151]
  ds_read_b64_tr_b16 a[164:165], v19 offset:24576
  ds_read_b64_tr_b16 a[166:167], v19 offset:25088
  v_mfma_f32_32x32x16_bf16 v[152:167], a[188:191], a[60:63], v[152:167]
  ds_read_b64_tr_b16 a[168:169], v20 offset:24576
  ds_read_b64_tr_b16 a[170:171], v20 offset:25088
  buffer_load_dwordx4 v11, s[12:15], s56 offen offset:3072 lds
  s_add_u32 s97, s97, 1
  s_cmp_eq_u32 s97, 10
  s_cselect_b32 s97, 0, s97
  v_mfma_f32_32x32x16_bf16 v[168:183], a[192:195], a[60:63], v[168:183]
  s_waitcnt lgkmcnt(6)
  ds_read_b64_tr_b16 a[172:173], v21 offset:24576
  ds_read_b64_tr_b16 a[174:175], v21 offset:25088
  v_mfma_f32_32x32x16_bf16 v[120:135], a[196:199], a[64:67], v[120:135]
  ds_read_b64_tr_b16 a[180:181], v18 offset:28672
  ds_read_b64_tr_b16 a[182:183], v18 offset:29184
  s_add_u32 m0, s88, 53248
  s_add_u32 s65, s66, 37888
  buffer_load_dwordx4 v38, s[20:23], s65 offen sc1 lds
  v_mfma_f32_32x32x16_bf16 v[136:151], a[200:203], a[64:67], v[136:151]
  ds_read_b64_tr_b16 a[184:185], v19 offset:28672
  ds_read_b64_tr_b16 a[186:187], v19 offset:29184
  v_mfma_f32_32x32x16_bf16 v[152:167], a[204:207], a[64:67], v[152:167]
  ds_read_b64_tr_b16 a[188:189], v20 offset:28672
  ds_read_b64_tr_b16 a[190:191], v20 offset:29184
  s_add_u32 m0, s88, 12288
  s_add_u32 s65, s66, 38912
  buffer_load_dwordx4 v38, s[20:23], s65 offen sc1 lds
  v_mfma_f32_32x32x16_bf16 v[168:183], a[208:211], a[64:67], v[168:183]
  s_waitcnt lgkmcnt(6)
  ds_read_b64_tr_b16 a[192:193], v21 offset:28672
  ds_read_b64_tr_b16 a[194:195], v21 offset:29184
  v_mfma_f32_32x32x16_bf16 v[120:135], a[160:163], a[68:71], v[120:135]
  ds_read_b64_tr_b16 a[196:197], v18 offset:32768
  ds_read_b64_tr_b16 a[198:199], v18 offset:33280
  s_add_u32 m0, s88, 159744
  s_add_u32 s65, s66, 39936
  buffer_load_dwordx4 v38, s[20:23], s65 offen sc1 lds
  v_mfma_f32_32x32x16_bf16 v[136:151], a[164:167], a[68:71], v[136:151]
  ds_read_b64_tr_b16 a[200:201], v19 offset:32768
  ds_read_b64_tr_b16 a[202:203], v19 offset:33280
  v_mfma_f32_32x32x16_bf16 v[152:167], a[168:171], a[68:71], v[152:167]
  ds_read_b64_tr_b16 a[204:205], v20 offset:32768
  ds_read_b64_tr_b16 a[206:207], v20 offset:33280
  s_add_u32 m0, s88, 73728
  s_add_u32 s65, s66, 40960
  buffer_load_dwordx4 v38, s[20:23], s65 offen sc1 lds
  v_mfma_f32_32x32x16_bf16 v[168:183], a[172:175], a[68:71], v[168:183]
  s_waitcnt lgkmcnt(6)
  ds_read_b64_tr_b16 a[208:209], v21 offset:32768
  ds_read_b64_tr_b16 a[210:211], v21 offset:33280
  v_mfma_f32_32x32x16_bf16 v[120:135], a[180:183], a[72:75], v[120:135]
  s_waitcnt vmcnt(24)
  s_barrier
  v_add_u32 v18, 4294905856, v18
  v_add_u32 v19, 4294905856, v19
  v_add_u32 v20, 4294905856, v20
  v_add_u32 v21, 4294905856, v21
  ds_read_b64_tr_b16 a[160:161], v18 offset:0
  ds_read_b64_tr_b16 a[162:163], v18 offset:512
  s_mul_i32 s55, s97, 196608
  s_add_u32 s55, s55, s98
  s_add_u32 s56, s55, 22528
  s_add_u32 m0, s54, 118784
  s_nop 0
  buffer_load_dwordx4 v10, s[8:11], s55 offen lds
  v_mfma_f32_32x32x16_bf16 v[136:151], a[184:187], a[72:75], v[136:151]
  ds_read_b64_tr_b16 a[164:165], v19 offset:0
  ds_read_b64_tr_b16 a[166:167], v19 offset:512
  v_mfma_f32_32x32x16_bf16 v[152:167], a[188:191], a[72:75], v[152:167]
  ds_read_b64_tr_b16 a[168:169], v20 offset:0
  ds_read_b64_tr_b16 a[170:171], v20 offset:512
  buffer_load_dwordx4 v11, s[12:15], s55 offen offset:1024 lds
  v_mfma_f32_32x32x16_bf16 v[168:183], a[192:195], a[72:75], v[168:183]
  s_waitcnt lgkmcnt(6)
  ds_read_b64_tr_b16 a[172:173], v21 offset:0
  ds_read_b64_tr_b16 a[174:175], v21 offset:512
  v_mfma_f32_32x32x16_bf16 v[120:135], a[196:199], a[76:79], v[120:135]
  ds_read_b64_tr_b16 a[180:181], v18 offset:4096
  ds_read_b64_tr_b16 a[182:183], v18 offset:4608
  buffer_load_dwordx4 v10, s[8:11], s56 offen offset:2048 lds
  v_mfma_f32_32x32x16_bf16 v[136:151], a[200:203], a[76:79], v[136:151]
  ds_read_b64_tr_b16 a[184:185], v19 offset:4096
  ds_read_b64_tr_b16 a[186:187], v19 offset:4608
  v_mfma_f32_32x32x16_bf16 v[152:167], a[204:207], a[76:79], v[152:167]
  ds_read_b64_tr_b16 a[188:189], v20 offset:4096
  ds_read_b64_tr_b16 a[190:191], v20 offset:4608
  buffer_load_dwordx4 v11, s[12:15], s56 offen offset:3072 lds
  s_add_u32 s97, s97, 1
  s_cmp_eq_u32 s97, 10
  s_cselect_b32 s97, 0, s97
  v_mfma_f32_32x32x16_bf16 v[168:183], a[208:211], a[76:79], v[168:183]
  s_waitcnt lgkmcnt(6)
  ds_read_b64_tr_b16 a[192:193], v21 offset:4096
  ds_read_b64_tr_b16 a[194:195], v21 offset:4608
  v_mfma_f32_32x32x16_bf16 v[120:135], a[160:163], a[80:83], v[120:135]
  ds_read_b64_tr_b16 a[196:197], v18 offset:8192
  ds_read_b64_tr_b16 a[198:199], v18 offset:8704
  s_add_u32 m0, s88, 94208
  s_add_u32 s65, s66, 41984
  buffer_load_dwordx4 v38, s[20:23], s65 offen sc1 lds
  v_mfma_f32_32x32x16_bf16 v[136:151], a[164:167], a[80:83], v[136:151]
  ds_read_b64_tr_b16 a[200:201], v19 offset:8192
  ds_read_b64_tr_b16 a[202:203], v19 offset:8704
  v_mfma_f32_32x32x16_bf16 v[152:167], a[168:171], a[80:83], v[152:167]
  ds_read_b64_tr_b16 a[204:205], v20 offset:8192
  ds_read_b64_tr_b16 a[206:207], v20 offset:8704
  s_add_u32 m0, s88, 114688
  s_add_u32 s65, s66, 43008
  buffer_load_dwordx4 v38, s[20:23], s65 offen sc1 lds
  v_mfma_f32_32x32x16_bf16 v[168:183], a[172:175], a[80:83], v[168:183]
  s_waitcnt lgkmcnt(6)
  ds_read_b64_tr_b16 a[208:209], v21 offset:8192
  ds_read_b64_tr_b16 a[210:211], v21 offset:8704
  v_mfma_f32_32x32x16_bf16 v[120:135], a[180:183], a[84:87], v[120:135]
  ds_read_b64_tr_b16 a[160:161], v18 offset:12288
  ds_read_b64_tr_b16 a[162:163], v18 offset:12800
  s_add_u32 m0, s88, 135168
  s_add_u32 s65, s66, 44032
  buffer_load_dwordx4 v38, s[20:23], s65 offen sc1 lds
  s_waitcnt vmcnt(14)
  v_xor_b32 v39, s92, v193
  v_bitop3_b32 v39, v39, v191, s92 bitop3:0xf6
  v_bitop3_b32 v39, v39, v189, s92 bitop3:0xf6
  v_mfma_f32_32x32x16_bf16 v[136:151], a[184:187], a[84:87], v[136:151]
  ds_read_b64_tr_b16 a[164:165], v19 offset:12288
  ds_read_b64_tr_b16 a[166:167], v19 offset:12800
  v_bitop3_b32 v39, v39, v187, s92 bitop3:0xf6
  v_bitop3_b32 v39, v39, v185, s92 bitop3:0xf6
  v_cmp_ne_u32 vcc, 0, v39
  v_mfma_f32_32x32x16_bf16 v[152:167], a[188:191], a[84:87], v[152:167]
  ds_read_b64_tr_b16 a[168:169], v20 offset:12288
  ds_read_b64_tr_b16 a[170:171], v20 offset:12800
  s_add_u32 m0, s88, 155648
  s_add_u32 s65, s66, 45056
  buffer_load_dwordx4 v38, s[20:23], s65 offen sc1 lds
  s_cbranch_vccnz Y_poll4_slow
Y_poll4_ret:
  v_cmp_gt_u32 vcc, 32, v1
  v_add_f32 v184, v184, v186
  v_mfma_f32_32x32x16_bf16 v[168:183], a[192:195], a[84:87], v[168:183]
  s_waitcnt lgkmcnt(6)
  ds_read_b64_tr_b16 a[172:173], v21 offset:12288
  ds_read_b64_tr_b16 a[174:175], v21 offset:12800
  v_add_f32 v188, v188, v190
  v_add_f32 v184, v184, v192
  v_add_f32 v184, v184, v188
  v_mfma_f32_32x32x16_bf16 v[120:135], a[196:199], a[88:91], v[120:135]
  s_barrier
  ds_read_b64_tr_b16 a[180:181], v18 offset:20480
  ds_read_b64_tr_b16 a[182:183], v18 offset:20992
  s_mul_i32 s55, s97, 196608
  s_add_u32 s55, s55, s98
  s_add_u32 s56, s55, 22528
  s_add_u32 m0, s54, 139264
  s_nop 0
  buffer_load_dwordx4 v10, s[8:11], s55 offen lds
  v_mov_b32 v185, v184
  v_mov_b32 v190, 0
  v_mov_b32 v191, 0
  v_mfma_f32_32x32x16_bf16 v[136:151], a[200:203], a[88:91], v[136:151]
  ds_read_b64_tr_b16 a[184:185], v19 offset:20480
  ds_read_b64_tr_b16 a[186:187], v19 offset:20992
  v_permlane32_swap_b32 v184, v185
  v_add_f32 v184, v184, v185
  v_cndmask_b32 v184, 0, v184, vcc
  v_mfma_f32_32x32x16_bf16 v[152:167], a[204:207], a[88:91], v[152:167]
  ds_read_b64_tr_b16 a[188:189], v20 offset:20480
  ds_read_b64_tr_b16 a[190:191], v20 offset:20992
  buffer_load_dwordx4 v11, s[12:15], s55 offen offset:1024 lds
  v_cvt_pk_bf16_f32 v185, v184, v184
  v_and_b32 v185, s52, v185
  v_sub_f32 v184, v184, v185
  v_mfma_f32_32x32x16_bf16 v[168:183], a[208:211], a[88:91], v[168:183]
  s_waitcnt lgkmcnt(6)
  ds_read_b64_tr_b16 a[192:193], v21 offset:20480
  ds_read_b64_tr_b16 a[194:195], v21 offset:20992
  v_cvt_pk_bf16_f32 v188, v185, v184
  v_and_b32 v186, s52, v188
  v_sub_f32 v184, v184, v186
  v_mfma_f32_32x32x16_bf16 v[120:135], a[160:163], a[92:95], v[120:135]
  ds_read_b64_tr_b16 a[196:197], v18 offset:24576
  ds_read_b64_tr_b16 a[198:199], v18 offset:25088
  buffer_load_dwordx4 v10, s[8:11], s56 offen offset:2048 lds
  v_cvt_pk_bf16_f32 v189, v184, 0
  s_lshr_b32 s86, s54, 2
  v_add_u32 v37, s86, v38
  v_mfma_f32_32x32x16_bf16 v[136:151], a[164:167], a[92:95], v[136:151]
  ds_read_b64_tr_b16 a[200:201], v19 offset:24576
  ds_read_b64_tr_b16 a[202:203], v19 offset:25088
  ds_write_b128 v37, v[188:191] offset:16384
  v_mfma_f32_32x32x16_bf16 v[152:167], a[168:171], a[92:95], v[152:167]
  ds_read_b64_tr_b16 a[204:205], v20 offset:24576
  ds_read_b64_tr_b16 a[206:207], v20 offset:25088
  buffer_load_dwordx4 v11, s[12:15], s56 offen offset:3072 lds
  s_add_u32 s97, s97, 1
  s_cmp_eq_u32 s97, 10
  s_cselect_b32 s97, 0, s97
  v_mfma_f32_32x32x16_bf16 v[168:183], a[172:175], a[92:95], v[168:183]
  s_waitcnt lgkmcnt(7)
  ds_read_b64_tr_b16 a[208:209], v21 offset:24576
  ds_read_b64_tr_b16 a[210:211], v21 offset:25088
  v_mfma_f32_32x32x16_bf16 v[120:135], a[180:183], a[96:99], v[120:135]
  ds_read_b64_tr_b16 a[160:161], v18 offset:28672
  ds_read_b64_tr_b16 a[162:163], v18 offset:29184
  s_add_u32 s64, s66, 0
  buffer_load_dwordx4 a[0:3], v38, s[20:23], s64 offen offset:0 sc1
  v_mfma_f32_32x32x16_bf16 v[136:151], a[184:187], a[96:99], v[136:151]
  ds_read_b64_tr_b16 a[164:165], v19 offset:28672
  ds_read_b64_tr_b16 a[166:167], v19 offset:29184
  v_mfma_f32_32x32x16_bf16 v[152:167], a[188:191], a[96:99], v[152:167]
  ds_read_b64_tr_b16 a[168:169], v20 offset:28672
  ds_read_b64_tr_b16 a[170:171], v20 offset:29184
  buffer_load_dwordx4 a[4:7], v38, s[20:23], s64 offen offset:1024 sc1
  v_mfma_f32_32x32x16_bf16 v[168:183], a[192:195], a[96:99], v[168:183]
  s_waitcnt lgkmcnt(6)
  ds_read_b64_tr_b16 a[172:173], v21 offset:28672
  ds_read_b64_tr_b16 a[174:175], v21 offset:29184
  v_mfma_f32_32x32x16_bf16 v[120:135], a[196:199], a[100:103], v[120:135]
  ds_read_b64_tr_b16 a[180:181], v18 offset:32768
  ds_read_b64_tr_b16 a[182:183], v18 offset:33280
  buffer_load_dwordx4 a[8:11], v38, s[20:23], s64 offen offset:2048 sc1
  v_mfma_f32_32x32x16_bf16 v[136:151], a[200:203], a[100:103], v[136:151]
  ds_read_b64_tr_b16 a[184:185], v19 offset:32768
  ds_read_b64_tr_b16 a[186:187], v19 offset:33280
  v_mfma_f32_32x32x16_bf16 v[152:167], a[204:207], a[100:103], v[152:167]
  ds_read_b64_tr_b16 a[188:189], v20 offset:32768
  ds_read_b64_tr_b16 a[190:191], v20 offset:33280
  buffer_load_dwordx4 a[12:15], v38, s[20:23], s64 offen offset:3072 sc1
  v_mfma_f32_32x32x16_bf16 v[168:183], a[208:211], a[100:103], v[168:183]
  s_waitcnt lgkmcnt(6)
  ds_read_b64_tr_b16 a[192:193], v21 offset:32768
  ds_read_b64_tr_b16 a[194:195], v21 offset:33280
  v_mfma_f32_32x32x16_bf16 v[120:135], a[160:163], a[104:107], v[120:135]
  s_waitcnt vmcnt(20)
  s_barrier
  ds_read_b64_tr_b16 a[196:197], v18 offset:40960
  ds_read_b64_tr_b16 a[198:199], v18 offset:41472
  s_add_u32 s64, s66, 4096
  buffer_load_dwordx4 a[16:19], v38, s[20:23], s64 offen offset:0 sc1
  ds_read_b128 a[220:223], v38 offset:16384
  ds_read_b128 a[224:227], v38 offset:17408
  ds_read_b128 a[228:231], v38 offset:18432
  v_mfma_f32_32x32x16_bf16 v[136:151], a[164:167], a[104:107], v[136:151]
  ds_read_b64_tr_b16 a[200:201], v18 offset:45056
  ds_read_b64_tr_b16 a[202:203], v18 offset:45568
  s_waitcnt lgkmcnt(10)
  ds_read_b128 a[232:235], v38 offset:19456
  s_and_b32 s87, s79, 8
  s_lshl_b32 s86, s42, 1
  v_mfma_f32_32x32x16_bf16 v[152:167], a[168:171], a[104:107], v[152:167]
  ds_read_b64_tr_b16 a[204:205], v18 offset:49152
  ds_read_b64_tr_b16 a[206:207], v18 offset:49664
  s_add_u32 s64, s66, 5120
  buffer_load_dwordx4 a[20:23], v38, s[20:23], s64 offen offset:0 sc1
  s_add_u32 s87, s87, s86
  s_lshl_b32 s86, s78, 4
  s_add_u32 s87, s87, s86
  v_mfma_f32_32x32x16_bf16 v[168:183], a[172:175], a[104:107], v[168:183]
  s_waitcnt lgkmcnt(10)
  ds_read_b64_tr_b16 a[208:209], v18 offset:53248
  ds_read_b64_tr_b16 a[210:211], v18 offset:53760
  s_lshl_b32 s87, s87, 7
  s_add_u32 s87, s87, 15908864
  v_mov_b32 v248, 0
  v_mfma_f32_32x32x16_bf16 v[120:135], a[180:183], a[108:111], v[120:135]
  s_waitcnt vmcnt(14)
  s_waitcnt vmcnt(6)
  s_barrier
  v_add_u32 v18, 61440, v18
  v_add_u32 v19, 61440, v19
  v_add_u32 v20, 61440, v20
  v_add_u32 v21, 61440, v21
  ds_read_b64_tr_b16 a[160:161], v18 offset:0
  ds_read_b64_tr_b16 a[162:163], v18 offset:512
  buffer_load_dwordx4 a[24:27], v38, s[20:23], s64 offen offset:1024 sc1
  v_mfma_f32_32x32x16_bf16 v[136:151], a[184:187], a[108:111], v[136:151]
  ds_read_b64_tr_b16 a[164:165], v18 offset:4096
  s_waitcnt lgkmcnt(10)
  ds_read_b64_tr_b16 a[166:167], v18 offset:4608
  v_mfma_f32_32x32x16_bf16 v[152:167], a[188:191], a[108:111], v[152:167]
  ds_read_b64_tr_b16 a[168:169], v18 offset:8192
  ds_read_b64_tr_b16 a[170:171], v18 offset:8704
  buffer_load_dwordx4 a[28:31], v38, s[20:23], s64 offen offset:2048 sc1
  v_mfma_f32_32x32x16_bf16 v[168:183], a[192:195], a[108:111], v[168:183]
  s_waitcnt lgkmcnt(6)
  ds_read_b64_tr_b16 a[172:173], v18 offset:12288
  ds_read_b64_tr_b16 a[174:175], v18 offset:12800
  v_mfma_f32_32x32x16_bf16 v[120:135], a[196:199], a[112:115], v[120:135]
  ds_read_b64_tr_b16 a[180:181], v18 offset:20480
  ds_read_b64_tr_b16 a[182:183], v18 offset:20992
  buffer_load_dwordx2 v[184:185], v254, s[36:39], s24 offen offset:0 sc1
  v_mfma_f32_32x32x16_bf16 v[120:135], a[200:203], a[116:119], v[120:135]
  ds_read_b64_tr_b16 a[184:185], v18 offset:24576
  ds_read_b64_tr_b16 a[186:187], v18 offset:25088
  buffer_load_dwordx2 v[186:187], v254, s[36:39], s24 offen offset:1280 sc1
  v_mfma_f32_32x32x16_bf16 v[120:135], a[204:207], a[120:123], v[120:135]
  ds_read_b64_tr_b16 a[188:189], v18 offset:28672
  ds_read_b64_tr_b16 a[190:191], v18 offset:29184
  buffer_load_dwordx2 v[188:189], v254, s[36:39], s24 offen offset:2560 sc1
  v_mfma_f32_32x32x16_bf16 v[120:135], a[208:211], a[124:127], v[120:135]
  s_waitcnt lgkmcnt(6)
  ds_read_b64_tr_b16 a[192:193], v18 offset:32768
  ds_read_b64_tr_b16 a[194:195], v18 offset:33280
  buffer_load_dwordx2 v[190:191], v254, s[36:39], s25 offen offset:0 sc1
  v_mfma_f32_32x32x16_bf16 v[120:135], a[160:163], a[128:131], v[120:135]
  v_add_u32 v18, 4294946816, v18
  v_add_u32 v19, 4294946816, v19
  v_add_u32 v20, 4294946816, v20
  v_add_u32 v21, 4294946816, v21
  ds_read_b64_tr_b16 a[196:197], v19 offset:0
  ds_read_b64_tr_b16 a[198:199], v19 offset:512
  buffer_load_dwordx2 v[192:193], v254, s[36:39], s25 offen offset:1280 sc1
  v_mfma_f32_32x32x16_bf16 v[120:135], a[164:167], a[132:135], v[120:135]
  ds_read_b64_tr_b16 a[200:201], v19 offset:4096
  ds_read_b64_tr_b16 a[202:203], v19 offset:4608
  buffer_load_dwordx2 v[194:195], v254, s[36:39], s25 offen offset:2560 sc1
  v_mfma_f32_32x32x16_bf16 v[120:135], a[168:171], a[136:139], v[120:135]
  ds_read_b64_tr_b16 a[204:205], v19 offset:8192
  ds_read_b64_tr_b16 a[206:207], v19 offset:8704
  buffer_load_dwordx2 v[196:197], v254, s[36:39], s26 offen offset:0 sc1
  v_mfma_f32_32x32x16_bf16 v[120:135], a[172:175], a[140:143], v[120:135]
  s_waitcnt lgkmcnt(6)
  ds_read_b64_tr_b16 a[208:209], v19 offset:12288
  ds_read_b64_tr_b16 a[210:211], v19 offset:12800
  buffer_load_dwordx2 v[198:199], v254, s[36:39], s26 offen offset:1280 sc1
  v_mfma_f32_32x32x16_bf16 v[120:135], a[180:183], a[144:147], v[120:135]
  ds_read_b64_tr_b16 a[160:161], v19 offset:20480
  ds_read_b64_tr_b16 a[162:163], v19 offset:20992
  buffer_load_dwordx2 v[4:5], v254, s[36:39], s26 offen offset:2560 sc1
  v_mfma_f32_32x32x16_bf16 v[120:135], a[184:187], a[148:151], v[120:135]
  ds_read_b64_tr_b16 a[164:165], v19 offset:24576
  ds_read_b64_tr_b16 a[166:167], v19 offset:25088
  buffer_load_dwordx2 v[6:7], v254, s[36:39], s27 offen offset:0 sc1
  v_mfma_f32_32x32x16_bf16 v[120:135], a[188:191], a[152:155], v[120:135]
  ds_read_b64_tr_b16 a[168:169], v19 offset:28672
  ds_read_b64_tr_b16 a[170:171], v19 offset:29184
  buffer_load_dwordx2 v[8:9], v254, s[36:39], s27 offen offset:1280 sc1
  v_mfma_f32_32x32x16_bf16 v[120:135], a[192:195], a[156:159], v[120:135]
  s_waitcnt lgkmcnt(6)
  ds_read_b64_tr_b16 a[172:173], v19 offset:32768
  ds_read_b64_tr_b16 a[174:175], v19 offset:33280
  buffer_load_dwordx2 v[10:11], v254, s[36:39], s27 offen offset:2560 sc1
  v_mfma_f32_32x32x16_bf16 v[120:135], a[220:223], v[28:31], v[120:135]
  buffer_load_dwordx2 v[12:13], v254, s[36:39], s28 offen offset:0 sc1
  v_mfma_f32_32x32x16_bf16 v[136:151], a[196:199], a[112:115], v[136:151]
  ds_read_b64_tr_b16 a[180:181], v19 offset:40960
  ds_read_b64_tr_b16 a[182:183], v19 offset:41472
  buffer_load_dwordx2 v[14:15], v254, s[36:39], s28 offen offset:1280 sc1
  s_nop 1
  s_nop 4
  v_mul_f32 v200, v212, v120
  v_mul_f32 v201, v212, v121
  v_mul_f32 v202, v212, v122
  v_mul_f32 v203, v212, v123
  v_mfma_f32_32x32x16_bf16 v[136:151], a[200:203], a[116:119], v[136:151]
  ds_read_b64_tr_b16 a[184:185], v19 offset:45056
  ds_read_b64_tr_b16 a[186:187], v19 offset:45568
  buffer_load_dwordx2 v[16:17], v254, s[36:39], s28 offen offset:2560 sc1
  v_mul_f32 v204, v212, v124
  v_mul_f32 v205, v212, v125
  v_mul_f32 v206, v212, v126
  v_mul_f32 v207, v212, v127
  v_exp_f32 v200, v200
  v_mfma_f32_32x32x16_bf16 v[136:151], a[204:207], a[120:123], v[136:151]
  ds_read_b64_tr_b16 a[188:189], v19 offset:49152
  ds_read_b64_tr_b16 a[190:191], v19 offset:49664
  buffer_load_dwordx4 a[32:35], v38, s[20:23], s64 offen offset:3072 sc1
  v_mul_f32 v120, v120, v128
  v_exp_f32 v201, v201
  v_mul_f32 v121, v121, v129
  v_exp_f32 v202, v202
  v_mfma_f32_32x32x16_bf16 v[136:151], a[208:211], a[124:127], v[136:151]
  s_waitcnt lgkmcnt(6)
  ds_read_b64_tr_b16 a[192:193], v19 offset:53248
  ds_read_b64_tr_b16 a[194:195], v19 offset:53760
  v_mul_f32 v122, v122, v130
  v_exp_f32 v203, v203
  v_mul_f32 v123, v123, v131
  v_exp_f32 v204, v204
  v_mfma_f32_32x32x16_bf16 v[136:151], a[160:163], a[128:131], v[136:151]
  ds_read_b64_tr_b16 a[196:197], v20 offset:0
  ds_read_b64_tr_b16 a[198:199], v20 offset:512
  s_add_u32 s64, s66, 9216
  buffer_load_dwordx4 a[36:39], v38, s[20:23], s64 offen offset:0 sc1
  v_mul_f32 v124, v124, v132
  v_exp_f32 v205, v205
  v_mul_f32 v125, v125, v133
  v_mfma_f32_32x32x16_bf16 v[136:151], a[164:167], a[132:135], v[136:151]
  ds_read_b64_tr_b16 a[200:201], v20 offset:4096
  ds_read_b64_tr_b16 a[202:203], v20 offset:4608
  v_exp_f32 v206, v206
  v_mul_f32 v126, v126, v134
  v_exp_f32 v207, v207
  v_mul_f32 v127, v127, v135
  v_mfma_f32_32x32x16_bf16 v[136:151], a[168:171], a[136:139], v[136:151]
  ds_read_b64_tr_b16 a[204:205], v20 offset:8192
  ds_read_b64_tr_b16 a[206:207], v20 offset:8704
  s_add_u32 s64, s66, 10240
  buffer_load_dwordx4 a[40:43], v38, s[20:23], s64 offen offset:0 sc1
  v_fma_f32 v200, v200, v213, v213
  v_fma_f32 v201, v201, v213, v213
  v_fma_f32 v202, v202, v213, v213
  v_fma_f32 v203, v203, v213, v213
  v_fma_f32 v204, v204, v213, v213
  v_mfma_f32_32x32x16_bf16 v[136:151], a[172:175], a[140:143], v[136:151]
  s_waitcnt lgkmcnt(6)
  ds_read_b64_tr_b16 a[208:209], v20 offset:12288
  ds_read_b64_tr_b16 a[210:211], v20 offset:12800
  v_fma_f32 v205, v205, v213, v213
  v_fma_f32 v206, v206, v213, v213
  v_fma_f32 v207, v207, v213, v213
  v_rcp_f32 v200, v200
  v_rcp_f32 v201, v201
  v_mfma_f32_32x32x16_bf16 v[136:151], a[180:183], a[144:147], v[136:151]
  ds_read_b64_tr_b16 a[160:161], v20 offset:20480
  ds_read_b64_tr_b16 a[162:163], v20 offset:20992
  buffer_load_dwordx4 a[44:47], v38, s[20:23], s64 offen offset:1024 sc1
  v_rcp_f32 v202, v202
  v_rcp_f32 v203, v203
  v_mfma_f32_32x32x16_bf16 v[136:151], a[184:187], a[148:151], v[136:151]
  ds_read_b64_tr_b16 a[164:165], v20 offset:24576
  ds_read_b64_tr_b16 a[166:167], v20 offset:25088
  v_rcp_f32 v204, v204
  v_rcp_f32 v205, v205
  v_rcp_f32 v206, v206
  v_mfma_f32_32x32x16_bf16 v[136:151], a[188:191], a[152:155], v[136:151]
  ds_read_b64_tr_b16 a[168:169], v20 offset:28672
  ds_read_b64_tr_b16 a[170:171], v20 offset:29184
  buffer_load_dwordx4 a[48:51], v38, s[20:23], s64 offen offset:2048 sc1
  v_rcp_f32 v207, v207
  s_add_u32 s46, s57, 16384
  v_mul_f32 v120, v120, v200
  v_mul_f32 v121, v121, v201
  v_mfma_f32_32x32x16_bf16 v[136:151], a[192:195], a[156:159], v[136:151]
  s_waitcnt lgkmcnt(6)
  ds_read_b64_tr_b16 a[172:173], v20 offset:32768
  ds_read_b64_tr_b16 a[174:175], v20 offset:33280
  v_mul_f32 v122, v122, v202
  v_mul_f32 v123, v123, v203
  v_mul_f32 v124, v124, v204
  v_mul_f32 v125, v125, v205
  v_mul_f32 v126, v126, v206
  v_mfma_f32_32x32x16_bf16 v[136:151], a[224:227], v[28:31], v[136:151]
  buffer_load_dwordx4 a[52:55], v38, s[20:23], s64 offen offset:3072 sc1
  v_mul_f32 v127, v127, v207
  v_cvt_pk_bf16_f32 v128, v120, v121
  v_cvt_pk_bf16_f32 v129, v122, v123
  v_cvt_pk_bf16_f32 v130, v124, v125
  v_cvt_pk_bf16_f32 v131, v126, v127
  buffer_store_dwordx4 v[128:131], v23, s[20:23], s46 offen offset:0 sc1
  v_mfma_f32_32x32x16_bf16 v[152:167], a[196:199], a[112:115], v[152:167]
  ds_read_b64_tr_b16 a[180:181], v20 offset:40960
  ds_read_b64_tr_b16 a[182:183], v20 offset:41472
  s_nop 1
  v_mul_f32 v200, v212, v136
  v_mul_f32 v201, v212, v137
  v_mul_f32 v202, v212, v138
  v_mul_f32 v203, v212, v139
  v_mul_f32 v204, v212, v140
  v_mul_f32 v205, v212, v141
  v_mfma_f32_32x32x16_bf16 v[152:167], a[200:203], a[116:119], v[152:167]
  ds_read_b64_tr_b16 a[184:185], v20 offset:45056
  ds_read_b64_tr_b16 a[186:187], v20 offset:45568
  s_add_u32 s64, s66, 14336
  buffer_load_dwordx4 a[56:59], v38, s[20:23], s64 offen offset:0 sc1
  v_mul_f32 v206, v212, v142
  v_mul_f32 v207, v212, v143
  v_exp_f32 v200, v200
  v_mul_f32 v136, v136, v144
  v_mfma_f32_32x32x16_bf16 v[152:167], a[204:207], a[120:123], v[152:167]
  ds_read_b64_tr_b16 a[188:189], v20 offset:49152
  ds_read_b64_tr_b16 a[190:191], v20 offset:49664
  v_exp_f32 v201, v201
  v_mul_f32 v137, v137, v145
  v_exp_f32 v202, v202
  v_mfma_f32_32x32x16_bf16 v[152:167], a[208:211], a[124:127], v[152:167]
  s_waitcnt lgkmcnt(6)
  ds_read_b64_tr_b16 a[192:193], v20 offset:53248
  ds_read_b64_tr_b16 a[194:195], v20 offset:53760
  s_add_u32 s64, s66, 15360
  buffer_load_dwordx4 a[60:63], v38, s[20:23], s64 offen offset:0 sc1
  v_mul_f32 v138, v138, v146
  v_exp_f32 v203, v203
  v_mul_f32 v139, v139, v147
  v_exp_f32 v204, v204
  v_mfma_f32_32x32x16_bf16 v[152:167], a[160:163], a[128:131], v[152:167]
  ds_read_b64_tr_b16 a[196:197], v21 offset:0
  ds_read_b64_tr_b16 a[198:199], v21 offset:512
  v_mul_f32 v140, v140, v148
  v_exp_f32 v205, v205
  v_mul_f32 v141, v141, v149
  v_exp_f32 v206, v206
  v_mfma_f32_32x32x16_bf16 v[152:167], a[164:167], a[132:135], v[152:167]
  ds_read_b64_tr_b16 a[200:201], v21 offset:4096
  ds_read_b64_tr_b16 a[202:203], v21 offset:4608
  buffer_load_dwordx4 a[64:67], v38, s[20:23], s64 offen offset:1024 sc1
  v_mul_f32 v142, v142, v150
  v_exp_f32 v207, v207
  v_mul_f32 v143, v143, v151
  v_mfma_f32_32x32x16_bf16 v[152:167], a[168:171], a[136:139], v[152:167]
  ds_read_b64_tr_b16 a[204:205], v21 offset:8192
  ds_read_b64_tr_b16 a[206:207], v21 offset:8704
  v_fma_f32 v200, v200, v213, v213
  v_fma_f32 v201, v201, v213, v213
  v_fma_f32 v202, v202, v213, v213
  v_fma_f32 v203, v203, v213, v213
  v_fma_f32 v204, v204, v213, v213
  v_fma_f32 v205, v205, v213, v213
  v_mfma_f32_32x32x16_bf16 v[152:167], a[172:175], a[140:143], v[152:167]
  s_waitcnt lgkmcnt(6)
  ds_read_b64_tr_b16 a[208:209], v21 offset:12288
  ds_read_b64_tr_b16 a[210:211], v21 offset:12800
  buffer_load_dwordx4 a[68:71], v38, s[20:23], s64 offen offset:2048 sc1
  v_fma_f32 v206, v206, v213, v213
  v_fma_f32 v207, v207, v213, v213
  v_rcp_f32 v200, v200
  v_rcp_f32 v201, v201
  v_mfma_f32_32x32x16_bf16 v[152:167], a[180:183], a[144:147], v[152:167]
  ds_read_b64_tr_b16 a[160:161], v21 offset:20480
  ds_read_b64_tr_b16 a[162:163], v21 offset:20992
  buffer_load_dword v250, v248, s[20:23], s87 offen offset:4 sc1
  v_rcp_f32 v202, v202
  v_rcp_f32 v203, v203
  v_mfma_f32_32x32x16_bf16 v[152:167], a[184:187], a[148:151], v[152:167]
  ds_read_b64_tr_b16 a[164:165], v21 offset:24576
  ds_read_b64_tr_b16 a[166:167], v21 offset:25088
  buffer_load_dwordx4 a[72:75], v38, s[20:23], s64 offen offset:3072 sc1
  v_rcp_f32 v204, v204
  v_rcp_f32 v205, v205
  v_rcp_f32 v206, v206
  v_mfma_f32_32x32x16_bf16 v[152:167], a[188:191], a[152:155], v[152:167]
  ds_read_b64_tr_b16 a[168:169], v21 offset:28672
  ds_read_b64_tr_b16 a[170:171], v21 offset:29184
  v_rcp_f32 v207, v207
  s_add_u32 s46, s57, 16384
  v_mul_f32 v136, v136, v200
  v_mul_f32 v137, v137, v201
  v_mfma_f32_32x32x16_bf16 v[152:167], a[192:195], a[156:159], v[152:167]
  s_waitcnt lgkmcnt(6)
  ds_read_b64_tr_b16 a[172:173], v21 offset:32768
  ds_read_b64_tr_b16 a[174:175], v21 offset:33280
  s_add_u32 s64, s66, 19456
  buffer_load_dwordx4 a[76:79], v38, s[20:23], s64 offen offset:0 sc1
  v_mul_f32 v138, v138, v202
  v_mul_f32 v139, v139, v203
  v_mul_f32 v140, v140, v204
  v_mul_f32 v141, v141, v205
  v_mul_f32 v142, v142, v206
  v_mul_f32 v143, v143, v207
  v_mfma_f32_32x32x16_bf16 v[152:167], a[228:231], v[28:31], v[152:167]
  v_cvt_pk_bf16_f32 v144, v136, v137
  v_cvt_pk_bf16_f32 v145, v138, v139
  v_cvt_pk_bf16_f32 v146, v140, v141
  v_cvt_pk_bf16_f32 v147, v142, v143
  buffer_store_dwordx4 v[144:147], v23, s[20:23], s46 offen offset:512 sc1
  v_mfma_f32_32x32x16_bf16 v[168:183], a[196:199], a[112:115], v[168:183]
  ds_read_b64_tr_b16 a[180:181], v21 offset:40960
  ds_read_b64_tr_b16 a[182:183], v21 offset:41472
  s_add_u32 s64, s66, 20480
  buffer_load_dwordx4 a[80:83], v38, s[20:23], s64 offen offset:0 sc1
  s_nop 1
  v_mul_f32 v200, v212, v152
  v_mul_f32 v201, v212, v153
  v_mul_f32 v202, v212, v154
  v_mul_f32 v203, v212, v155
  v_mfma_f32_32x32x16_bf16 v[168:183], a[200:203], a[116:119], v[168:183]
  ds_read_b64_tr_b16 a[184:185], v21 offset:45056
  ds_read_b64_tr_b16 a[186:187], v21 offset:45568
  v_mul_f32 v204, v212, v156
  v_mul_f32 v205, v212, v157
  v_mul_f32 v206, v212, v158
  v_mul_f32 v207, v212, v159
  v_exp_f32 v200, v200
  v_mfma_f32_32x32x16_bf16 v[168:183], a[204:207], a[120:123], v[168:183]
  ds_read_b64_tr_b16 a[188:189], v21 offset:49152
  ds_read_b64_tr_b16 a[190:191], v21 offset:49664
  buffer_load_dwordx4 a[84:87], v38, s[20:23], s64 offen offset:1024 sc1
  v_mul_f32 v152, v152, v160
  v_exp_f32 v201, v201
  v_mul_f32 v153, v153, v161
  v_exp_f32 v202, v202
  v_mfma_f32_32x32x16_bf16 v[168:183], a[208:211], a[124:127], v[168:183]
  s_waitcnt lgkmcnt(6)
  ds_read_b64_tr_b16 a[192:193], v21 offset:53248
  ds_read_b64_tr_b16 a[194:195], v21 offset:53760
  v_mul_f32 v154, v154, v162
  v_exp_f32 v203, v203
  v_mul_f32 v155, v155, v163
  v_mfma_f32_32x32x16_bf16 v[168:183], a[160:163], a[128:131], v[168:183]
  buffer_load_dwordx4 a[88:91], v38, s[20:23], s64 offen offset:2048 sc1
  v_exp_f32 v204, v204
  v_mul_f32 v156, v156, v164
  v_exp_f32 v205, v205
  v_mul_f32 v157, v157, v165
  v_mfma_f32_32x32x16_bf16 v[168:183], a[164:167], a[132:135], v[168:183]
  v_exp_f32 v206, v206
  v_mul_f32 v158, v158, v166
  v_exp_f32 v207, v207
  v_mfma_f32_32x32x16_bf16 v[168:183], a[168:171], a[136:139], v[168:183]
  buffer_load_dwordx4 a[92:95], v38, s[20:23], s64 offen offset:3072 sc1
  v_mul_f32 v159, v159, v167
  v_fma_f32 v200, v200, v213, v213
  v_fma_f32 v201, v201, v213, v213
  v_fma_f32 v202, v202, v213, v213
  v_fma_f32 v203, v203, v213, v213
  v_fma_f32 v204, v204, v213, v213
  v_mfma_f32_32x32x16_bf16 v[168:183], a[172:175], a[140:143], v[168:183]
  v_fma_f32 v205, v205, v213, v213
  v_fma_f32 v206, v206, v213, v213
  v_fma_f32 v207, v207, v213, v213
  v_rcp_f32 v200, v200
  s_waitcnt lgkmcnt(0)
  v_mfma_f32_32x32x16_bf16 v[168:183], a[180:183], a[144:147], v[168:183]
  s_add_u32 s64, s66, 24576
  buffer_load_dwordx4 a[96:99], v38, s[20:23], s64 offen offset:0 sc1
  v_rcp_f32 v201, v201
  v_rcp_f32 v202, v202
  v_rcp_f32 v203, v203
  v_mfma_f32_32x32x16_bf16 v[168:183], a[184:187], a[148:151], v[168:183]
  v_rcp_f32 v204, v204
  v_rcp_f32 v205, v205
  v_rcp_f32 v206, v206
  v_mfma_f32_32x32x16_bf16 v[168:183], a[188:191], a[152:155], v[168:183]
  s_add_u32 s64, s66, 25600
  buffer_load_dwordx4 a[100:103], v38, s[20:23], s64 offen offset:0 sc1
  v_rcp_f32 v207, v207
  s_add_u32 s46, s57, 20480
  v_mul_f32 v152, v152, v200
  v_mul_f32 v153, v153, v201
  v_mfma_f32_32x32x16_bf16 v[168:183], a[192:195], a[156:159], v[168:183]
  v_mul_f32 v154, v154, v202
  v_mul_f32 v155, v155, v203
  v_mul_f32 v156, v156, v204
  v_mul_f32 v157, v157, v205
  v_mul_f32 v158, v158, v206
  v_mfma_f32_32x32x16_bf16 v[168:183], a[232:235], v[28:31], v[168:183]
  buffer_load_dwordx4 a[104:107], v38, s[20:23], s64 offen offset:1024 sc1
  v_mul_f32 v159, v159, v207
  v_cvt_pk_bf16_f32 v160, v152, v153
  v_cvt_pk_bf16_f32 v161, v154, v155
  v_cvt_pk_bf16_f32 v162, v156, v157
  v_cvt_pk_bf16_f32 v163, v158, v159
  buffer_store_dwordx4 v[160:163], v23, s[20:23], s46 offen offset:0 sc1
  s_mov_b32 s85, s63
  v_mov_b32 v35, v211
  v_mov_b32 v37, v208
  v_add_u32 v209, s88, v38
  v_add_u32 v22, 65536, v209
  v_add_u32 v28, 131072, v209
  ds_read_b128 a[112:115], v209 offset:24576
  ds_read_b128 a[116:119], v209 offset:28672
  ds_read_b128 a[120:123], v209 offset:53248
  ds_read_b128 a[124:127], v209 offset:12288
  ds_read_b128 a[128:131], v28 offset:28672
  ds_read_b128 a[132:135], v22 offset:8192
  ds_read_b128 a[136:139], v22 offset:28672
  ds_read_b128 a[140:143], v22 offset:49152
  ds_read_b128 a[144:147], v28 offset:4096
  ds_read_b128 a[148:151], v28 offset:24576
  s_waitcnt vmcnt(11)
  v_xor_b32 v39, s92, v250
  v_cmp_ne_u32 vcc, 0, v39
  s_nop 3
  s_cbranch_vccnz Y_poll6_slow
Y_poll6_ret:
  v_mul_f32 v200, v212, v168
  s_add_u32 s65, s67, 0
  v_xor_b32 v39, s92, v17
  v_mul_f32 v201, v212, v169
  v_bitop3_b32 v39, v39, v15, s92 bitop3:0xf6
  v_mul_f32 v202, v212, v170
  v_bitop3_b32 v39, v39, v13, s92 bitop3:0xf6
  v_mul_f32 v203, v212, v171
  v_bitop3_b32 v39, v39, v11, s92 bitop3:0xf6
  v_mul_f32 v204, v212, v172
  v_bitop3_b32 v39, v39, v9, s92 bitop3:0xf6
  v_bitop3_b32 v39, v39, v7, s92 bitop3:0xf6
  v_mul_f32 v205, v212, v173
  v_bitop3_b32 v39, v39, v5, s92 bitop3:0xf6
  buffer_load_dwordx4 a[220:223], v38, s[20:23], s65 offen offset:0 sc1
  v_mul_f32 v206, v212, v174
  v_bitop3_b32 v39, v39, v199, s92 bitop3:0xf6
  v_mul_f32 v207, v212, v175
  v_bitop3_b32 v39, v39, v197, s92 bitop3:0xf6
  v_bitop3_b32 v39, v39, v195, s92 bitop3:0xf6
  v_exp_f32 v200, v200
  v_bitop3_b32 v39, v39, v193, s92 bitop3:0xf6
  v_mul_f32 v168, v168, v176
  v_bitop3_b32 v39, v39, v191, s92 bitop3:0xf6
  v_exp_f32 v201, v201
  v_bitop3_b32 v39, v39, v189, s92 bitop3:0xf6
  v_bitop3_b32 v39, v39, v187, s92 bitop3:0xf6
  buffer_load_dwordx4 a[224:227], v38, s[20:23], s65 offen offset:1024 sc1
  v_mul_f32 v169, v169, v177
  v_bitop3_b32 v39, v39, v185, s92 bitop3:0xf6
  v_exp_f32 v202, v202
  v_cmp_ne_u32 vcc, 0, v39
  v_mul_f32 v170, v170, v178
  s_nop 2
  s_cbranch_vccnz Y_poll7_slow
Y_poll7_ret:
  v_fmac_f32 v14, v246, v16
  v_exp_f32 v203, v203
  v_fmac_f32_dpp v14, v16, v247 quad_perm:[1,0,3,2] row_mask:0xf bank_mask:0xf
  v_mul_f32 v171, v171, v179
  v_fmac_f32 v12, v246, v14
  buffer_load_dwordx4 a[228:231], v38, s[20:23], s65 offen offset:2048 sc1
  v_exp_f32 v204, v204
  v_fmac_f32_dpp v12, v14, v247 quad_perm:[1,0,3,2] row_mask:0xf bank_mask:0xf
  v_fmac_f32 v10, v246, v12
  v_mul_f32 v172, v172, v180
  v_fmac_f32_dpp v10, v12, v247 quad_perm:[1,0,3,2] row_mask:0xf bank_mask:0xf
  v_exp_f32 v205, v205
  v_fmac_f32 v8, v246, v10
  v_mul_f32 v173, v173, v181
  v_fmac_f32_dpp v8, v10, v247 quad_perm:[1,0,3,2] row_mask:0xf bank_mask:0xf
  v_fmac_f32 v6, v246, v8
  v_exp_f32 v206, v206
  v_fmac_f32_dpp v6, v8, v247 quad_perm:[1,0,3,2] row_mask:0xf bank_mask:0xf
  buffer_load_dwordx4 a[232:235], v38, s[20:23], s65 offen offset:3072 sc1
  v_mul_f32 v174, v174, v182
  v_fmac_f32 v4, v246, v6
  v_exp_f32 v207, v207
  v_fmac_f32_dpp v4, v6, v247 quad_perm:[1,0,3,2] row_mask:0xf bank_mask:0xf
  v_fmac_f32 v198, v246, v4
  v_mul_f32 v175, v175, v183
  v_fmac_f32_dpp v198, v4, v247 quad_perm:[1,0,3,2] row_mask:0xf bank_mask:0xf
  v_fma_f32 v200, v200, v213, v213
  v_fmac_f32 v196, v246, v198
  v_fma_f32 v201, v201, v213, v213
  v_fmac_f32_dpp v196, v198, v247 quad_perm:[1,0,3,2] row_mask:0xf bank_mask:0xf
  s_add_u32 s65, s67, 4096
  v_fmac_f32 v194, v246, v196
  v_fma_f32 v202, v202, v213, v213
  v_fmac_f32_dpp v194, v196, v247 quad_perm:[1,0,3,2] row_mask:0xf bank_mask:0xf
  v_fma_f32 v203, v203, v213, v213
  v_fmac_f32 v192, v246, v194
  v_fma_f32 v204, v204, v213, v213
  v_fmac_f32_dpp v192, v194, v247 quad_perm:[1,0,3,2] row_mask:0xf bank_mask:0xf
  v_fma_f32 v205, v205, v213, v213
  v_fmac_f32 v190, v246, v192
  v_fmac_f32_dpp v190, v192, v247 quad_perm:[1,0,3,2] row_mask:0xf bank_mask:0xf
  v_fma_f32 v206, v206, v213, v213
  v_fmac_f32 v188, v246, v190
  buffer_load_dwordx4 a[196:199], v38, s[20:23], s65 offen offset:0 sc1
  v_fma_f32 v207, v207, v213, v213
  v_fmac_f32_dpp v188, v190, v247 quad_perm:[1,0,3,2] row_mask:0xf bank_mask:0xf
  v_rcp_f32 v200, v200
  v_fmac_f32 v186, v246, v188
  v_fmac_f32_dpp v186, v188, v247 quad_perm:[1,0,3,2] row_mask:0xf bank_mask:0xf
  v_rcp_f32 v201, v201
  v_fmac_f32 v184, v246, v186
  v_rcp_f32 v202, v202
  v_fmac_f32_dpp v184, v186, v247 quad_perm:[1,0,3,2] row_mask:0xf bank_mask:0xf
  v_rcp_f32 v203, v203
  ds_write_b32 v242, v184 offset:12
  v_fmac_f32 v220, v244, v184
  buffer_load_dwordx4 a[200:203], v38, s[20:23], s65 offen offset:1024 sc1
  v_rcp_f32 v204, v204
  v_fmac_f32_dpp v220, v184, v245 quad_perm:[1,0,3,2] row_mask:0xf bank_mask:0xf
  v_rcp_f32 v205, v205
  v_fmac_f32 v221, v244, v220
  v_rcp_f32 v206, v206
  v_fmac_f32_dpp v221, v220, v245 quad_perm:[1,0,3,2] row_mask:0xf bank_mask:0xf
  v_fmac_f32 v222, v244, v221
  v_rcp_f32 v207, v207
  v_fmac_f32_dpp v222, v221, v245 quad_perm:[1,0,3,2] row_mask:0xf bank_mask:0xf
  s_add_u32 s46, s57, 20480
  v_fmac_f32 v223, v244, v222
  buffer_load_dwordx4 a[204:207], v38, s[20:23], s65 offen offset:2048 sc1
  v_mul_f32 v168, v168, v200
  v_fmac_f32_dpp v223, v222, v245 quad_perm:[1,0,3,2] row_mask:0xf bank_mask:0xf
  v_fmac_f32 v224, v244, v223
  v_mul_f32 v169, v169, v201
  v_fmac_f32_dpp v224, v223, v245 quad_perm:[1,0,3,2] row_mask:0xf bank_mask:0xf
  v_mul_f32 v170, v170, v202
  v_fmac_f32 v225, v244, v224
  v_mul_f32 v171, v171, v203
  v_fmac_f32_dpp v225, v224, v245 quad_perm:[1,0,3,2] row_mask:0xf bank_mask:0xf
  v_fmac_f32 v226, v244, v225
  v_mul_f32 v172, v172, v204
  v_fmac_f32_dpp v226, v225, v245 quad_perm:[1,0,3,2] row_mask:0xf bank_mask:0xf
  buffer_load_dwordx4 a[208:211], v38, s[20:23], s65 offen offset:3072 sc1
  v_mul_f32 v173, v173, v205
  ds_write_b128 v242, v[220:223] offset:16
  v_mul_f32 v174, v174, v206
  ds_write_b128 v242, v[224:227] offset:32
  v_mul_f32 v175, v175, v207
  v_cvt_pk_bf16_f32 v176, v168, v169
  v_cvt_pk_bf16_f32 v177, v170, v171
  v_cvt_pk_bf16_f32 v178, v172, v173
  v_cvt_pk_bf16_f32 v179, v174, v175
  buffer_store_dwordx4 v[176:179], v23, s[20:23], s46 offen offset:512 sc1
  s_waitcnt lgkmcnt(0)
  s_barrier
  ds_read_b32 v216, v253 offset:12
  ds_read_b32 v217, v253 offset:1548
  ds_read_b32 v218, v253 offset:3084
  ds_read_b32 v219, v253 offset:4620
  ds_read_b32 v228, v253 offset:6156
  s_waitcnt lgkmcnt(4)
  v_fmac_f32 v40, v232, v216
  s_waitcnt lgkmcnt(3)
  v_fmac_f32 v56, v234, v217
  v_fmac_f32_dpp v40, v216, v233 quad_perm:[1,0,3,2] row_mask:0xf bank_mask:0xf
  v_fmac_f32_dpp v56, v217, v235 quad_perm:[1,0,3,2] row_mask:0xf bank_mask:0xf
  v_fmac_f32 v41, v232, v40
  v_fmac_f32 v57, v234, v56
  v_fmac_f32_dpp v41, v40, v233 quad_perm:[1,0,3,2] row_mask:0xf bank_mask:0xf
  v_fmac_f32_dpp v57, v56, v235 quad_perm:[1,0,3,2] row_mask:0xf bank_mask:0xf
  v_fmac_f32 v42, v232, v41
  v_fmac_f32 v58, v234, v57
  v_fmac_f32_dpp v42, v41, v233 quad_perm:[1,0,3,2] row_mask:0xf bank_mask:0xf
  v_fmac_f32_dpp v58, v57, v235 quad_perm:[1,0,3,2] row_mask:0xf bank_mask:0xf
  v_cvt_pk_bf16_f32 v40, v40, v41
  v_cvt_pk_bf16_f32 v56, v56, v57
  v_fmac_f32 v43, v232, v42
  v_fmac_f32 v59, v234, v58
  v_fmac_f32_dpp v43, v42, v233 quad_perm:[1,0,3,2] row_mask:0xf bank_mask:0xf
  v_fmac_f32_dpp v59, v58, v235 quad_perm:[1,0,3,2] row_mask:0xf bank_mask:0xf
  v_fmac_f32 v44, v232, v43
  v_fmac_f32 v60, v234, v59
  v_fmac_f32_dpp v44, v43, v233 quad_perm:[1,0,3,2] row_mask:0xf bank_mask:0xf
  v_fmac_f32_dpp v60, v59, v235 quad_perm:[1,0,3,2] row_mask:0xf bank_mask:0xf
  v_cvt_pk_bf16_f32 v41, v42, v43
  v_cvt_pk_bf16_f32 v57, v58, v59
  v_fmac_f32 v45, v232, v44
  v_fmac_f32 v61, v234, v60
  v_fmac_f32_dpp v45, v44, v233 quad_perm:[1,0,3,2] row_mask:0xf bank_mask:0xf
  v_fmac_f32_dpp v61, v60, v235 quad_perm:[1,0,3,2] row_mask:0xf bank_mask:0xf
  v_fmac_f32 v46, v232, v45
  v_fmac_f32 v62, v234, v61
  v_fmac_f32_dpp v46, v45, v233 quad_perm:[1,0,3,2] row_mask:0xf bank_mask:0xf
  v_fmac_f32_dpp v62, v61, v235 quad_perm:[1,0,3,2] row_mask:0xf bank_mask:0xf
  v_cvt_pk_bf16_f32 v42, v44, v45
  v_cvt_pk_bf16_f32 v58, v60, v61
  v_fmac_f32 v47, v232, v46
  v_fmac_f32 v63, v234, v62
  v_fmac_f32_dpp v47, v46, v233 quad_perm:[1,0,3,2] row_mask:0xf bank_mask:0xf
  v_fmac_f32_dpp v63, v62, v235 quad_perm:[1,0,3,2] row_mask:0xf bank_mask:0xf
  v_fmac_f32 v48, v232, v47
  v_fmac_f32 v64, v234, v63
  v_fmac_f32_dpp v48, v47, v233 quad_perm:[1,0,3,2] row_mask:0xf bank_mask:0xf
  v_fmac_f32_dpp v64, v63, v235 quad_perm:[1,0,3,2] row_mask:0xf bank_mask:0xf
  v_cvt_pk_bf16_f32 v43, v46, v47
  v_cvt_pk_bf16_f32 v59, v62, v63
  v_fmac_f32 v49, v232, v48
  v_fmac_f32 v65, v234, v64
  v_fmac_f32_dpp v49, v48, v233 quad_perm:[1,0,3,2] row_mask:0xf bank_mask:0xf
  v_fmac_f32_dpp v65, v64, v235 quad_perm:[1,0,3,2] row_mask:0xf bank_mask:0xf
  v_fmac_f32 v50, v232, v49
  v_fmac_f32 v66, v234, v65
  v_fmac_f32_dpp v50, v49, v233 quad_perm:[1,0,3,2] row_mask:0xf bank_mask:0xf
  v_fmac_f32_dpp v66, v65, v235 quad_perm:[1,0,3,2] row_mask:0xf bank_mask:0xf
  v_cvt_pk_bf16_f32 v44, v48, v49
  v_cvt_pk_bf16_f32 v60, v64, v65
  ds_write_b128 v2, v[40:43] offset:0
  ds_write_b128 v2, v[56:59] offset:2048
  v_fmac_f32 v51, v232, v50
  v_fmac_f32 v67, v234, v66
  v_fmac_f32_dpp v51, v50, v233 quad_perm:[1,0,3,2] row_mask:0xf bank_mask:0xf
  v_fmac_f32_dpp v67, v66, v235 quad_perm:[1,0,3,2] row_mask:0xf bank_mask:0xf
  v_fmac_f32 v52, v232, v51
  v_fmac_f32 v68, v234, v67
  v_fmac_f32_dpp v52, v51, v233 quad_perm:[1,0,3,2] row_mask:0xf bank_mask:0xf
  v_fmac_f32_dpp v68, v67, v235 quad_perm:[1,0,3,2] row_mask:0xf bank_mask:0xf
  v_cvt_pk_bf16_f32 v45, v50, v51
  v_cvt_pk_bf16_f32 v61, v66, v67
  v_fmac_f32 v53, v232, v52
  v_fmac_f32 v69, v234, v68
  v_fmac_f32_dpp v53, v52, v233 quad_perm:[1,0,3,2] row_mask:0xf bank_mask:0xf
  v_fmac_f32_dpp v69, v68, v235 quad_perm:[1,0,3,2] row_mask:0xf bank_mask:0xf
  v_fmac_f32 v54, v232, v53
  v_fmac_f32 v70, v234, v69
  v_fmac_f32_dpp v54, v53, v233 quad_perm:[1,0,3,2] row_mask:0xf bank_mask:0xf
  v_fmac_f32_dpp v70, v69, v235 quad_perm:[1,0,3,2] row_mask:0xf bank_mask:0xf
  v_cvt_pk_bf16_f32 v46, v52, v53
  v_cvt_pk_bf16_f32 v62, v68, v69
  v_fmac_f32 v55, v232, v54
  v_fmac_f32 v71, v234, v70
  v_fmac_f32_dpp v55, v54, v233 quad_perm:[1,0,3,2] row_mask:0xf bank_mask:0xf
  v_fmac_f32_dpp v71, v70, v235 quad_perm:[1,0,3,2] row_mask:0xf bank_mask:0xf
  v_cvt_pk_bf16_f32 v47, v54, v55
  v_cvt_pk_bf16_f32 v63, v70, v71
  s_waitcnt lgkmcnt(4)
  v_fmac_f32 v72, v236, v218
  ds_write_b128 v229, v[44:47] offset:0
  s_waitcnt lgkmcnt(4)
  v_fmac_f32 v88, v238, v219
  v_fmac_f32_dpp v72, v218, v237 quad_perm:[1,0,3,2] row_mask:0xf bank_mask:0xf
  v_fmac_f32_dpp v88, v219, v239 quad_perm:[1,0,3,2] row_mask:0xf bank_mask:0xf
  v_fmac_f32 v73, v236, v72
  v_fmac_f32 v89, v238, v88
  v_fmac_f32_dpp v73, v72, v237 quad_perm:[1,0,3,2] row_mask:0xf bank_mask:0xf
  ds_read_b64_tr_b16 v[48:49], v3 offset:0
  v_fmac_f32_dpp v89, v88, v239 quad_perm:[1,0,3,2] row_mask:0xf bank_mask:0xf
  v_fmac_f32 v74, v236, v73
  v_fmac_f32 v90, v238, v89
  v_fmac_f32_dpp v74, v73, v237 quad_perm:[1,0,3,2] row_mask:0xf bank_mask:0xf
  v_fmac_f32_dpp v90, v89, v239 quad_perm:[1,0,3,2] row_mask:0xf bank_mask:0xf
  ds_read_b64_tr_b16 v[50:51], v3 offset:256
  v_cvt_pk_bf16_f32 v72, v72, v73
  v_cvt_pk_bf16_f32 v88, v88, v89
  v_fmac_f32 v75, v236, v74
  v_fmac_f32 v91, v238, v90
  v_fmac_f32_dpp v75, v74, v237 quad_perm:[1,0,3,2] row_mask:0xf bank_mask:0xf
  ds_read_b64_tr_b16 v[52:53], v230 offset:0
  v_fmac_f32_dpp v91, v90, v239 quad_perm:[1,0,3,2] row_mask:0xf bank_mask:0xf
  v_fmac_f32 v76, v236, v75
  v_fmac_f32 v92, v238, v91
  v_fmac_f32_dpp v76, v75, v237 quad_perm:[1,0,3,2] row_mask:0xf bank_mask:0xf
  v_fmac_f32_dpp v92, v91, v239 quad_perm:[1,0,3,2] row_mask:0xf bank_mask:0xf
  ds_read_b64_tr_b16 v[54:55], v230 offset:256
  v_cvt_pk_bf16_f32 v73, v74, v75
  v_cvt_pk_bf16_f32 v89, v90, v91
  v_fmac_f32 v77, v236, v76
  v_fmac_f32 v93, v238, v92
  v_fmac_f32_dpp v77, v76, v237 quad_perm:[1,0,3,2] row_mask:0xf bank_mask:0xf
  ds_write_b128 v229, v[60:63] offset:2048
  v_fmac_f32_dpp v93, v92, v239 quad_perm:[1,0,3,2] row_mask:0xf bank_mask:0xf
  v_fmac_f32 v78, v236, v77
  v_fmac_f32 v94, v238, v93
  v_fmac_f32_dpp v78, v77, v237 quad_perm:[1,0,3,2] row_mask:0xf bank_mask:0xf
  v_fmac_f32_dpp v94, v93, v239 quad_perm:[1,0,3,2] row_mask:0xf bank_mask:0xf
  ds_read_b64_tr_b16 v[64:65], v3 offset:2048
  v_cvt_pk_bf16_f32 v74, v76, v77
  v_cvt_pk_bf16_f32 v90, v92, v93
  v_fmac_f32 v79, v236, v78
  v_fmac_f32 v95, v238, v94
  v_fmac_f32_dpp v79, v78, v237 quad_perm:[1,0,3,2] row_mask:0xf bank_mask:0xf
  ds_read_b64_tr_b16 v[66:67], v3 offset:2304
  v_fmac_f32_dpp v95, v94, v239 quad_perm:[1,0,3,2] row_mask:0xf bank_mask:0xf
  v_fmac_f32 v80, v236, v79
  v_fmac_f32 v96, v238, v95
  v_fmac_f32_dpp v80, v79, v237 quad_perm:[1,0,3,2] row_mask:0xf bank_mask:0xf
  v_fmac_f32_dpp v96, v95, v239 quad_perm:[1,0,3,2] row_mask:0xf bank_mask:0xf
  ds_read_b64_tr_b16 v[68:69], v230 offset:2048
  v_cvt_pk_bf16_f32 v75, v78, v79
  v_cvt_pk_bf16_f32 v91, v94, v95
  v_fmac_f32 v81, v236, v80
  v_fmac_f32 v97, v238, v96
  v_fmac_f32_dpp v81, v80, v237 quad_perm:[1,0,3,2] row_mask:0xf bank_mask:0xf
  v_fmac_f32_dpp v97, v96, v239 quad_perm:[1,0,3,2] row_mask:0xf bank_mask:0xf
  ds_read_b64_tr_b16 v[70:71], v230 offset:2304
  v_fmac_f32 v82, v236, v81
  v_fmac_f32 v98, v238, v97
  v_fmac_f32_dpp v82, v81, v237 quad_perm:[1,0,3,2] row_mask:0xf bank_mask:0xf
  v_fmac_f32_dpp v98, v97, v239 quad_perm:[1,0,3,2] row_mask:0xf bank_mask:0xf
  v_cvt_pk_bf16_f32 v76, v80, v81
  s_add_u32 s46, s85, 0
  v_cvt_pk_bf16_f32 v92, v96, v97
  ds_write_b128 v2, v[72:75] offset:4096
  ds_write_b128 v2, v[88:91] offset:6144
  v_fmac_f32 v83, v236, v82
  v_fmac_f32 v99, v238, v98
  s_waitcnt lgkmcnt(9)
  buffer_store_dwordx4 v[48:51], v38, s[20:23], s46 offen offset:0 sc1
  v_fmac_f32_dpp v83, v82, v237 quad_perm:[1,0,3,2] row_mask:0xf bank_mask:0xf
  v_fmac_f32_dpp v99, v98, v239 quad_perm:[1,0,3,2] row_mask:0xf bank_mask:0xf
  v_fmac_f32 v84, v236, v83
  v_fmac_f32 v100, v238, v99
  v_fmac_f32_dpp v84, v83, v237 quad_perm:[1,0,3,2] row_mask:0xf bank_mask:0xf
  s_waitcnt lgkmcnt(7)
  buffer_store_dwordx4 v[52:55], v38, s[20:23], s46 offen offset:1024 sc1
  v_fmac_f32_dpp v100, v99, v239 quad_perm:[1,0,3,2] row_mask:0xf bank_mask:0xf
  v_cvt_pk_bf16_f32 v77, v82, v83
  v_cvt_pk_bf16_f32 v93, v98, v99
  v_fmac_f32 v85, v236, v84
  v_fmac_f32 v101, v238, v100
  s_add_u32 s46, s85, 4096
  v_fmac_f32_dpp v85, v84, v237 quad_perm:[1,0,3,2] row_mask:0xf bank_mask:0xf
  v_fmac_f32_dpp v101, v100, v239 quad_perm:[1,0,3,2] row_mask:0xf bank_mask:0xf
  v_fmac_f32 v86, v236, v85
  v_fmac_f32 v102, v238, v101
  v_fmac_f32_dpp v86, v85, v237 quad_perm:[1,0,3,2] row_mask:0xf bank_mask:0xf
  s_waitcnt lgkmcnt(4)
  buffer_store_dwordx4 v[64:67], v38, s[20:23], s46 offen offset:0 sc1
  v_fmac_f32_dpp v102, v101, v239 quad_perm:[1,0,3,2] row_mask:0xf bank_mask:0xf
  v_cvt_pk_bf16_f32 v78, v84, v85
  v_cvt_pk_bf16_f32 v94, v100, v101
  v_fmac_f32 v87, v236, v86
  v_fmac_f32 v103, v238, v102
  s_waitcnt lgkmcnt(2)
  buffer_store_dwordx4 v[68:71], v38, s[20:23], s46 offen offset:1024 sc1
  v_fmac_f32_dpp v87, v86, v237 quad_perm:[1,0,3,2] row_mask:0xf bank_mask:0xf
  v_fmac_f32_dpp v103, v102, v239 quad_perm:[1,0,3,2] row_mask:0xf bank_mask:0xf
  v_cvt_pk_bf16_f32 v79, v86, v87
  v_cvt_pk_bf16_f32 v95, v102, v103
  v_fmac_f32 v104, v240, v228
  ds_write_b128 v229, v[76:79] offset:4096
  v_fmac_f32_dpp v104, v228, v241 quad_perm:[1,0,3,2] row_mask:0xf bank_mask:0xf
  v_fmac_f32 v105, v240, v104
  s_nop 0
  v_fmac_f32_dpp v105, v104, v241 quad_perm:[1,0,3,2] row_mask:0xf bank_mask:0xf
  ds_read_b64_tr_b16 v[80:81], v3 offset:4096
  v_fmac_f32 v106, v240, v105
  v_fmac_f32_dpp v106, v105, v241 quad_perm:[1,0,3,2] row_mask:0xf bank_mask:0xf
  v_cvt_pk_bf16_f32 v104, v104, v105
  ds_read_b64_tr_b16 v[82:83], v3 offset:4352
  v_fmac_f32 v107, v240, v106
  v_fmac_f32_dpp v107, v106, v241 quad_perm:[1,0,3,2] row_mask:0xf bank_mask:0xf
  v_fmac_f32 v108, v240, v107
  ds_read_b64_tr_b16 v[84:85], v230 offset:4096
  v_fmac_f32_dpp v108, v107, v241 quad_perm:[1,0,3,2] row_mask:0xf bank_mask:0xf
  v_cvt_pk_bf16_f32 v105, v106, v107
  v_fmac_f32 v109, v240, v108
  ds_read_b64_tr_b16 v[86:87], v230 offset:4352
  v_fmac_f32_dpp v109, v108, v241 quad_perm:[1,0,3,2] row_mask:0xf bank_mask:0xf
  v_fmac_f32 v110, v240, v109
  s_nop 0
  v_fmac_f32_dpp v110, v109, v241 quad_perm:[1,0,3,2] row_mask:0xf bank_mask:0xf
  ds_write_b128 v229, v[92:95] offset:6144
  v_cvt_pk_bf16_f32 v106, v108, v109
  v_fmac_f32 v111, v240, v110
  v_fmac_f32_dpp v111, v110, v241 quad_perm:[1,0,3,2] row_mask:0xf bank_mask:0xf
  ds_read_b64_tr_b16 v[96:97], v3 offset:6144
  v_fmac_f32 v112, v240, v111
  v_fmac_f32_dpp v112, v111, v241 quad_perm:[1,0,3,2] row_mask:0xf bank_mask:0xf
  v_cvt_pk_bf16_f32 v107, v110, v111
  ds_read_b64_tr_b16 v[98:99], v3 offset:6400
  v_fmac_f32 v113, v240, v112
  v_fmac_f32_dpp v113, v112, v241 quad_perm:[1,0,3,2] row_mask:0xf bank_mask:0xf
  ds_read_b64_tr_b16 v[100:101], v230 offset:6144
  v_fmac_f32 v114, v240, v113
  v_fmac_f32_dpp v114, v113, v241 quad_perm:[1,0,3,2] row_mask:0xf bank_mask:0xf
  v_cvt_pk_bf16_f32 v108, v112, v113
  ds_read_b64_tr_b16 v[102:103], v230 offset:6400
  ds_write_b128 v2, v[104:107] offset:8192
  v_fmac_f32 v115, v240, v114
  v_fmac_f32_dpp v115, v114, v241 quad_perm:[1,0,3,2] row_mask:0xf bank_mask:0xf
  s_add_u32 s46, s85, 8192
  v_fmac_f32 v116, v240, v115
  v_fmac_f32_dpp v116, v115, v241 quad_perm:[1,0,3,2] row_mask:0xf bank_mask:0xf
  v_cvt_pk_bf16_f32 v109, v114, v115
  s_waitcnt lgkmcnt(8)
  buffer_store_dwordx4 v[80:83], v38, s[20:23], s46 offen offset:0 sc1
  v_fmac_f32 v117, v240, v116
  v_fmac_f32_dpp v117, v116, v241 quad_perm:[1,0,3,2] row_mask:0xf bank_mask:0xf
  v_fmac_f32 v118, v240, v117
  s_waitcnt lgkmcnt(6)
  buffer_store_dwordx4 v[84:87], v38, s[20:23], s46 offen offset:1024 sc1
  v_fmac_f32_dpp v118, v117, v241 quad_perm:[1,0,3,2] row_mask:0xf bank_mask:0xf
  v_cvt_pk_bf16_f32 v110, v116, v117
  v_fmac_f32 v119, v240, v118
  s_add_u32 s46, s85, 12288
  v_fmac_f32_dpp v119, v118, v241 quad_perm:[1,0,3,2] row_mask:0xf bank_mask:0xf
  v_cvt_pk_bf16_f32 v111, v118, v119
  ds_write_b128 v229, v[108:111] offset:8192
  s_waitcnt lgkmcnt(4)
  buffer_store_dwordx4 v[96:99], v38, s[20:23], s46 offen offset:0 sc1
  ds_read_b64_tr_b16 v[112:113], v3 offset:8192
  ds_read_b64_tr_b16 v[114:115], v3 offset:8448
  ds_read_b64_tr_b16 v[116:117], v230 offset:8192
  s_waitcnt lgkmcnt(5)
  buffer_store_dwordx4 v[100:103], v38, s[20:23], s46 offen offset:1024 sc1
  ds_read_b64_tr_b16 v[118:119], v230 offset:8448
  buffer_load_dword v249, v248, s[20:23], s87 offen sc1
  s_add_u32 s46, s85, 16384
  s_waitcnt lgkmcnt(2)
  buffer_store_dwordx4 v[112:115], v38, s[20:23], s46 offen offset:0 sc1
  s_waitcnt lgkmcnt(0)
  buffer_store_dwordx4 v[116:119], v38, s[20:23], s46 offen offset:1024 sc1
  s_add_u32 s65, s68, 0
  buffer_load_dwordx4 v[200:203], v38, s[20:23], s65 offen offset:0 sc1
  buffer_load_dwordx4 v[204:207], v38, s[20:23], s65 offen offset:1024 sc1
  buffer_load_dwordx4 v[208:211], v38, s[20:23], s65 offen offset:2048 sc1
  buffer_load_dwordx4 v[212:215], v38, s[20:23], s65 offen offset:3072 sc1
  s_waitcnt vmcnt(23)
  v_mfma_f32_16x16x32_bf16 v[120:123], a[0:3], a[220:223], 0
  s_add_u32 s65, s68, 4096
  buffer_load_dwordx4 v[18:21], v38, s[20:23], s65 offen offset:0 sc1
  s_mov_b32 s8, s80
  s_mov_b32 s9, s81
  s_mov_b32 s10, 1280
  v_mfma_f32_16x16x32_bf16 v[124:127], a[4:7], a[220:223], 0
  s_add_u32 s64, s66, 27648
  s_mov_b32 s11, 0x20000
  s_mov_b32 s12, s90
  s_mov_b32 s13, s91
  v_mfma_f32_16x16x32_bf16 v[128:131], a[8:11], a[220:223], 0
  s_mov_b32 s14, 5242880
  s_mov_b32 s15, 0x20000
  s_and_b32 s100, s79, 7
  v_mfma_f32_16x16x32_bf16 v[132:135], a[12:15], a[220:223], 0
  s_lshr_b32 s101, s79, 3
  s_lshl_b32 s45, s78, 1
  s_add_u32 s101, s101, s45
  v_mfma_f32_16x16x32_bf16 v[136:139], a[16:19], a[220:223], 0
  buffer_load_dwordx4 v[22:25], v38, s[20:23], s65 offen offset:1024 sc1
  s_mul_i32 s61, s48, 1280
  s_add_u32 s61, s61, s49
  s_waitcnt vmcnt(24)
  v_mfma_f32_16x16x32_bf16 v[140:143], a[0:3], a[224:227], 0
  buffer_load_dwordx4 a[108:111], v38, s[20:23], s64 offen sc1
  s_lshl_b32 s61, s61, 1
  s_and_b32 s59, s49, 127
  s_add_u32 s59, s59, s50
  v_mfma_f32_16x16x32_bf16 v[144:147], a[4:7], a[224:227], 0
  s_add_u32 s64, s66, 28672
  s_mov_b32 s60, s50
  v_lshlrev_b32 v5, 2, v1
  s_add_u32 m0, s60, 4096
  s_nop 0
  buffer_load_dword v5, s[8:11], s49 offen lds
  v_mfma_f32_16x16x32_bf16 v[148:151], a[8:11], a[224:227], 0
  s_lshl_b32 s49, s48, 4
  s_add_u32 s49, s49, 15138816
  v_mfma_f32_16x16x32_bf16 v[152:155], a[12:15], a[224:227], 0
  buffer_load_dwordx4 v[26:29], v38, s[20:23], s65 offen offset:2048 sc1
  v_and_b32 v3, 15, v1
  v_lshlrev_b32 v3, 4, v3
  v_mfma_f32_16x16x32_bf16 v[156:159], a[16:19], a[224:227], 0
  buffer_load_dwordx4 a[176:179], v38, s[20:23], s64 offen sc1
  s_waitcnt vmcnt(27)
  v_mfma_f32_16x16x32_bf16 v[160:163], a[0:3], a[228:231], 0
  buffer_load_dwordx4 v[252:255], v3, s[20:23], s49 offen sc1
  s_lshl_b32 s44, s101, 3
  s_add_u32 s44, s44, s100
  s_mul_i32 s62, s44, 28672
  s_add_u32 s62, s62, 15958016
  v_mfma_f32_16x16x32_bf16 v[164:167], a[4:7], a[228:231], 0
  s_xor_b32 s44, s44, 8
  s_mul_i32 s63, s44, 28672
  s_add_u32 s63, s63, 15958016
  v_mfma_f32_16x16x32_bf16 v[168:171], a[8:11], a[228:231], 0
  buffer_load_dwordx4 v[30:33], v38, s[20:23], s65 offen offset:3072 sc1
  s_add_u32 s64, s66, 29696
  v_lshlrev_b32 v17, 4, v0
  v_and_b32 v4, 15, v1
  v_mul_u32_u24 v4, 336, v4
  v_mfma_f32_16x16x32_bf16 v[172:175], a[12:15], a[228:231], 0
  v_lshrrev_b32 v5, 4, v1
  v_lshl_add_u32 v4, v5, 4, v4
  s_mul_i32 s44, s42, 21504
  v_mfma_f32_16x16x32_bf16 v[176:179], a[16:19], a[228:231], 0
  v_add_u32 v36, s44, v4
  s_mul_i32 s44, s42, 5376
  v_add_u32 v4, 0, v1
  s_waitcnt vmcnt(28)
  v_mfma_f32_16x16x32_bf16 v[180:183], a[0:3], a[232:235], 0
  buffer_load_dwordx4 a[212:215], v38, s[20:23], s64 offen sc1
  v_mul_u32_u24 v5, 3277, v4
  v_lshrrev_b32 v5, 16, v5
  v_lshlrev_b32 v4, 4, v4
  v_mfma_f32_16x16x32_bf16 v[184:187], a[4:7], a[232:235], 0
  v_lshl_add_u32 v2, v5, 4, v4
  v_add_u32 v6, s44, v2
  v_mul_u32_u24 v2, 320, v5
  v_mfma_f32_16x16x32_bf16 v[188:191], a[8:11], a[232:235], 0
  v_sub_u32 v4, v4, v2
  v_lshl_add_u32 v11, v2, 3, v4
  v_lshrrev_b32 v4, 1, v4
  v_mfma_f32_16x16x32_bf16 v[192:195], a[12:15], a[232:235], 0
  s_add_u32 s64, s66, 30720
  v_lshl_add_u32 v2, v5, 8, v4
  v_add_u32 v216, s59, v2
  v_add_u32 v226, s60, v4
  v_mfma_f32_16x16x32_bf16 v[196:199], a[16:19], a[232:235], 0
  v_lshlrev_b32 v5, 3, v5
  v_add_u32 v236, s60, v5
  v_add_u32 v4, 64, v1
  s_waitcnt vmcnt(28)
  v_mfma_f32_16x16x32_bf16 v[120:123], a[20:23], a[196:199], v[120:123]
  buffer_load_dwordx4 a[216:219], v38, s[20:23], s64 offen sc1
  v_mul_u32_u24 v5, 3277, v4
  v_lshrrev_b32 v5, 16, v5
  v_lshlrev_b32 v4, 4, v4
  v_mfma_f32_16x16x32_bf16 v[124:127], a[24:27], a[196:199], v[124:127]
  v_lshl_add_u32 v2, v5, 4, v4
  v_add_u32 v7, s44, v2
  v_mul_u32_u24 v2, 320, v5
  v_mfma_f32_16x16x32_bf16 v[128:131], a[28:31], a[196:199], v[128:131]
  v_sub_u32 v4, v4, v2
  v_lshl_add_u32 v12, v2, 3, v4
  v_lshrrev_b32 v4, 1, v4
  v_mfma_f32_16x16x32_bf16 v[132:135], a[32:35], a[196:199], v[132:135]
  s_add_u32 s64, s66, 31744
  v_lshl_add_u32 v2, v5, 8, v4
  v_add_u32 v218, s59, v2
  v_mfma_f32_16x16x32_bf16 v[136:139], a[36:39], a[196:199], v[136:139]
  v_add_u32 v228, s60, v4
  v_lshlrev_b32 v5, 3, v5
  v_add_u32 v238, s60, v5
  s_waitcnt vmcnt(28)
  v_mfma_f32_16x16x32_bf16 v[140:143], a[20:23], a[200:203], v[140:143]
  v_add_u32 v4, 128, v1
  v_mul_u32_u24 v5, 3277, v4
  v_lshrrev_b32 v5, 16, v5
  v_mfma_f32_16x16x32_bf16 v[144:147], a[24:27], a[200:203], v[144:147]
  buffer_load_dwordx4 a[240:243], v38, s[20:23], s64 offen sc1
  v_lshlrev_b32 v4, 4, v4
  v_lshl_add_u32 v2, v5, 4, v4
  v_add_u32 v8, s44, v2
  v_mfma_f32_16x16x32_bf16 v[148:151], a[28:31], a[200:203], v[148:151]
  v_mul_u32_u24 v2, 320, v5
  v_sub_u32 v4, v4, v2
  v_lshl_add_u32 v13, v2, 3, v4
  v_mfma_f32_16x16x32_bf16 v[152:155], a[32:35], a[200:203], v[152:155]
  v_lshrrev_b32 v4, 1, v4
  v_lshl_add_u32 v2, v5, 8, v4
  v_add_u32 v220, s59, v2
  v_mfma_f32_16x16x32_bf16 v[156:159], a[36:39], a[200:203], v[156:159]
  s_add_u32 s64, s66, 32768
  v_add_u32 v230, s60, v4
  v_lshlrev_b32 v5, 3, v5
  v_add_u32 v240, s60, v5
  s_waitcnt vmcnt(28)
  v_mfma_f32_16x16x32_bf16 v[160:163], a[20:23], a[204:207], v[160:163]
  v_add_u32 v4, 192, v1
  v_mul_u32_u24 v5, 3277, v4
  v_lshrrev_b32 v5, 16, v5
  v_mfma_f32_16x16x32_bf16 v[164:167], a[24:27], a[204:207], v[164:167]
  buffer_load_dwordx4 a[244:247], v38, s[20:23], s64 offen sc1
  v_lshlrev_b32 v4, 4, v4
  v_lshl_add_u32 v2, v5, 4, v4
  v_add_u32 v9, s44, v2
  v_mfma_f32_16x16x32_bf16 v[168:171], a[28:31], a[204:207], v[168:171]
  v_mul_u32_u24 v2, 320, v5
  v_sub_u32 v4, v4, v2
  v_lshl_add_u32 v14, v2, 3, v4
  v_mfma_f32_16x16x32_bf16 v[172:175], a[32:35], a[204:207], v[172:175]
  v_lshrrev_b32 v4, 1, v4
  v_lshl_add_u32 v2, v5, 8, v4
  v_add_u32 v222, s59, v2
  v_mfma_f32_16x16x32_bf16 v[176:179], a[36:39], a[204:207], v[176:179]
  s_add_u32 s64, s66, 33792
  v_add_u32 v232, s60, v4
  v_lshlrev_b32 v5, 3, v5
  v_add_u32 v242, s60, v5
  s_waitcnt vmcnt(28)
  v_mfma_f32_16x16x32_bf16 v[180:183], a[20:23], a[208:211], v[180:183]
  v_add_u32 v4, 256, v1
  v_mul_u32_u24 v5, 3277, v4
  v_lshrrev_b32 v5, 16, v5
  v_mfma_f32_16x16x32_bf16 v[184:187], a[24:27], a[208:211], v[184:187]
  v_lshlrev_b32 v4, 4, v4
  v_lshl_add_u32 v2, v5, 4, v4
  v_add_u32 v10, s44, v2
  v_mfma_f32_16x16x32_bf16 v[188:191], a[28:31], a[208:211], v[188:191]
  buffer_load_dwordx4 a[248:251], v38, s[20:23], s64 offen sc1
  v_mul_u32_u24 v2, 320, v5
  v_sub_u32 v4, v4, v2
  v_lshl_add_u32 v15, v2, 3, v4
  v_mfma_f32_16x16x32_bf16 v[192:195], a[32:35], a[208:211], v[192:195]
  v_lshrrev_b32 v4, 1, v4
  v_lshl_add_u32 v2, v5, 8, v4
  v_add_u32 v224, s59, v2
  v_mfma_f32_16x16x32_bf16 v[196:199], a[36:39], a[208:211], v[196:199]
  v_add_u32 v234, s60, v4
  v_lshlrev_b32 v5, 3, v5
  v_add_u32 v244, s60, v5
  s_waitcnt vmcnt(19)
  v_xor_b32 v39, s92, v249
  v_cmp_ne_u32 vcc, 0, v39
  s_nop 3
  s_cbranch_vccnz Y_poll5_slow
Y_poll5_ret:
  s_waitcnt vmcnt(16)
  v_mfma_f32_16x16x32_bf16 v[40:43], a[0:3], v[200:203], 0
  s_add_u32 s65, s67, 8192
  buffer_load_dwordx4 a[220:223], v38, s[20:23], s65 offen offset:0 sc1
  s_add_u32 s64, s66, 34816
  v_mfma_f32_16x16x32_bf16 v[44:47], a[4:7], v[200:203], 0
  v_mfma_f32_16x16x32_bf16 v[48:51], a[8:11], v[200:203], 0
  buffer_load_dwordx4 a[224:227], v38, s[20:23], s65 offen offset:1024 sc1
  v_mfma_f32_16x16x32_bf16 v[52:55], a[12:15], v[200:203], 0
  buffer_load_dwordx4 a[252:255], v38, s[20:23], s64 offen sc1
  v_mfma_f32_16x16x32_bf16 v[56:59], a[16:19], v[200:203], 0
  buffer_load_dwordx4 a[228:231], v38, s[20:23], s65 offen offset:2048 sc1
  s_waitcnt vmcnt(19)
  v_mfma_f32_16x16x32_bf16 v[60:63], a[0:3], v[204:207], 0
  s_add_u32 s64, s66, 46080
  v_mfma_f32_16x16x32_bf16 v[64:67], a[4:7], v[204:207], 0
  buffer_load_dwordx4 a[232:235], v38, s[20:23], s65 offen offset:3072 sc1
  v_mfma_f32_16x16x32_bf16 v[68:71], a[8:11], v[204:207], 0
  v_mfma_f32_16x16x32_bf16 v[72:75], a[12:15], v[204:207], 0
  s_add_u32 s65, s68, 8192
  buffer_load_dwordx4 a[196:199], v38, s[20:23], s65 offen offset:0 sc1
  v_mfma_f32_16x16x32_bf16 v[76:79], a[16:19], v[204:207], 0
  buffer_load_dwordx4 a[152:155], v38, s[20:23], s64 offen sc1
  s_waitcnt vmcnt(21)
  v_mfma_f32_16x16x32_bf16 v[80:83], a[0:3], v[208:211], 0
  v_mfma_f32_16x16x32_bf16 v[84:87], a[4:7], v[208:211], 0
  s_add_u32 s64, s66, 47104
  v_mfma_f32_16x16x32_bf16 v[88:91], a[8:11], v[208:211], 0
  buffer_load_dwordx4 a[200:203], v38, s[20:23], s65 offen offset:1024 sc1
  v_mfma_f32_16x16x32_bf16 v[92:95], a[12:15], v[208:211], 0
  v_mfma_f32_16x16x32_bf16 v[96:99], a[16:19], v[208:211], 0
  buffer_load_dwordx4 a[156:159], v38, s[20:23], s64 offen sc1
  s_waitcnt vmcnt(22)
  v_mfma_f32_16x16x32_bf16 v[100:103], a[0:3], v[212:215], 0
  v_mfma_f32_16x16x32_bf16 v[104:107], a[4:7], v[212:215], 0
  buffer_load_dwordx4 a[204:207], v38, s[20:23], s65 offen offset:2048 sc1
  s_add_u32 s64, s66, 48128
  v_mfma_f32_16x16x32_bf16 v[108:111], a[8:11], v[212:215], 0
  v_mfma_f32_16x16x32_bf16 v[112:115], a[12:15], v[212:215], 0
  v_mfma_f32_16x16x32_bf16 v[116:119], a[16:19], v[212:215], 0
  buffer_load_dwordx4 a[160:163], v38, s[20:23], s64 offen sc1
  s_waitcnt vmcnt(23)
  v_mfma_f32_16x16x32_bf16 v[40:43], a[20:23], v[18:21], v[40:43]
  buffer_load_dwordx4 a[208:211], v38, s[20:23], s65 offen offset:3072 sc1
  s_waitcnt vmcnt(18)
  v_xor_b32 v39, s92, v255
  v_bitop3_b32 v39, v39, v254, s92 bitop3:0xf6
  v_cmp_ne_u32 vcc, 0, v39
  s_nop 3
  s_cbranch_vccnz Y_poll8_slow
Y_poll8_ret:
  v_lshrrev_b32 v3, 1, v3
  v_mfma_f32_16x16x32_bf16 v[44:47], a[24:27], v[18:21], v[44:47]
  v_add_u32 v3, s60, v3
  ds_write_b64 v3, v[252:253] offset:4352
  ds_read_b64 v[216:217], v216
  ds_read_b64 v[226:227], v226 offset:4096
  v_mfma_f32_16x16x32_bf16 v[48:51], a[28:31], v[18:21], v[48:51]
  s_add_u32 s64, s66, 49152
  ds_read_b64 v[236:237], v236 offset:4352
  ds_read_b64 v[218:219], v218
  ds_read_b64 v[228:229], v228 offset:4096
  ds_read_b64 v[238:239], v238 offset:4352
  ds_read_b64 v[220:221], v220
  v_mfma_f32_16x16x32_bf16 v[52:55], a[32:35], v[18:21], v[52:55]
  ds_read_b64 v[230:231], v230 offset:4096
  ds_read_b64 v[240:241], v240 offset:4352
  ds_read_b64 v[222:223], v222
  ds_read_b64 v[232:233], v232 offset:4096
  ds_read_b64 v[242:243], v242 offset:4352
  v_mfma_f32_16x16x32_bf16 v[56:59], a[36:39], v[18:21], v[56:59]
  s_add_u32 s65, s68, 12288
  buffer_load_dwordx4 v[200:203], v38, s[20:23], s65 offen offset:0 sc1
  s_barrier
  buffer_store_dword v35, v37, s[20:23], s53 offen sc1
  ds_read_b64 v[224:225], v224
  ds_read_b64 v[234:235], v234 offset:4096
  s_waitcnt lgkmcnt(10)
  ds_read_b64 v[244:245], v244 offset:4352
  v_lshlrev_b32 v2, 16, v216
  v_and_b32 v3, s52, v216
  v_mfma_f32_16x16x32_bf16 v[60:63], a[20:23], v[22:25], v[60:63]
  buffer_load_dwordx4 a[164:167], v38, s[20:23], s64 offen sc1
  v_lshlrev_b32 v4, 16, v217
  v_and_b32 v5, s52, v217
  v_lshlrev_b32 v246, 16, v226
  v_and_b32 v247, s52, v226
  v_mfma_f32_16x16x32_bf16 v[64:67], a[24:27], v[22:25], v[64:67]
  v_lshlrev_b32 v252, 16, v227
  v_and_b32 v253, s52, v227
  v_and_b32 v237, s52, v237
  v_mul_f32 v237, v237, v236
  v_fma_f32 v254, v2, v236, v237
  v_mfma_f32_16x16x32_bf16 v[68:71], a[28:31], v[22:25], v[68:71]
  s_add_u32 s64, s66, 50176
  v_fma_f32 v255, v3, v236, v237
  v_fma_f32 v16, v4, v236, v237
  v_fma_f32 v34, v5, v236, v237
  v_cvt_pk_bf16_f32 v254, v254, v255
  v_cvt_pk_bf16_f32 v16, v16, v34
  v_mfma_f32_16x16x32_bf16 v[72:75], a[32:35], v[22:25], v[72:75]
  buffer_load_dwordx4 v[204:207], v38, s[20:23], s65 offen offset:1024 sc1
  v_and_b32 v255, s52, v254
  v_lshlrev_b32 v254, 16, v254
  v_and_b32 v34, s52, v16
  v_lshlrev_b32 v16, 16, v16
  v_mul_f32 v254, v254, v246
  v_mfma_f32_16x16x32_bf16 v[76:79], a[36:39], v[22:25], v[76:79]
  v_mul_f32 v255, v255, v247
  v_mul_f32 v16, v16, v252
  v_mul_f32 v34, v34, v253
  v_cvt_pk_bf16_f32 v254, v254, v255
  v_cvt_pk_bf16_f32 v16, v16, v34
  v_mfma_f32_16x16x32_bf16 v[80:83], a[20:23], v[26:29], v[80:83]
  buffer_load_dwordx4 a[168:171], v38, s[20:23], s64 offen sc1
  v_and_b32 v255, s52, v254
  v_lshlrev_b32 v254, 16, v254
  v_and_b32 v34, s52, v16
  v_lshlrev_b32 v16, 16, v16
  v_mfma_f32_16x16x32_bf16 v[84:87], a[24:27], v[26:29], v[84:87]
  v_add_f32 v216, v2, v254
  v_add_f32 v217, v3, v255
  v_add_f32 v226, v4, v16
  v_add_f32 v227, v5, v34
  v_lshlrev_b32 v2, 16, v218
  v_mfma_f32_16x16x32_bf16 v[88:91], a[28:31], v[26:29], v[88:91]
  buffer_load_dwordx4 v[208:211], v38, s[20:23], s65 offen offset:2048 sc1
  v_and_b32 v3, s52, v218
  v_lshlrev_b32 v4, 16, v219
  v_and_b32 v5, s52, v219
  s_waitcnt lgkmcnt(10)
  v_lshlrev_b32 v246, 16, v228
  v_and_b32 v247, s52, v228
  v_mfma_f32_16x16x32_bf16 v[92:95], a[32:35], v[26:29], v[92:95]
  s_add_u32 s64, s66, 51200
  v_lshlrev_b32 v252, 16, v229
  v_and_b32 v253, s52, v229
  s_waitcnt lgkmcnt(9)
  v_and_b32 v239, s52, v239
  v_mul_f32 v239, v239, v238
  v_fma_f32 v254, v2, v238, v239
  v_mfma_f32_16x16x32_bf16 v[96:99], a[36:39], v[26:29], v[96:99]
  v_fma_f32 v255, v3, v238, v239
  v_fma_f32 v16, v4, v238, v239
  v_fma_f32 v34, v5, v238, v239
  v_cvt_pk_bf16_f32 v254, v254, v255
  v_cvt_pk_bf16_f32 v16, v16, v34
  s_waitcnt vmcnt(23)
  v_mfma_f32_16x16x32_bf16 v[100:103], a[20:23], v[30:33], v[100:103]
  v_and_b32 v255, s52, v254
  v_lshlrev_b32 v254, 16, v254
  v_and_b32 v34, s52, v16
  v_lshlrev_b32 v16, 16, v16
  v_mfma_f32_16x16x32_bf16 v[104:107], a[24:27], v[30:33], v[104:107]
  buffer_load_dwordx4 v[212:215], v38, s[20:23], s65 offen offset:3072 sc1
  v_mul_f32 v254, v254, v246
  v_mul_f32 v255, v255, v247
  v_mul_f32 v16, v16, v252
  v_mul_f32 v34, v34, v253
  v_cvt_pk_bf16_f32 v254, v254, v255
  v_mfma_f32_16x16x32_bf16 v[108:111], a[28:31], v[30:33], v[108:111]
  buffer_load_dwordx4 a[172:175], v38, s[20:23], s64 offen sc1
  v_cvt_pk_bf16_f32 v16, v16, v34
  v_and_b32 v255, s52, v254
  v_lshlrev_b32 v254, 16, v254
  v_and_b32 v34, s52, v16
  v_lshlrev_b32 v16, 16, v16
  v_mfma_f32_16x16x32_bf16 v[112:115], a[32:35], v[30:33], v[112:115]
  v_add_f32 v218, v2, v254
  v_add_f32 v219, v3, v255
  v_add_f32 v228, v4, v16
  v_add_f32 v229, v5, v34
  s_waitcnt lgkmcnt(8)
  v_lshlrev_b32 v2, 16, v220
  v_mfma_f32_16x16x32_bf16 v[116:119], a[36:39], v[30:33], v[116:119]
  s_add_u32 s64, s66, 52224
  v_and_b32 v3, s52, v220
  v_lshlrev_b32 v4, 16, v221
  v_and_b32 v5, s52, v221
  s_waitcnt lgkmcnt(7)
  v_lshlrev_b32 v246, 16, v230
  v_and_b32 v247, s52, v230
  s_waitcnt vmcnt(19)
  v_mfma_f32_16x16x32_bf16 v[120:123], a[40:43], a[220:223], v[120:123]
  v_lshlrev_b32 v252, 16, v231
  v_and_b32 v253, s52, v231
  s_waitcnt lgkmcnt(6)
  v_and_b32 v241, s52, v241
  v_mul_f32 v241, v241, v240
  v_fma_f32 v254, v2, v240, v241
  v_mfma_f32_16x16x32_bf16 v[124:127], a[44:47], a[220:223], v[124:127]
  buffer_load_dwordx4 a[180:183], v38, s[20:23], s64 offen sc1
  v_fma_f32 v255, v3, v240, v241
  v_fma_f32 v16, v4, v240, v241
  v_fma_f32 v34, v5, v240, v241
  v_cvt_pk_bf16_f32 v254, v254, v255
  v_mfma_f32_16x16x32_bf16 v[128:131], a[48:51], a[220:223], v[128:131]
  v_cvt_pk_bf16_f32 v16, v16, v34
  v_and_b32 v255, s52, v254
  v_lshlrev_b32 v254, 16, v254
  v_and_b32 v34, s52, v16
  v_lshlrev_b32 v16, 16, v16
  v_mfma_f32_16x16x32_bf16 v[132:135], a[52:55], a[220:223], v[132:135]
  v_mul_f32 v254, v254, v246
  v_mul_f32 v255, v255, v247
  v_mul_f32 v16, v16, v252
  v_mul_f32 v34, v34, v253
  v_cvt_pk_bf16_f32 v254, v254, v255
  v_mfma_f32_16x16x32_bf16 v[136:139], a[56:59], a[220:223], v[136:139]
  s_add_u32 s64, s66, 53248
  v_cvt_pk_bf16_f32 v16, v16, v34
  v_and_b32 v255, s52, v254
  v_lshlrev_b32 v254, 16, v254
  v_and_b32 v34, s52, v16
  v_lshlrev_b32 v16, 16, v16
  s_waitcnt vmcnt(19)
  v_mfma_f32_16x16x32_bf16 v[140:143], a[40:43], a[224:227], v[140:143]
  v_add_f32 v220, v2, v254
  v_add_f32 v221, v3, v255
  v_add_f32 v230, v4, v16
  v_add_f32 v231, v5, v34
  s_waitcnt lgkmcnt(5)
  v_lshlrev_b32 v2, 16, v222
  v_mfma_f32_16x16x32_bf16 v[144:147], a[44:47], a[224:227], v[144:147]
  v_and_b32 v3, s52, v222
  v_lshlrev_b32 v4, 16, v223
  v_and_b32 v5, s52, v223
  s_waitcnt lgkmcnt(4)
  v_lshlrev_b32 v246, 16, v232
  v_mfma_f32_16x16x32_bf16 v[148:151], a[48:51], a[224:227], v[148:151]
  buffer_load_dwordx4 a[184:187], v38, s[20:23], s64 offen sc1
  v_and_b32 v247, s52, v232
  v_lshlrev_b32 v252, 16, v233
  v_and_b32 v253, s52, v233
  s_waitcnt lgkmcnt(3)
  v_and_b32 v243, s52, v243
  v_mul_f32 v243, v243, v242
  v_mfma_f32_16x16x32_bf16 v[152:155], a[52:55], a[224:227], v[152:155]
  v_fma_f32 v254, v2, v242, v243
  v_fma_f32 v255, v3, v242, v243
  v_fma_f32 v16, v4, v242, v243
  v_fma_f32 v34, v5, v242, v243
  v_cvt_pk_bf16_f32 v254, v254, v255
  v_mfma_f32_16x16x32_bf16 v[156:159], a[56:59], a[224:227], v[156:159]
  v_cvt_pk_bf16_f32 v16, v16, v34
  v_and_b32 v255, s52, v254
  v_lshlrev_b32 v254, 16, v254
  v_and_b32 v34, s52, v16
  v_lshlrev_b32 v16, 16, v16
  s_waitcnt vmcnt(18)
  v_mfma_f32_16x16x32_bf16 v[160:163], a[40:43], a[228:231], v[160:163]
  buffer_load_dword v250, v248, s[20:23], s87 offen offset:128 sc1
  s_add_u32 s64, s66, 54272
  v_mul_f32 v254, v254, v246
  v_mul_f32 v255, v255, v247
  v_mul_f32 v16, v16, v252
  v_mul_f32 v34, v34, v253
  v_cvt_pk_bf16_f32 v254, v254, v255
  v_mfma_f32_16x16x32_bf16 v[164:167], a[44:47], a[228:231], v[164:167]
  v_cvt_pk_bf16_f32 v16, v16, v34
  v_and_b32 v255, s52, v254
  v_lshlrev_b32 v254, 16, v254
  v_and_b32 v34, s52, v16
  v_mfma_f32_16x16x32_bf16 v[168:171], a[48:51], a[228:231], v[168:171]
  buffer_load_dwordx4 a[188:191], v38, s[20:23], s64 offen sc1
  v_lshlrev_b32 v16, 16, v16
  v_add_f32 v222, v2, v254
  v_add_f32 v223, v3, v255
  v_add_f32 v232, v4, v16
  v_add_f32 v233, v5, v34
  v_mfma_f32_16x16x32_bf16 v[172:175], a[52:55], a[228:231], v[172:175]
  s_waitcnt lgkmcnt(2)
  v_lshlrev_b32 v2, 16, v224
  v_and_b32 v3, s52, v224
  v_lshlrev_b32 v4, 16, v225
  v_and_b32 v5, s52, v225
  s_waitcnt lgkmcnt(1)
  v_lshlrev_b32 v246, 16, v234
  v_mfma_f32_16x16x32_bf16 v[176:179], a[56:59], a[228:231], v[176:179]
  v_and_b32 v247, s52, v234
  v_lshlrev_b32 v252, 16, v235
  v_and_b32 v253, s52, v235
  s_waitcnt lgkmcnt(0)
  v_and_b32 v245, s52, v245
  v_mul_f32 v245, v245, v244
  s_waitcnt vmcnt(19)
  v_mfma_f32_16x16x32_bf16 v[180:183], a[40:43], a[232:235], v[180:183]
  s_add_u32 s64, s66, 55296
  v_fma_f32 v254, v2, v244, v245
  v_fma_f32 v255, v3, v244, v245
  v_fma_f32 v16, v4, v244, v245
  v_fma_f32 v34, v5, v244, v245
  v_cvt_pk_bf16_f32 v254, v254, v255
  v_mfma_f32_16x16x32_bf16 v[184:187], a[44:47], a[232:235], v[184:187]
  v_cvt_pk_bf16_f32 v16, v16, v34
  v_and_b32 v255, s52, v254
  v_lshlrev_b32 v254, 16, v254
  v_and_b32 v34, s52, v16
  v_lshlrev_b32 v16, 16, v16
  v_mfma_f32_16x16x32_bf16 v[188:191], a[48:51], a[232:235], v[188:191]
  v_mul_f32 v254, v254, v246
  v_mul_f32 v255, v255, v247
  v_mul_f32 v16, v16, v252
  v_mul_f32 v34, v34, v253
  v_mfma_f32_16x16x32_bf16 v[192:195], a[52:55], a[232:235], v[192:195]
  buffer_load_dwordx4 a[192:195], v38, s[20:23], s64 offen sc1
  v_cvt_pk_bf16_f32 v254, v254, v255
  v_cvt_pk_bf16_f32 v16, v16, v34
  v_and_b32 v255, s52, v254
  v_lshlrev_b32 v254, 16, v254
  v_and_b32 v34, s52, v16
  v_mfma_f32_16x16x32_bf16 v[196:199], a[56:59], a[232:235], v[196:199]
  v_lshlrev_b32 v16, 16, v16
  v_add_f32 v224, v2, v254
  v_add_f32 v225, v3, v255
  v_add_f32 v234, v4, v16
  v_add_f32 v235, v5, v34
  s_waitcnt vmcnt(2)
  v_xor_b32 v39, s92, v250
  v_cmp_ne_u32 vcc, 0, v39
  s_nop 3
  s_cbranch_vccnz Y_poll9_slow
Y_poll9_ret:
  v_mfma_f32_16x16x32_bf16 v[40:43], a[40:43], a[196:199], v[40:43]
  s_add_u32 s65, s68, 16384
  buffer_load_dwordx4 a[0:3], v38, s[20:23], s65 offen offset:0 sc1
  v_mfma_f32_16x16x32_bf16 v[44:47], a[44:47], a[196:199], v[44:47]
  v_mfma_f32_16x16x32_bf16 v[48:51], a[48:51], a[196:199], v[48:51]
  buffer_load_dwordx4 a[4:7], v38, s[20:23], s65 offen offset:1024 sc1
  v_mfma_f32_16x16x32_bf16 v[52:55], a[52:55], a[196:199], v[52:55]
  v_mfma_f32_16x16x32_bf16 v[56:59], a[56:59], a[196:199], v[56:59]
  buffer_load_dwordx4 a[8:11], v38, s[20:23], s65 offen offset:2048 sc1
  v_mfma_f32_16x16x32_bf16 v[60:63], a[40:43], a[200:203], v[60:63]
  v_mfma_f32_16x16x32_bf16 v[64:67], a[44:47], a[200:203], v[64:67]
  buffer_load_dwordx4 a[12:15], v38, s[20:23], s65 offen offset:3072 sc1
  v_mfma_f32_16x16x32_bf16 v[68:71], a[48:51], a[200:203], v[68:71]
  v_mfma_f32_16x16x32_bf16 v[72:75], a[52:55], a[200:203], v[72:75]
  s_add_u32 s65, s68, 20480
  buffer_load_dwordx4 v[18:21], v38, s[20:23], s65 offen offset:0 sc1
  v_mfma_f32_16x16x32_bf16 v[76:79], a[56:59], a[200:203], v[76:79]
  v_mfma_f32_16x16x32_bf16 v[80:83], a[40:43], a[204:207], v[80:83]
  v_mfma_f32_16x16x32_bf16 v[84:87], a[44:47], a[204:207], v[84:87]
  v_mfma_f32_16x16x32_bf16 v[88:91], a[48:51], a[204:207], v[88:91]
  buffer_load_dwordx4 v[22:25], v38, s[20:23], s65 offen offset:1024 sc1
  v_mfma_f32_16x16x32_bf16 v[92:95], a[52:55], a[204:207], v[92:95]
  v_mfma_f32_16x16x32_bf16 v[96:99], a[56:59], a[204:207], v[96:99]
  v_mfma_f32_16x16x32_bf16 v[100:103], a[40:43], a[208:211], v[100:103]
  v_mfma_f32_16x16x32_bf16 v[104:107], a[44:47], a[208:211], v[104:107]
  buffer_load_dwordx4 v[26:29], v38, s[20:23], s65 offen offset:2048 sc1
  v_mfma_f32_16x16x32_bf16 v[108:111], a[48:51], a[208:211], v[108:111]
  v_mfma_f32_16x16x32_bf16 v[112:115], a[52:55], a[208:211], v[112:115]
  v_mfma_f32_16x16x32_bf16 v[116:119], a[56:59], a[208:211], v[116:119]
  s_getpc_b64 s[90:91]
Y_cp2:
  v_lshlrev_b32 v4, 7, v0
  v_min_u32 v4, Y_end-Y_cp2, v4
  global_load_dword v250, v4, s[90:91]
  v_mfma_f32_16x16x32_bf16 v[40:43], a[60:63], v[200:203], v[40:43]
  buffer_load_dwordx4 v[30:33], v38, s[20:23], s65 offen offset:3072 sc1
  v_mfma_f32_16x16x32_bf16 v[44:47], a[64:67], v[200:203], v[44:47]
  v_mfma_f32_16x16x32_bf16 v[48:51], a[68:71], v[200:203], v[48:51]
  v_mfma_f32_16x16x32_bf16 v[52:55], a[72:75], v[200:203], v[52:55]
  v_mfma_f32_16x16x32_bf16 v[56:59], a[76:79], v[200:203], v[56:59]
  s_add_u32 s65, s68, 24576
  buffer_load_dwordx4 a[16:19], v38, s[20:23], s65 offen offset:0 sc1
  v_mfma_f32_16x16x32_bf16 v[60:63], a[60:63], v[204:207], v[60:63]
  v_mfma_f32_16x16x32_bf16 v[64:67], a[64:67], v[204:207], v[64:67]
  v_mfma_f32_16x16x32_bf16 v[68:71], a[68:71], v[204:207], v[68:71]
  v_mfma_f32_16x16x32_bf16 v[72:75], a[72:75], v[204:207], v[72:75]
  buffer_load_dwordx4 a[20:23], v38, s[20:23], s65 offen offset:1024 sc1
  v_mfma_f32_16x16x32_bf16 v[76:79], a[76:79], v[204:207], v[76:79]
  v_mfma_f32_16x16x32_bf16 v[80:83], a[60:63], v[208:211], v[80:83]
  v_mfma_f32_16x16x32_bf16 v[84:87], a[64:67], v[208:211], v[84:87]
  v_mfma_f32_16x16x32_bf16 v[88:91], a[68:71], v[208:211], v[88:91]
  buffer_load_dwordx4 a[24:27], v38, s[20:23], s65 offen offset:2048 sc1
  v_mfma_f32_16x16x32_bf16 v[92:95], a[72:75], v[208:211], v[92:95]
  v_mfma_f32_16x16x32_bf16 v[96:99], a[76:79], v[208:211], v[96:99]
  v_mfma_f32_16x16x32_bf16 v[100:103], a[60:63], v[212:215], v[100:103]
  v_mfma_f32_16x16x32_bf16 v[104:107], a[64:67], v[212:215], v[104:107]
  buffer_load_dwordx4 a[28:31], v38, s[20:23], s65 offen offset:3072 sc1
  v_mfma_f32_16x16x32_bf16 v[108:111], a[68:71], v[212:215], v[108:111]
  v_mfma_f32_16x16x32_bf16 v[112:115], a[72:75], v[212:215], v[112:115]
  v_mfma_f32_16x16x32_bf16 v[116:119], a[76:79], v[212:215], v[116:119]
  s_waitcnt vmcnt(12)
  v_mfma_f32_16x16x32_bf16 v[40:43], a[80:83], a[0:3], v[40:43]
  s_add_u32 s65, s68, 28672
  buffer_load_dwordx4 a[220:223], v38, s[20:23], s65 offen offset:0 sc1
  v_mfma_f32_16x16x32_bf16 v[44:47], a[84:87], a[0:3], v[44:47]
  v_mfma_f32_16x16x32_bf16 v[48:51], a[88:91], a[0:3], v[48:51]
  v_mfma_f32_16x16x32_bf16 v[52:55], a[92:95], a[0:3], v[52:55]
  v_mfma_f32_16x16x32_bf16 v[56:59], a[96:99], a[0:3], v[56:59]
  buffer_load_dwordx4 a[224:227], v38, s[20:23], s65 offen offset:1024 sc1
  s_waitcnt vmcnt(13)
  v_mfma_f32_16x16x32_bf16 v[60:63], a[80:83], a[4:7], v[60:63]
  v_mfma_f32_16x16x32_bf16 v[64:67], a[84:87], a[4:7], v[64:67]
  v_mfma_f32_16x16x32_bf16 v[68:71], a[88:91], a[4:7], v[68:71]
  v_mfma_f32_16x16x32_bf16 v[72:75], a[92:95], a[4:7], v[72:75]
  buffer_load_dwordx4 a[228:231], v38, s[20:23], s65 offen offset:2048 sc1
  v_mfma_f32_16x16x32_bf16 v[76:79], a[96:99], a[4:7], v[76:79]
  s_waitcnt vmcnt(13)
  v_mfma_f32_16x16x32_bf16 v[80:83], a[80:83], a[8:11], v[80:83]
  v_mfma_f32_16x16x32_bf16 v[84:87], a[84:87], a[8:11], v[84:87]
  v_mfma_f32_16x16x32_bf16 v[88:91], a[88:91], a[8:11], v[88:91]
  buffer_load_dwordx4 a[232:235], v38, s[20:23], s65 offen offset:3072 sc1
  v_mfma_f32_16x16x32_bf16 v[92:95], a[92:95], a[8:11], v[92:95]
  v_mfma_f32_16x16x32_bf16 v[96:99], a[96:99], a[8:11], v[96:99]
  s_waitcnt vmcnt(13)
  v_mfma_f32_16x16x32_bf16 v[100:103], a[80:83], a[12:15], v[100:103]
  v_mfma_f32_16x16x32_bf16 v[104:107], a[84:87], a[12:15], v[104:107]
  s_add_u32 s65, s68, 32768
  buffer_load_dwordx4 a[196:199], v38, s[20:23], s65 offen offset:0 sc1
  v_mfma_f32_16x16x32_bf16 v[108:111], a[88:91], a[12:15], v[108:111]
  v_mfma_f32_16x16x32_bf16 v[112:115], a[92:95], a[12:15], v[112:115]
  v_mfma_f32_16x16x32_bf16 v[116:119], a[96:99], a[12:15], v[116:119]
  s_waitcnt vmcnt(13)
  v_mfma_f32_16x16x32_bf16 v[40:43], a[100:103], v[18:21], v[40:43]
  buffer_load_dwordx4 a[200:203], v38, s[20:23], s65 offen offset:1024 sc1
  v_mfma_f32_16x16x32_bf16 v[44:47], a[104:107], v[18:21], v[44:47]
  v_mfma_f32_16x16x32_bf16 v[48:51], a[108:111], v[18:21], v[48:51]
  v_mfma_f32_16x16x32_bf16 v[52:55], a[176:179], v[18:21], v[52:55]
  v_mfma_f32_16x16x32_bf16 v[56:59], a[212:215], v[18:21], v[56:59]
  buffer_load_dwordx4 a[204:207], v38, s[20:23], s65 offen offset:2048 sc1
  s_waitcnt vmcnt(14)
  v_mfma_f32_16x16x32_bf16 v[60:63], a[100:103], v[22:25], v[60:63]
  v_mfma_f32_16x16x32_bf16 v[64:67], a[104:107], v[22:25], v[64:67]
  v_mfma_f32_16x16x32_bf16 v[68:71], a[108:111], v[22:25], v[68:71]
  v_mfma_f32_16x16x32_bf16 v[72:75], a[176:179], v[22:25], v[72:75]
  buffer_load_dwordx4 a[208:211], v38, s[20:23], s65 offen offset:3072 sc1
  v_mfma_f32_16x16x32_bf16 v[76:79], a[212:215], v[22:25], v[76:79]
  s_waitcnt vmcnt(14)
  v_mfma_f32_16x16x32_bf16 v[80:83], a[100:103], v[26:29], v[80:83]
  v_mfma_f32_16x16x32_bf16 v[84:87], a[104:107], v[26:29], v[84:87]
  v_mfma_f32_16x16x32_bf16 v[88:91], a[108:111], v[26:29], v[88:91]
  s_add_u32 s65, s68, 36864
  buffer_load_dwordx4 a[32:35], v38, s[20:23], s65 offen offset:0 sc1
  v_mfma_f32_16x16x32_bf16 v[92:95], a[176:179], v[26:29], v[92:95]
  v_mfma_f32_16x16x32_bf16 v[96:99], a[212:215], v[26:29], v[96:99]
  s_waitcnt vmcnt(13)
  v_mfma_f32_16x16x32_bf16 v[100:103], a[100:103], v[30:33], v[100:103]
  v_mfma_f32_16x16x32_bf16 v[104:107], a[104:107], v[30:33], v[104:107]
  buffer_load_dwordx4 a[36:39], v38, s[20:23], s65 offen offset:1024 sc1
  v_mfma_f32_16x16x32_bf16 v[108:111], a[108:111], v[30:33], v[108:111]
  v_mfma_f32_16x16x32_bf16 v[112:115], a[176:179], v[30:33], v[112:115]
  v_mfma_f32_16x16x32_bf16 v[116:119], a[212:215], v[30:33], v[116:119]
  s_waitcnt vmcnt(13)
  v_mfma_f32_16x16x32_bf16 v[40:43], a[216:219], a[16:19], v[40:43]
  buffer_load_dwordx4 a[40:43], v38, s[20:23], s65 offen offset:2048 sc1
  v_mfma_f32_16x16x32_bf16 v[44:47], a[240:243], a[16:19], v[44:47]
  v_mfma_f32_16x16x32_bf16 v[48:51], a[244:247], a[16:19], v[48:51]
  v_mfma_f32_16x16x32_bf16 v[52:55], a[248:251], a[16:19], v[52:55]
  v_mfma_f32_16x16x32_bf16 v[56:59], a[252:255], a[16:19], v[56:59]
  buffer_load_dwordx4 a[44:47], v38, s[20:23], s65 offen offset:3072 sc1
  s_waitcnt vmcnt(14)
  v_mfma_f32_16x16x32_bf16 v[60:63], a[216:219], a[20:23], v[60:63]
  v_mfma_f32_16x16x32_bf16 v[64:67], a[240:243], a[20:23], v[64:67]
  v_mfma_f32_16x16x32_bf16 v[68:71], a[244:247], a[20:23], v[68:71]
  v_mfma_f32_16x16x32_bf16 v[72:75], a[248:251], a[20:23], v[72:75]
  s_add_u32 s65, s68, 40960
  buffer_load_dwordx4 v[200:203], v38, s[20:23], s65 offen offset:0 sc1
  v_mfma_f32_16x16x32_bf16 v[76:79], a[252:255], a[20:23], v[76:79]
  s_waitcnt vmcnt(14)
  v_mfma_f32_16x16x32_bf16 v[80:83], a[216:219], a[24:27], v[80:83]
  v_mfma_f32_16x16x32_bf16 v[84:87], a[240:243], a[24:27], v[84:87]
  v_mfma_f32_16x16x32_bf16 v[88:91], a[244:247], a[24:27], v[88:91]
  buffer_load_dwordx4 v[204:207], v38, s[20:23], s65 offen offset:1024 sc1
  v_mfma_f32_16x16x32_bf16 v[92:95], a[248:251], a[24:27], v[92:95]
  v_mfma_f32_16x16x32_bf16 v[96:99], a[252:255], a[24:27], v[96:99]
  s_waitcnt vmcnt(14)
  v_mfma_f32_16x16x32_bf16 v[100:103], a[216:219], a[28:31], v[100:103]
  v_mfma_f32_16x16x32_bf16 v[104:107], a[240:243], a[28:31], v[104:107]
  buffer_load_dwordx4 v[208:211], v38, s[20:23], s65 offen offset:2048 sc1
  v_mfma_f32_16x16x32_bf16 v[108:111], a[244:247], a[28:31], v[108:111]
  v_mfma_f32_16x16x32_bf16 v[112:115], a[248:251], a[28:31], v[112:115]
  v_mfma_f32_16x16x32_bf16 v[116:119], a[252:255], a[28:31], v[116:119]
  s_waitcnt vmcnt(14)
  v_mfma_f32_16x16x32_bf16 v[40:43], a[112:115], a[220:223], v[40:43]
  buffer_load_dwordx4 v[212:215], v38, s[20:23], s65 offen offset:3072 sc1
  v_mfma_f32_16x16x32_bf16 v[44:47], a[116:119], a[220:223], v[44:47]
  v_mfma_f32_16x16x32_bf16 v[48:51], a[120:123], a[220:223], v[48:51]
  v_mfma_f32_16x16x32_bf16 v[52:55], a[124:127], a[220:223], v[52:55]
  v_mfma_f32_16x16x32_bf16 v[56:59], a[128:131], a[220:223], v[56:59]
  s_add_u32 s65, s67, 12288
  buffer_load_dwordx4 a[0:3], v38, s[20:23], s65 offen offset:0 sc1
  s_waitcnt vmcnt(15)
  v_mfma_f32_16x16x32_bf16 v[60:63], a[112:115], a[224:227], v[60:63]
  v_mfma_f32_16x16x32_bf16 v[64:67], a[116:119], a[224:227], v[64:67]
  v_mfma_f32_16x16x32_bf16 v[68:71], a[120:123], a[224:227], v[68:71]
  v_mfma_f32_16x16x32_bf16 v[72:75], a[124:127], a[224:227], v[72:75]
  buffer_load_dwordx4 a[4:7], v38, s[20:23], s65 offen offset:1024 sc1
  v_mfma_f32_16x16x32_bf16 v[76:79], a[128:131], a[224:227], v[76:79]
  s_waitcnt vmcnt(15)
  v_mfma_f32_16x16x32_bf16 v[80:83], a[112:115], a[228:231], v[80:83]
  v_mfma_f32_16x16x32_bf16 v[84:87], a[116:119], a[228:231], v[84:87]
  v_mfma_f32_16x16x32_bf16 v[88:91], a[120:123], a[228:231], v[88:91]
  buffer_load_dwordx4 a[8:11], v38, s[20:23], s65 offen offset:2048 sc1
  v_mfma_f32_16x16x32_bf16 v[92:95], a[124:127], a[228:231], v[92:95]
  v_mfma_f32_16x16x32_bf16 v[96:99], a[128:131], a[228:231], v[96:99]
  s_waitcnt vmcnt(15)
  v_mfma_f32_16x16x32_bf16 v[100:103], a[112:115], a[232:235], v[100:103]
  v_mfma_f32_16x16x32_bf16 v[104:107], a[116:119], a[232:235], v[104:107]
  buffer_load_dwordx4 a[12:15], v38, s[20:23], s65 offen offset:3072 sc1
  v_mfma_f32_16x16x32_bf16 v[108:111], a[120:123], a[232:235], v[108:111]
  v_mfma_f32_16x16x32_bf16 v[112:115], a[124:127], a[232:235], v[112:115]
  v_mfma_f32_16x16x32_bf16 v[116:119], a[128:131], a[232:235], v[116:119]
  s_waitcnt vmcnt(15)
  v_mfma_f32_16x16x32_bf16 v[40:43], a[132:135], a[196:199], v[40:43]
  s_add_u32 s65, s67, 16384
  buffer_load_dwordx4 v[18:21], v38, s[20:23], s65 offen offset:0 sc1
  v_mfma_f32_16x16x32_bf16 v[44:47], a[136:139], a[196:199], v[44:47]
  v_mfma_f32_16x16x32_bf16 v[48:51], a[140:143], a[196:199], v[48:51]
  v_mfma_f32_16x16x32_bf16 v[52:55], a[144:147], a[196:199], v[52:55]
  v_mfma_f32_16x16x32_bf16 v[56:59], a[148:151], a[196:199], v[56:59]
  buffer_load_dwordx4 v[22:25], v38, s[20:23], s65 offen offset:1024 sc1
  s_waitcnt vmcnt(16)
  v_mfma_f32_16x16x32_bf16 v[60:63], a[132:135], a[200:203], v[60:63]
  v_mfma_f32_16x16x32_bf16 v[64:67], a[136:139], a[200:203], v[64:67]
  v_mfma_f32_16x16x32_bf16 v[68:71], a[140:143], a[200:203], v[68:71]
  v_mfma_f32_16x16x32_bf16 v[72:75], a[144:147], a[200:203], v[72:75]
  buffer_load_dwordx4 v[26:29], v38, s[20:23], s65 offen offset:2048 sc1
  v_mfma_f32_16x16x32_bf16 v[76:79], a[148:151], a[200:203], v[76:79]
  s_waitcnt vmcnt(16)
  v_mfma_f32_16x16x32_bf16 v[80:83], a[132:135], a[204:207], v[80:83]
  v_mfma_f32_16x16x32_bf16 v[84:87], a[136:139], a[204:207], v[84:87]
  v_mfma_f32_16x16x32_bf16 v[88:91], a[140:143], a[204:207], v[88:91]
  buffer_load_dwordx4 v[30:33], v38, s[20:23], s65 offen offset:3072 sc1
  v_mfma_f32_16x16x32_bf16 v[92:95], a[144:147], a[204:207], v[92:95]
  v_mfma_f32_16x16x32_bf16 v[96:99], a[148:151], a[204:207], v[96:99]
  s_waitcnt vmcnt(16)
  v_mfma_f32_16x16x32_bf16 v[100:103], a[132:135], a[208:211], v[100:103]
  v_mfma_f32_16x16x32_bf16 v[104:107], a[136:139], a[208:211], v[104:107]
  s_add_u32 s65, s67, 20480
  buffer_load_dwordx4 a[16:19], v38, s[20:23], s65 offen offset:0 sc1
  v_mfma_f32_16x16x32_bf16 v[108:111], a[140:143], a[208:211], v[108:111]
  v_mfma_f32_16x16x32_bf16 v[112:115], a[144:147], a[208:211], v[112:115]
  v_mfma_f32_16x16x32_bf16 v[116:119], a[148:151], a[208:211], v[116:119]
  s_waitcnt vmcnt(16)
  v_mfma_f32_16x16x32_bf16 v[40:43], a[152:155], a[32:35], v[40:43]
  buffer_load_dwordx4 a[20:23], v38, s[20:23], s65 offen offset:1024 sc1
  v_mfma_f32_16x16x32_bf16 v[44:47], a[156:159], a[32:35], v[44:47]
  v_mfma_f32_16x16x32_bf16 v[48:51], a[160:163], a[32:35], v[48:51]
  v_mfma_f32_16x16x32_bf16 v[52:55], a[164:167], a[32:35], v[52:55]
  v_mfma_f32_16x16x32_bf16 v[56:59], a[168:171], a[32:35], v[56:59]
  buffer_load_dwordx4 a[24:27], v38, s[20:23], s65 offen offset:2048 sc1
  s_waitcnt vmcnt(14)
  v_mfma_f32_16x16x32_bf16 v[40:43], a[172:175], v[200:203], v[40:43]
  v_mfma_f32_16x16x32_bf16 v[44:47], a[180:183], v[200:203], v[44:47]
  v_mfma_f32_16x16x32_bf16 v[48:51], a[184:187], v[200:203], v[48:51]
  v_mfma_f32_16x16x32_bf16 v[52:55], a[188:191], v[200:203], v[52:55]
  buffer_load_dwordx4 a[28:31], v38, s[20:23], s65 offen offset:3072 sc1
  v_mfma_f32_16x16x32_bf16 v[56:59], a[192:195], v[200:203], v[56:59]
  v_mfma_f32_16x16x32_bf16 v[60:63], a[152:155], a[36:39], v[60:63]
  v_mfma_f32_16x16x32_bf16 v[64:67], a[156:159], a[36:39], v[64:67]
  v_mfma_f32_16x16x32_bf16 v[68:71], a[160:163], a[36:39], v[68:71]
  s_add_u32 s65, s67, 24576
  buffer_load_dwordx4 a[220:223], v38, s[20:23], s65 offen offset:0 sc1
  v_mfma_f32_16x16x32_bf16 v[72:75], a[164:167], a[36:39], v[72:75]
  ds_write_b128 v36, v[40:43] offset:0
  v_mfma_f32_16x16x32_bf16 v[76:79], a[168:171], a[36:39], v[76:79]
  ds_write_b128 v36, v[44:47] offset:64
  s_waitcnt vmcnt(15)
  v_mfma_f32_16x16x32_bf16 v[60:63], a[172:175], v[204:207], v[60:63]
  ds_write_b128 v36, v[48:51] offset:128
  v_mfma_f32_16x16x32_bf16 v[64:67], a[180:183], v[204:207], v[64:67]
  buffer_load_dwordx4 a[224:227], v38, s[20:23], s65 offen offset:1024 sc1
  ds_write_b128 v36, v[52:55] offset:192
  v_mfma_f32_16x16x32_bf16 v[68:71], a[184:187], v[204:207], v[68:71]
  ds_write_b128 v36, v[56:59] offset:256
  v_mfma_f32_16x16x32_bf16 v[72:75], a[188:191], v[204:207], v[72:75]
  v_mfma_f32_16x16x32_bf16 v[76:79], a[192:195], v[204:207], v[76:79]
  v_mfma_f32_16x16x32_bf16 v[80:83], a[152:155], a[40:43], v[80:83]
  buffer_load_dwordx4 a[228:231], v38, s[20:23], s65 offen offset:2048 sc1
  v_mfma_f32_16x16x32_bf16 v[84:87], a[156:159], a[40:43], v[84:87]
  v_mfma_f32_16x16x32_bf16 v[88:91], a[160:163], a[40:43], v[88:91]
  v_mfma_f32_16x16x32_bf16 v[92:95], a[164:167], a[40:43], v[92:95]
  ds_write_b128 v36, v[60:63] offset:5376
  v_mfma_f32_16x16x32_bf16 v[96:99], a[168:171], a[40:43], v[96:99]
  buffer_load_dwordx4 a[232:235], v38, s[20:23], s65 offen offset:3072 sc1
  ds_write_b128 v36, v[64:67] offset:5440
  s_waitcnt vmcnt(17)
  v_mfma_f32_16x16x32_bf16 v[80:83], a[172:175], v[208:211], v[80:83]
  ds_write_b128 v36, v[68:71] offset:5504
  v_mfma_f32_16x16x32_bf16 v[84:87], a[180:183], v[208:211], v[84:87]
  ds_write_b128 v36, v[72:75] offset:5568
  v_mfma_f32_16x16x32_bf16 v[88:91], a[184:187], v[208:211], v[88:91]
  ds_write_b128 v36, v[76:79] offset:5632
  v_mfma_f32_16x16x32_bf16 v[92:95], a[188:191], v[208:211], v[92:95]
  s_add_u32 s65, s67, 28672
  buffer_load_dwordx4 a[196:199], v38, s[20:23], s65 offen offset:0 sc1
  v_mfma_f32_16x16x32_bf16 v[96:99], a[192:195], v[208:211], v[96:99]
  v_mfma_f32_16x16x32_bf16 v[100:103], a[152:155], a[44:47], v[100:103]
  v_mfma_f32_16x16x32_bf16 v[104:107], a[156:159], a[44:47], v[104:107]
  v_mfma_f32_16x16x32_bf16 v[108:111], a[160:163], a[44:47], v[108:111]
  buffer_load_dwordx4 a[200:203], v38, s[20:23], s65 offen offset:1024 sc1
  v_mfma_f32_16x16x32_bf16 v[112:115], a[164:167], a[44:47], v[112:115]
  ds_write_b128 v36, v[80:83] offset:10752
  v_mfma_f32_16x16x32_bf16 v[116:119], a[168:171], a[44:47], v[116:119]
  ds_write_b128 v36, v[84:87] offset:10816
  s_waitcnt vmcnt(18)
  v_mfma_f32_16x16x32_bf16 v[100:103], a[172:175], v[212:215], v[100:103]
  ds_write_b128 v36, v[88:91] offset:10880
  v_mfma_f32_16x16x32_bf16 v[104:107], a[180:183], v[212:215], v[104:107]
  buffer_load_dwordx4 a[204:207], v38, s[20:23], s65 offen offset:2048 sc1
  ds_write_b128 v36, v[92:95] offset:10944
  v_mfma_f32_16x16x32_bf16 v[108:111], a[184:187], v[212:215], v[108:111]
  ds_write_b128 v36, v[96:99] offset:11008
  v_mfma_f32_16x16x32_bf16 v[112:115], a[188:191], v[212:215], v[112:115]
  v_mfma_f32_16x16x32_bf16 v[116:119], a[192:195], v[212:215], v[116:119]
  s_waitcnt vmcnt(18)
  v_mfma_f32_16x16x32_bf16 v[120:123], a[60:63], a[0:3], v[120:123]
  buffer_load_dwordx4 a[208:211], v38, s[20:23], s65 offen offset:3072 sc1
  v_mfma_f32_16x16x32_bf16 v[124:127], a[64:67], a[0:3], v[124:127]
  v_mfma_f32_16x16x32_bf16 v[128:131], a[68:71], a[0:3], v[128:131]
  v_mfma_f32_16x16x32_bf16 v[132:135], a[72:75], a[0:3], v[132:135]
  s_waitcnt lgkmcnt(10)
  ds_write_b128 v36, v[100:103] offset:16128
  v_mfma_f32_16x16x32_bf16 v[136:139], a[76:79], a[0:3], v[136:139]
  s_add_u32 s65, s67, 32768
  buffer_load_dwordx4 v[200:203], v38, s[20:23], s65 offen offset:0 sc1
  ds_write_b128 v36, v[104:107] offset:16192
  s_waitcnt vmcnt(19)
  v_mfma_f32_16x16x32_bf16 v[140:143], a[60:63], a[4:7], v[140:143]
  ds_write_b128 v36, v[108:111] offset:16256
  v_mfma_f32_16x16x32_bf16 v[144:147], a[64:67], a[4:7], v[144:147]
  ds_write_b128 v36, v[112:115] offset:16320
  v_mfma_f32_16x16x32_bf16 v[148:151], a[68:71], a[4:7], v[148:151]
  ds_write_b128 v36, v[116:119] offset:16384
  v_mfma_f32_16x16x32_bf16 v[152:155], a[72:75], a[4:7], v[152:155]
  buffer_load_dwordx4 v[204:207], v38, s[20:23], s65 offen offset:1024 sc1
  v_mfma_f32_16x16x32_bf16 v[156:159], a[76:79], a[4:7], v[156:159]
  s_waitcnt vmcnt(19)
  v_mfma_f32_16x16x32_bf16 v[160:163], a[60:63], a[8:11], v[160:163]
  v_mfma_f32_16x16x32_bf16 v[164:167], a[64:67], a[8:11], v[164:167]
  v_mfma_f32_16x16x32_bf16 v[168:171], a[68:71], a[8:11], v[168:171]
  buffer_load_dwordx4 v[208:211], v38, s[20:23], s65 offen offset:2048 sc1
  s_waitcnt lgkmcnt(0)
  s_barrier
  v_mfma_f32_16x16x32_bf16 v[172:175], a[72:75], a[8:11], v[172:175]
  v_mfma_f32_16x16x32_bf16 v[176:179], a[76:79], a[8:11], v[176:179]
  s_waitcnt vmcnt(19)
  v_mfma_f32_16x16x32_bf16 v[180:183], a[60:63], a[12:15], v[180:183]
  v_mfma_f32_16x16x32_bf16 v[184:187], a[64:67], a[12:15], v[184:187]
  buffer_load_dwordx4 v[212:215], v38, s[20:23], s65 offen offset:3072 sc1
  v_mfma_f32_16x16x32_bf16 v[188:191], a[68:71], a[12:15], v[188:191]
  v_mfma_f32_16x16x32_bf16 v[192:195], a[72:75], a[12:15], v[192:195]
  v_mfma_f32_16x16x32_bf16 v[196:199], a[76:79], a[12:15], v[196:199]
  s_waitcnt vmcnt(19)
  v_mfma_f32_16x16x32_bf16 v[120:123], a[80:83], v[18:21], v[120:123]
  s_add_u32 s65, s67, 36864
  buffer_load_dwordx4 a[32:35], v38, s[20:23], s65 offen offset:0 sc1
  ds_read_b128 v[40:43], v6 offset:0
  ds_read_b128 v[44:47], v6 offset:21504
  ds_read_b128 v[48:51], v6 offset:43008
  v_mfma_f32_16x16x32_bf16 v[124:127], a[84:87], v[18:21], v[124:127]
  ds_read_b128 v[52:55], v6 offset:64512
  ds_read_b128 v[56:59], v7 offset:0
  v_mfma_f32_16x16x32_bf16 v[128:131], a[88:91], v[18:21], v[128:131]
  ds_read_b128 v[60:63], v7 offset:21504
  ds_read_b128 v[64:67], v7 offset:43008
  ds_read_b128 v[68:71], v7 offset:64512
  v_mfma_f32_16x16x32_bf16 v[132:135], a[92:95], v[18:21], v[132:135]
  ds_read_b128 v[72:75], v8 offset:0
  ds_read_b128 v[76:79], v8 offset:21504
  v_mfma_f32_16x16x32_bf16 v[136:139], a[96:99], v[18:21], v[136:139]
  buffer_load_dwordx4 a[36:39], v38, s[20:23], s65 offen offset:1024 sc1
  ds_read_b128 v[80:83], v8 offset:43008
  ds_read_b128 v[84:87], v8 offset:64512
  s_waitcnt lgkmcnt(10)
  v_add_f32 v40, v40, v44
  s_waitcnt vmcnt(20)
  v_mfma_f32_16x16x32_bf16 v[140:143], a[80:83], v[22:25], v[140:143]
  s_waitcnt lgkmcnt(8)
  v_add_f32 v48, v48, v52
  v_add_f32 v41, v41, v45
  v_mfma_f32_16x16x32_bf16 v[144:147], a[84:87], v[22:25], v[144:147]
  v_add_f32 v49, v49, v53
  v_add_f32 v42, v42, v46
  v_add_f32 v50, v50, v54
  v_mfma_f32_16x16x32_bf16 v[148:151], a[88:91], v[22:25], v[148:151]
  v_add_f32 v43, v43, v47
  v_add_f32 v51, v51, v55
  v_mfma_f32_16x16x32_bf16 v[152:155], a[92:95], v[22:25], v[152:155]
  buffer_load_dwordx4 a[40:43], v38, s[20:23], s65 offen offset:2048 sc1
  v_add_f32 v40, v40, v48
  v_add_f32 v41, v41, v49
  v_add_f32 v42, v42, v50
  v_mfma_f32_16x16x32_bf16 v[156:159], a[96:99], v[22:25], v[156:159]
  v_add_f32 v43, v43, v51
  v_cvt_pk_bf16_f32 v88, v40, v41
  s_waitcnt vmcnt(20)
  v_mfma_f32_16x16x32_bf16 v[160:163], a[80:83], v[26:29], v[160:163]
  v_cvt_pk_bf16_f32 v89, v42, v43
  ds_read_b128 v[40:43], v9 offset:0
  ds_read_b128 v[44:47], v9 offset:21504
  v_mfma_f32_16x16x32_bf16 v[164:167], a[84:87], v[26:29], v[164:167]
  ds_read_b128 v[48:51], v9 offset:43008
  ds_read_b128 v[52:55], v9 offset:64512
  s_waitcnt lgkmcnt(10)
  v_add_f32 v56, v56, v60
  v_mfma_f32_16x16x32_bf16 v[168:171], a[88:91], v[26:29], v[168:171]
  buffer_load_dwordx4 a[44:47], v38, s[20:23], s65 offen offset:3072 sc1
  s_waitcnt lgkmcnt(8)
  v_add_f32 v64, v64, v68
  v_add_f32 v57, v57, v61
  v_mfma_f32_16x16x32_bf16 v[172:175], a[92:95], v[26:29], v[172:175]
  v_add_f32 v65, v65, v69
  v_add_f32 v58, v58, v62
  v_add_f32 v66, v66, v70
  v_mfma_f32_16x16x32_bf16 v[176:179], a[96:99], v[26:29], v[176:179]
  v_add_f32 v59, v59, v63
  v_add_f32 v67, v67, v71
  s_waitcnt vmcnt(20)
  v_mfma_f32_16x16x32_bf16 v[180:183], a[80:83], v[30:33], v[180:183]
  v_add_f32 v56, v56, v64
  v_add_f32 v57, v57, v65
  v_add_f32 v58, v58, v66
  v_mfma_f32_16x16x32_bf16 v[184:187], a[84:87], v[30:33], v[184:187]
  s_add_u32 s65, s67, 40960
  buffer_load_dwordx4 a[0:3], v38, s[20:23], s65 offen offset:0 sc1
  v_add_f32 v59, v59, v67
  v_cvt_pk_bf16_f32 v90, v56, v57
  v_mfma_f32_16x16x32_bf16 v[188:191], a[88:91], v[30:33], v[188:191]
  v_cvt_pk_bf16_f32 v92, v58, v59
  v_mov_b32 v91, s92
  buffer_store_dwordx4 v[88:91], v17, s[20:23], s63 offen sc1
  v_mfma_f32_16x16x32_bf16 v[192:195], a[92:95], v[30:33], v[192:195]
  s_add_u32 s63, s63, 4096
  ds_read_b128 v[56:59], v10 offset:0
  v_mfma_f32_16x16x32_bf16 v[196:199], a[96:99], v[30:33], v[196:199]
  ds_read_b128 v[60:63], v10 offset:21504
  ds_read_b128 v[64:67], v10 offset:43008
  ds_read_b128 v[68:71], v10 offset:64512
  s_waitcnt vmcnt(21)
  v_mfma_f32_16x16x32_bf16 v[120:123], a[100:103], a[16:19], v[120:123]
  buffer_load_dwordx4 a[4:7], v38, s[20:23], s65 offen offset:1024 sc1
  s_waitcnt lgkmcnt(10)
  v_add_f32 v72, v72, v76
  s_waitcnt lgkmcnt(8)
  v_add_f32 v80, v80, v84
  v_add_f32 v73, v73, v77
  v_mfma_f32_16x16x32_bf16 v[124:127], a[104:107], a[16:19], v[124:127]
  v_add_f32 v81, v81, v85
  v_add_f32 v74, v74, v78
  v_mfma_f32_16x16x32_bf16 v[128:131], a[108:111], a[16:19], v[128:131]
  v_add_f32 v82, v82, v86
  v_add_f32 v75, v75, v79
  v_add_f32 v83, v83, v87
  v_mfma_f32_16x16x32_bf16 v[132:135], a[176:179], a[16:19], v[132:135]
  v_add_f32 v72, v72, v80
  v_add_f32 v73, v73, v81
  v_mfma_f32_16x16x32_bf16 v[136:139], a[212:215], a[16:19], v[136:139]
  buffer_load_dwordx4 a[8:11], v38, s[20:23], s65 offen offset:2048 sc1
  v_add_f32 v74, v74, v82
  v_add_f32 v75, v75, v83
  v_cvt_pk_bf16_f32 v93, v72, v73
  s_waitcnt vmcnt(22)
  v_mfma_f32_16x16x32_bf16 v[140:143], a[100:103], a[20:23], v[140:143]
  v_cvt_pk_bf16_f32 v94, v74, v75
  v_mov_b32 v95, s92
  v_mfma_f32_16x16x32_bf16 v[144:147], a[104:107], a[20:23], v[144:147]
  buffer_store_dwordx4 v[92:95], v17, s[20:23], s63 offen sc1
  s_add_u32 s63, s63, 4096
  s_waitcnt lgkmcnt(6)
  v_add_f32 v40, v40, v44
  v_mfma_f32_16x16x32_bf16 v[148:151], a[108:111], a[20:23], v[148:151]
  s_waitcnt lgkmcnt(4)
  v_add_f32 v48, v48, v52
  v_add_f32 v41, v41, v45
  v_mfma_f32_16x16x32_bf16 v[152:155], a[176:179], a[20:23], v[152:155]
  buffer_load_dwordx4 a[12:15], v38, s[20:23], s65 offen offset:3072 sc1
  v_add_f32 v49, v49, v53
  v_add_f32 v42, v42, v46
  v_add_f32 v50, v50, v54
  v_mfma_f32_16x16x32_bf16 v[156:159], a[212:215], a[20:23], v[156:159]
  v_add_f32 v43, v43, v47
  v_add_f32 v51, v51, v55
  v_add_f32 v40, v40, v48
  s_waitcnt vmcnt(23)
  v_mfma_f32_16x16x32_bf16 v[160:163], a[100:103], a[24:27], v[160:163]
  v_add_f32 v41, v41, v49
  v_add_f32 v42, v42, v50
  v_mfma_f32_16x16x32_bf16 v[164:167], a[104:107], a[24:27], v[164:167]
  v_add_f32 v43, v43, v51
  v_cvt_pk_bf16_f32 v96, v40, v41
  v_cvt_pk_bf16_f32 v97, v42, v43
  v_mfma_f32_16x16x32_bf16 v[168:171], a[108:111], a[24:27], v[168:171]
  s_waitcnt lgkmcnt(2)
  v_add_f32 v56, v56, v60
  s_waitcnt lgkmcnt(0)
  v_add_f32 v64, v64, v68
  v_mfma_f32_16x16x32_bf16 v[172:175], a[176:179], a[24:27], v[172:175]
  v_add_f32 v57, v57, v61
  v_add_f32 v65, v65, v69
  v_add_f32 v58, v58, v62
  v_mfma_f32_16x16x32_bf16 v[176:179], a[212:215], a[24:27], v[176:179]
  v_add_f32 v66, v66, v70
  v_add_f32 v59, v59, v63
  s_waitcnt vmcnt(22)
  v_mfma_f32_16x16x32_bf16 v[180:183], a[100:103], a[28:31], v[180:183]
  v_add_f32 v67, v67, v71
  v_add_f32 v56, v56, v64
  v_add_f32 v57, v57, v65
  v_mfma_f32_16x16x32_bf16 v[184:187], a[104:107], a[28:31], v[184:187]
  v_add_f32 v58, v58, v66
  v_add_f32 v59, v59, v67
  v_mfma_f32_16x16x32_bf16 v[188:191], a[108:111], a[28:31], v[188:191]
  v_cvt_pk_bf16_f32 v98, v56, v57
  v_cvt_pk_bf16_f32 v100, v58, v59
  v_mov_b32 v99, s92
  v_mfma_f32_16x16x32_bf16 v[192:195], a[176:179], a[28:31], v[192:195]
  buffer_store_dwordx4 v[96:99], v17, s[20:23], s63 offen sc1
  s_add_u32 s63, s63, 4096
  v_mfma_f32_16x16x32_bf16 v[196:199], a[212:215], a[28:31], v[196:199]
  v_mov_b32 v101, s92
  v_lshrrev_b32 v16, 1, v17
  buffer_store_dwordx2 v[100:101], v16, s[20:23], s63 offen sc1
  s_waitcnt vmcnt(23)
  v_mfma_f32_16x16x32_bf16 v[120:123], a[216:219], a[220:223], v[120:123]
  s_add_u32 s70, s62, 0
  v_mfma_f32_16x16x32_bf16 v[124:127], a[240:243], a[220:223], v[124:127]
  s_add_u32 s71, s62, 4096
  v_mfma_f32_16x16x32_bf16 v[128:131], a[244:247], a[220:223], v[128:131]
  s_add_u32 s72, s62, 8192
  v_mfma_f32_16x16x32_bf16 v[132:135], a[248:251], a[220:223], v[132:135]
  s_add_u32 s73, s62, 12288
  v_mfma_f32_16x16x32_bf16 v[136:139], a[252:255], a[220:223], v[136:139]
  s_waitcnt vmcnt(22)
  v_mfma_f32_16x16x32_bf16 v[140:143], a[216:219], a[224:227], v[140:143]
  v_mfma_f32_16x16x32_bf16 v[144:147], a[240:243], a[224:227], v[144:147]
  v_mfma_f32_16x16x32_bf16 v[148:151], a[244:247], a[224:227], v[148:151]
  v_mfma_f32_16x16x32_bf16 v[152:155], a[248:251], a[224:227], v[152:155]
  v_mfma_f32_16x16x32_bf16 v[156:159], a[252:255], a[224:227], v[156:159]
  s_waitcnt vmcnt(21)
  v_mfma_f32_16x16x32_bf16 v[160:163], a[216:219], a[228:231], v[160:163]
  v_mfma_f32_16x16x32_bf16 v[164:167], a[240:243], a[228:231], v[164:167]
  v_mfma_f32_16x16x32_bf16 v[168:171], a[244:247], a[228:231], v[168:171]
  v_mfma_f32_16x16x32_bf16 v[172:175], a[248:251], a[228:231], v[172:175]
  v_mfma_f32_16x16x32_bf16 v[176:179], a[252:255], a[228:231], v[176:179]
  s_waitcnt vmcnt(20)
  v_mfma_f32_16x16x32_bf16 v[180:183], a[216:219], a[232:235], v[180:183]
  v_mfma_f32_16x16x32_bf16 v[184:187], a[240:243], a[232:235], v[184:187]
  v_mfma_f32_16x16x32_bf16 v[188:191], a[244:247], a[232:235], v[188:191]
  v_mfma_f32_16x16x32_bf16 v[192:195], a[248:251], a[232:235], v[192:195]
  v_mfma_f32_16x16x32_bf16 v[196:199], a[252:255], a[232:235], v[196:199]
  s_waitcnt vmcnt(19)
  v_mfma_f32_16x16x32_bf16 v[120:123], a[112:115], a[196:199], v[120:123]
  v_mfma_f32_16x16x32_bf16 v[124:127], a[116:119], a[196:199], v[124:127]
  v_mfma_f32_16x16x32_bf16 v[128:131], a[120:123], a[196:199], v[128:131]
  v_mfma_f32_16x16x32_bf16 v[132:135], a[124:127], a[196:199], v[132:135]
  v_mfma_f32_16x16x32_bf16 v[136:139], a[128:131], a[196:199], v[136:139]
  s_waitcnt vmcnt(18)
  v_mfma_f32_16x16x32_bf16 v[140:143], a[112:115], a[200:203], v[140:143]
  v_mfma_f32_16x16x32_bf16 v[144:147], a[116:119], a[200:203], v[144:147]
  v_mfma_f32_16x16x32_bf16 v[148:151], a[120:123], a[200:203], v[148:151]
  v_mfma_f32_16x16x32_bf16 v[152:155], a[124:127], a[200:203], v[152:155]
  v_mfma_f32_16x16x32_bf16 v[156:159], a[128:131], a[200:203], v[156:159]
  s_waitcnt vmcnt(17)
  v_mfma_f32_16x16x32_bf16 v[160:163], a[112:115], a[204:207], v[160:163]
  v_mfma_f32_16x16x32_bf16 v[164:167], a[116:119], a[204:207], v[164:167]
  v_mfma_f32_16x16x32_bf16 v[168:171], a[120:123], a[204:207], v[168:171]
  v_mfma_f32_16x16x32_bf16 v[172:175], a[124:127], a[204:207], v[172:175]
  v_mfma_f32_16x16x32_bf16 v[176:179], a[128:131], a[204:207], v[176:179]
  s_waitcnt vmcnt(16)
  v_mfma_f32_16x16x32_bf16 v[180:183], a[112:115], a[208:211], v[180:183]
  v_mfma_f32_16x16x32_bf16 v[184:187], a[116:119], a[208:211], v[184:187]
  v_mfma_f32_16x16x32_bf16 v[188:191], a[120:123], a[208:211], v[188:191]
  v_mfma_f32_16x16x32_bf16 v[192:195], a[124:127], a[208:211], v[192:195]
  v_mfma_f32_16x16x32_bf16 v[196:199], a[128:131], a[208:211], v[196:199]
  s_waitcnt vmcnt(15)
  v_mfma_f32_16x16x32_bf16 v[120:123], a[132:135], v[200:203], v[120:123]
  v_mfma_f32_16x16x32_bf16 v[124:127], a[136:139], v[200:203], v[124:127]
  v_mfma_f32_16x16x32_bf16 v[128:131], a[140:143], v[200:203], v[128:131]
  v_mfma_f32_16x16x32_bf16 v[132:135], a[144:147], v[200:203], v[132:135]
  v_mfma_f32_16x16x32_bf16 v[136:139], a[148:151], v[200:203], v[136:139]
  s_waitcnt vmcnt(14)
  v_mfma_f32_16x16x32_bf16 v[140:143], a[132:135], v[204:207], v[140:143]
  v_mfma_f32_16x16x32_bf16 v[144:147], a[136:139], v[204:207], v[144:147]
  v_mfma_f32_16x16x32_bf16 v[148:151], a[140:143], v[204:207], v[148:151]
  v_mfma_f32_16x16x32_bf16 v[152:155], a[144:147], v[204:207], v[152:155]
  v_mfma_f32_16x16x32_bf16 v[156:159], a[148:151], v[204:207], v[156:159]
  s_waitcnt vmcnt(13)
  v_mfma_f32_16x16x32_bf16 v[160:163], a[132:135], v[208:211], v[160:163]
  v_mfma_f32_16x16x32_bf16 v[164:167], a[136:139], v[208:211], v[164:167]
  v_mfma_f32_16x16x32_bf16 v[168:171], a[140:143], v[208:211], v[168:171]
  v_mfma_f32_16x16x32_bf16 v[172:175], a[144:147], v[208:211], v[172:175]
  v_mfma_f32_16x16x32_bf16 v[176:179], a[148:151], v[208:211], v[176:179]
  s_waitcnt vmcnt(12)
  v_mfma_f32_16x16x32_bf16 v[180:183], a[132:135], v[212:215], v[180:183]
  v_mfma_f32_16x16x32_bf16 v[184:187], a[136:139], v[212:215], v[184:187]
  v_mfma_f32_16x16x32_bf16 v[188:191], a[140:143], v[212:215], v[188:191]
  v_mfma_f32_16x16x32_bf16 v[192:195], a[144:147], v[212:215], v[192:195]
  v_mfma_f32_16x16x32_bf16 v[196:199], a[148:151], v[212:215], v[196:199]
  s_waitcnt vmcnt(11)
  v_mfma_f32_16x16x32_bf16 v[120:123], a[152:155], a[32:35], v[120:123]
  s_barrier
  buffer_load_dwordx4 v[40:43], v17, s[20:23], s70 offen sc1
  v_mfma_f32_16x16x32_bf16 v[124:127], a[156:159], a[32:35], v[124:127]
  buffer_load_dwordx4 v[44:47], v17, s[20:23], s71 offen sc1
  v_mfma_f32_16x16x32_bf16 v[128:131], a[160:163], a[32:35], v[128:131]
  buffer_load_dwordx4 v[48:51], v17, s[20:23], s72 offen sc1
  v_mfma_f32_16x16x32_bf16 v[132:135], a[164:167], a[32:35], v[132:135]
  buffer_load_dwordx2 v[52:53], v16, s[20:23], s73 offen sc1
  v_mfma_f32_16x16x32_bf16 v[136:139], a[168:171], a[32:35], v[136:139]
  s_waitcnt vmcnt(11)
  v_mfma_f32_16x16x32_bf16 v[120:123], a[172:175], a[0:3], v[120:123]
  v_mfma_f32_16x16x32_bf16 v[124:127], a[180:183], a[0:3], v[124:127]
  v_mfma_f32_16x16x32_bf16 v[128:131], a[184:187], a[0:3], v[128:131]
  v_mfma_f32_16x16x32_bf16 v[132:135], a[188:191], a[0:3], v[132:135]
  v_mfma_f32_16x16x32_bf16 v[136:139], a[192:195], a[0:3], v[136:139]
  v_mfma_f32_16x16x32_bf16 v[140:143], a[152:155], a[36:39], v[140:143]
  v_mfma_f32_16x16x32_bf16 v[144:147], a[156:159], a[36:39], v[144:147]
  v_mfma_f32_16x16x32_bf16 v[148:151], a[160:163], a[36:39], v[148:151]
  v_mfma_f32_16x16x32_bf16 v[152:155], a[164:167], a[36:39], v[152:155]
  ds_write_b128 v36, v[120:123] offset:0
  v_mfma_f32_16x16x32_bf16 v[156:159], a[168:171], a[36:39], v[156:159]
  ds_write_b128 v36, v[124:127] offset:64
  s_waitcnt vmcnt(9)
  v_mfma_f32_16x16x32_bf16 v[140:143], a[172:175], a[4:7], v[140:143]
  ds_write_b128 v36, v[128:131] offset:128
  v_mfma_f32_16x16x32_bf16 v[144:147], a[180:183], a[4:7], v[144:147]
  ds_write_b128 v36, v[132:135] offset:192
  v_mfma_f32_16x16x32_bf16 v[148:151], a[184:187], a[4:7], v[148:151]
  ds_write_b128 v36, v[136:139] offset:256
  v_mfma_f32_16x16x32_bf16 v[152:155], a[188:191], a[4:7], v[152:155]
  v_mfma_f32_16x16x32_bf16 v[156:159], a[192:195], a[4:7], v[156:159]
  v_mfma_f32_16x16x32_bf16 v[160:163], a[152:155], a[40:43], v[160:163]
  v_mfma_f32_16x16x32_bf16 v[164:167], a[156:159], a[40:43], v[164:167]
  v_mfma_f32_16x16x32_bf16 v[168:171], a[160:163], a[40:43], v[168:171]
  v_mfma_f32_16x16x32_bf16 v[172:175], a[164:167], a[40:43], v[172:175]
  ds_write_b128 v36, v[140:143] offset:5376
  v_mfma_f32_16x16x32_bf16 v[176:179], a[168:171], a[40:43], v[176:179]
  ds_write_b128 v36, v[144:147] offset:5440
  s_waitcnt vmcnt(8)
  v_mfma_f32_16x16x32_bf16 v[160:163], a[172:175], a[8:11], v[160:163]
  ds_write_b128 v36, v[148:151] offset:5504
  v_mfma_f32_16x16x32_bf16 v[164:167], a[180:183], a[8:11], v[164:167]
  ds_write_b128 v36, v[152:155] offset:5568
  v_mfma_f32_16x16x32_bf16 v[168:171], a[184:187], a[8:11], v[168:171]
  ds_write_b128 v36, v[156:159] offset:5632
  v_mfma_f32_16x16x32_bf16 v[172:175], a[188:191], a[8:11], v[172:175]
  v_mfma_f32_16x16x32_bf16 v[176:179], a[192:195], a[8:11], v[176:179]
  v_mfma_f32_16x16x32_bf16 v[180:183], a[152:155], a[44:47], v[180:183]
  v_mfma_f32_16x16x32_bf16 v[184:187], a[156:159], a[44:47], v[184:187]
  v_mfma_f32_16x16x32_bf16 v[188:191], a[160:163], a[44:47], v[188:191]
  v_mfma_f32_16x16x32_bf16 v[192:195], a[164:167], a[44:47], v[192:195]
  ds_write_b128 v36, v[160:163] offset:10752
  v_mfma_f32_16x16x32_bf16 v[196:199], a[168:171], a[44:47], v[196:199]
  ds_write_b128 v36, v[164:167] offset:10816
  s_waitcnt vmcnt(6)
  v_mfma_f32_16x16x32_bf16 v[180:183], a[172:175], a[12:15], v[180:183]
  ds_write_b128 v36, v[168:171] offset:10880
  v_mfma_f32_16x16x32_bf16 v[184:187], a[180:183], a[12:15], v[184:187]
  ds_write_b128 v36, v[172:175] offset:10944
  v_mfma_f32_16x16x32_bf16 v[188:191], a[184:187], a[12:15], v[188:191]
  ds_write_b128 v36, v[176:179] offset:11008
  v_mfma_f32_16x16x32_bf16 v[192:195], a[188:191], a[12:15], v[192:195]
  v_mfma_f32_16x16x32_bf16 v[196:199], a[192:195], a[12:15], v[196:199]
  s_waitcnt lgkmcnt(10)
  ds_write_b128 v36, v[180:183] offset:16128
  s_nop 0
  ds_write_b128 v36, v[184:187] offset:16192
  s_nop 0
  ds_write_b128 v36, v[188:191] offset:16256
  s_nop 0
  ds_write_b128 v36, v[192:195] offset:16320
  ds_write_b128 v36, v[196:199] offset:16384
  s_waitcnt lgkmcnt(0)
  s_barrier
  ds_read_b128 v[120:123], v6 offset:0
  ds_read_b128 v[124:127], v6 offset:21504
  ds_read_b128 v[128:131], v6 offset:43008
  ds_read_b128 v[132:135], v6 offset:64512
  ds_read_b128 v[136:139], v7 offset:0
  ds_read_b128 v[140:143], v7 offset:21504
  ds_read_b128 v[144:147], v7 offset:43008
  ds_read_b128 v[148:151], v7 offset:64512
  ds_read_b128 v[152:155], v8 offset:0
  ds_read_b128 v[156:159], v8 offset:21504
  ds_read_b128 v[160:163], v8 offset:43008
  ds_read_b128 v[164:167], v8 offset:64512
  s_waitcnt vmcnt(0)
  v_xor_b32 v39, s92, v53
  v_bitop3_b32 v39, v39, v51, s92 bitop3:0xf6
  v_bitop3_b32 v39, v39, v47, s92 bitop3:0xf6
  v_bitop3_b32 v39, v39, v43, s92 bitop3:0xf6
  v_cmp_ne_u32 vcc, 0, v39
  s_nop 3
  s_cbranch_vccnz Y_poll10_slow
Y_poll10_ret:
  v_lshlrev_b32 v56, 16, v40
  v_and_b32 v40, s52, v40
  v_lshlrev_b32 v57, 16, v41
  v_and_b32 v41, s52, v41
  v_lshlrev_b32 v58, 16, v42
  v_and_b32 v42, s52, v42
  v_lshlrev_b32 v59, 16, v44
  v_and_b32 v44, s52, v44
  v_lshlrev_b32 v60, 16, v45
  v_and_b32 v45, s52, v45
  v_lshlrev_b32 v61, 16, v46
  v_and_b32 v46, s52, v46
  v_lshlrev_b32 v62, 16, v48
  v_and_b32 v48, s52, v48
  v_lshlrev_b32 v63, 16, v49
  v_and_b32 v49, s52, v49
  v_lshlrev_b32 v64, 16, v50
  v_and_b32 v50, s52, v50
  v_lshlrev_b32 v65, 16, v52
  v_and_b32 v52, s52, v52
  v_add_f32 v216, v216, v56
  v_add_f32 v217, v217, v40
  v_add_f32 v226, v226, v57
  v_add_f32 v227, v227, v41
  v_add_f32 v218, v218, v58
  v_add_f32 v219, v219, v42
  v_add_f32 v228, v228, v59
  v_add_f32 v229, v229, v44
  v_add_f32 v220, v220, v60
  v_add_f32 v221, v221, v45
  v_add_f32 v230, v230, v61
  v_add_f32 v231, v231, v46
  v_add_f32 v222, v222, v62
  v_add_f32 v223, v223, v48
  v_add_f32 v232, v232, v63
  v_add_f32 v233, v233, v49
  v_add_f32 v224, v224, v64
  v_add_f32 v225, v225, v50
  v_add_f32 v234, v234, v65
  v_add_f32 v235, v235, v52
  ds_read_b128 v[168:171], v9 offset:0
  ds_read_b128 v[172:175], v9 offset:21504
  ds_read_b128 v[176:179], v9 offset:43008
  s_waitcnt lgkmcnt(10)
  ds_read_b128 v[180:183], v9 offset:64512
  ds_read_b128 v[184:187], v10 offset:0
  ds_read_b128 v[188:191], v10 offset:21504
  ds_read_b128 v[192:195], v10 offset:43008
  ds_read_b128 v[196:199], v10 offset:64512
  v_add_f32 v120, v120, v124
  v_add_f32 v128, v128, v132
  v_add_f32 v121, v121, v125
  v_add_f32 v129, v129, v133
  v_add_f32 v122, v122, v126
  v_add_f32 v130, v130, v134
  v_add_f32 v123, v123, v127
  v_add_f32 v131, v131, v135
  v_add_f32 v120, v120, v216
  v_add_f32 v121, v121, v217
  v_add_f32 v122, v122, v226
  v_add_f32 v123, v123, v227
  v_add_f32 v120, v120, v128
  v_add_f32 v121, v121, v129
  v_add_f32 v122, v122, v130
  v_add_f32 v123, v123, v131
  buffer_store_dwordx4 v[120:123], v11, s[12:15], s61 offen sc1
  s_waitcnt lgkmcnt(14)
  v_add_f32 v136, v136, v140
  s_waitcnt lgkmcnt(12)
  v_add_f32 v144, v144, v148
  v_add_f32 v137, v137, v141
  v_add_f32 v145, v145, v149
  v_add_f32 v138, v138, v142
  v_add_f32 v146, v146, v150
  v_add_f32 v139, v139, v143
  v_add_f32 v147, v147, v151
  v_add_f32 v136, v136, v218
  v_add_f32 v137, v137, v219
  v_add_f32 v138, v138, v228
  v_add_f32 v139, v139, v229
  v_add_f32 v136, v136, v144
  v_add_f32 v137, v137, v145
  v_add_f32 v138, v138, v146
  v_add_f32 v139, v139, v147
  buffer_store_dwordx4 v[136:139], v12, s[12:15], s61 offen sc1
  s_waitcnt lgkmcnt(10)
  v_add_f32 v152, v152, v156
  s_waitcnt lgkmcnt(8)
  v_add_f32 v160, v160, v164
  v_add_f32 v153, v153, v157
  v_add_f32 v161, v161, v165
  v_add_f32 v154, v154, v158
  v_add_f32 v162, v162, v166
  v_add_f32 v155, v155, v159
  v_add_f32 v163, v163, v167
  v_add_f32 v152, v152, v220
  v_add_f32 v153, v153, v221
  v_add_f32 v154, v154, v230
  v_add_f32 v155, v155, v231
  v_add_f32 v152, v152, v160
  v_add_f32 v153, v153, v161
  v_add_f32 v154, v154, v162
  v_add_f32 v155, v155, v163
  buffer_store_dwordx4 v[152:155], v13, s[12:15], s61 offen sc1
  s_waitcnt lgkmcnt(6)
  v_add_f32 v168, v168, v172
  s_waitcnt lgkmcnt(4)
  v_add_f32 v176, v176, v180
  v_add_f32 v169, v169, v173
  v_add_f32 v177, v177, v181
  v_add_f32 v170, v170, v174
  v_add_f32 v178, v178, v182
  v_add_f32 v171, v171, v175
  v_add_f32 v179, v179, v183
  v_add_f32 v168, v168, v222
  v_add_f32 v169, v169, v223
  v_add_f32 v170, v170, v232
  v_add_f32 v171, v171, v233
  v_add_f32 v168, v168, v176
  v_add_f32 v169, v169, v177
  v_add_f32 v170, v170, v178
  v_add_f32 v171, v171, v179
  buffer_store_dwordx4 v[168:171], v14, s[12:15], s61 offen sc1
  s_waitcnt lgkmcnt(2)
  v_add_f32 v184, v184, v188
  s_waitcnt lgkmcnt(0)
  v_add_f32 v192, v192, v196
  v_add_f32 v185, v185, v189
  v_add_f32 v193, v193, v197
  v_add_f32 v186, v186, v190
  v_add_f32 v194, v194, v198
  v_add_f32 v187, v187, v191
  v_add_f32 v195, v195, v199
  v_add_f32 v184, v184, v224
  v_add_f32 v185, v185, v225
  v_add_f32 v186, v186, v234
  v_add_f32 v187, v187, v235
  v_add_f32 v184, v184, v192
  v_add_f32 v185, v185, v193
  v_add_f32 v186, v186, v194
  v_add_f32 v187, v187, v195
  buffer_store_dwordx4 v[184:187], v15, s[12:15], s61 offen sc1
Y_end:
  s_endpgm
Y_poll0_slow:
  s_mov_b32 s89, 0x40000
Y_poll0_lp:
  s_sleep 1
  s_sub_u32 s89, s89, 1
  s_cmp_eq_u32 s89, 0
  s_cbranch_scc1 Y_poll0_ret
  buffer_load_dwordx4 v[28:31], v212, s[20:23], s100 offen sc1
  s_waitcnt vmcnt(0)
  v_xor_b32 v39, s92, v31
  v_bitop3_b32 v39, v39, v30, s92 bitop3:0xf6
  v_cmp_ne_u32 vcc, 0, v39
  s_nop 3
  s_cbranch_vccnz Y_poll0_lp
  s_branch Y_poll0_ret
Y_poll1_slow:
  s_mov_b32 s89, 0x40000
Y_poll1_lp:
  s_sleep 1
  s_sub_u32 s89, s89, 1
  s_cmp_eq_u32 s89, 0
  s_cbranch_scc1 Y_poll1_ret
  buffer_load_dwordx2 v[120:121], v209, s[20:23], s83 offen offset:0 sc1
  buffer_load_dwordx2 v[122:123], v209, s[20:23], s83 offen offset:1280 sc1
  buffer_load_dwordx2 v[124:125], v209, s[20:23], s83 offen offset:2560 sc1
  buffer_load_dwordx2 v[126:127], v209, s[20:23], s82 offen offset:0 sc1
  buffer_load_dwordx2 v[128:129], v209, s[20:23], s82 offen offset:1280 sc1
  buffer_load_dwordx2 v[130:131], v22, s[20:23], s83 offen offset:0 sc1
  buffer_load_dwordx2 v[132:133], v22, s[20:23], s83 offen offset:1280 sc1
  buffer_load_dwordx2 v[134:135], v22, s[20:23], s83 offen offset:2560 sc1
  buffer_load_dwordx2 v[136:137], v22, s[20:23], s82 offen offset:0 sc1
  buffer_load_dwordx2 v[138:139], v22, s[20:23], s82 offen offset:1280 sc1
  s_waitcnt vmcnt(0)
  v_xor_b32 v39, s92, v139
  v_bitop3_b32 v39, v39, v137, s92 bitop3:0xf6
  v_bitop3_b32 v39, v39, v135, s92 bitop3:0xf6
  v_bitop3_b32 v39, v39, v133, s92 bitop3:0xf6
  v_bitop3_b32 v39, v39, v131, s92 bitop3:0xf6
  v_bitop3_b32 v39, v39, v129, s92 bitop3:0xf6
  v_bitop3_b32 v39, v39, v127, s92 bitop3:0xf6
  v_bitop3_b32 v39, v39, v125, s92 bitop3:0xf6
  v_bitop3_b32 v39, v39, v123, s92 bitop3:0xf6
  v_bitop3_b32 v39, v39, v121, s92 bitop3:0xf6
  v_cmp_ne_u32 vcc, 0, v39
  s_nop 3
  s_cbranch_vccnz Y_poll1_lp
  s_branch Y_poll1_ret
Y_poll2_slow:
  s_mov_b32 s89, 0x40000
Y_poll2_lp:
  s_sleep 1
  buffer_load_dword v249, v248, s[20:23], s69 offen sc1
  s_waitcnt vmcnt(0)
  v_xor_b32 v250, s92, v249
  v_cmp_ne_u32 s[86:87], 0, v250
  s_nop 3
  s_cmp_lg_u64 s[86:87], 0
  s_cbranch_scc0 Y_poll2_ret
  s_sub_u32 s89, s89, 1
  s_cmp_lg_u32 s89, 0
  s_cbranch_scc1 Y_poll2_lp
  s_branch Y_poll2_ret
Y_poll3_slow:
  s_mov_b32 s89, 0x40000
Y_poll3_lp:
  s_sleep 1
  s_sub_u32 s89, s89, 1
  s_cmp_eq_u32 s89, 0
  s_cbranch_scc1 Y_poll3_ret
  buffer_load_dword v211, v210, s[32:35], 0 offen sc1
  s_waitcnt vmcnt(0)
  v_cmp_eq_u32 vcc, 0, v211
  s_nop 3
  s_cbranch_vccnz Y_poll3_lp
  s_branch Y_poll3_ret
Y_poll4_slow:
  s_mov_b32 s89, 0x40000
Y_poll4_lp:
  s_sleep 1
  s_sub_u32 s89, s89, 1
  s_cmp_eq_u32 s89, 0
  s_cbranch_scc1 Y_poll4_ret
  buffer_load_dwordx2 v[184:185], v209, s[20:23], s83 offen offset:0 sc1
  buffer_load_dwordx2 v[186:187], v209, s[20:23], s83 offen offset:1280 sc1
  buffer_load_dwordx2 v[188:189], v209, s[20:23], s83 offen offset:2560 sc1
  buffer_load_dwordx2 v[190:191], v209, s[20:23], s82 offen offset:0 sc1
  buffer_load_dwordx2 v[192:193], v209, s[20:23], s82 offen offset:1280 sc1
  s_waitcnt vmcnt(0)
  v_xor_b32 v39, s92, v193
  v_bitop3_b32 v39, v39, v191, s92 bitop3:0xf6
  v_bitop3_b32 v39, v39, v189, s92 bitop3:0xf6
  v_bitop3_b32 v39, v39, v187, s92 bitop3:0xf6
  v_bitop3_b32 v39, v39, v185, s92 bitop3:0xf6
  v_cmp_ne_u32 vcc, 0, v39
  s_nop 3
  s_cbranch_vccnz Y_poll4_lp
  s_branch Y_poll4_ret
Y_poll5_slow:
  s_mov_b32 s89, 0x40000
Y_poll5_lp:
  s_sleep 1
  s_sub_u32 s89, s89, 1
  s_cmp_eq_u32 s89, 0
  s_cbranch_scc1 Y_poll5_ret
  buffer_load_dword v249, v248, s[20:23], s87 offen sc1
  s_waitcnt vmcnt(0)
  v_xor_b32 v39, s92, v249
  v_cmp_ne_u32 vcc, 0, v39
  s_nop 3
  s_cbranch_vccnz Y_poll5_lp
  s_branch Y_poll5_ret
Y_poll6_slow:
  s_mov_b32 s89, 0x40000
Y_poll6_lp:
  s_sleep 1
  s_sub_u32 s89, s89, 1
  s_cmp_eq_u32 s89, 0
  s_cbranch_scc1 Y_poll6_ret
  buffer_load_dword v250, v248, s[20:23], s87 offen offset:4 sc1
  s_waitcnt vmcnt(0)
  v_xor_b32 v39, s92, v250
  v_cmp_ne_u32 vcc, 0, v39
  s_nop 3
  s_cbranch_vccnz Y_poll6_lp
  s_branch Y_poll6_ret
Y_poll7_slow:
  s_mov_b32 s89, 0x40000
Y_poll7_lp:
  s_sleep 1
  s_sub_u32 s89, s89, 1
  s_cmp_eq_u32 s89, 0
  s_cbranch_scc1 Y_poll7_ret
  buffer_load_dwordx2 v[184:185], v254, s[36:39], s24 offen offset:0 sc1
  buffer_load_dwordx2 v[186:187], v254, s[36:39], s24 offen offset:1280 sc1
  buffer_load_dwordx2 v[188:189], v254, s[36:39], s24 offen offset:2560 sc1
  buffer_load_dwordx2 v[190:191], v254, s[36:39], s25 offen offset:0 sc1
  buffer_load_dwordx2 v[192:193], v254, s[36:39], s25 offen offset:1280 sc1
  buffer_load_dwordx2 v[194:195], v254, s[36:39], s25 offen offset:2560 sc1
  buffer_load_dwordx2 v[196:197], v254, s[36:39], s26 offen offset:0 sc1
  buffer_load_dwordx2 v[198:199], v254, s[36:39], s26 offen offset:1280 sc1
  buffer_load_dwordx2 v[4:5], v254, s[36:39], s26 offen offset:2560 sc1
  buffer_load_dwordx2 v[6:7], v254, s[36:39], s27 offen offset:0 sc1
  buffer_load_dwordx2 v[8:9], v254, s[36:39], s27 offen offset:1280 sc1
  buffer_load_dwordx2 v[10:11], v254, s[36:39], s27 offen offset:2560 sc1
  buffer_load_dwordx2 v[12:13], v254, s[36:39], s28 offen offset:0 sc1
  buffer_load_dwordx2 v[14:15], v254, s[36:39], s28 offen offset:1280 sc1
  buffer_load_dwordx2 v[16:17], v254, s[36:39], s28 offen offset:2560 sc1
  s_waitcnt vmcnt(0)
  v_xor_b32 v39, s92, v17
  v_bitop3_b32 v39, v39, v15, s92 bitop3:0xf6
  v_bitop3_b32 v39, v39, v13, s92 bitop3:0xf6
  v_bitop3_b32 v39, v39, v11, s92 bitop3:0xf6
  v_bitop3_b32 v39, v39, v9, s92 bitop3:0xf6
  v_bitop3_b32 v39, v39, v7, s92 bitop3:0xf6
  v_bitop3_b32 v39, v39, v5, s92 bitop3:0xf6
  v_bitop3_b32 v39, v39, v199, s92 bitop3:0xf6
  v_bitop3_b32 v39, v39, v197, s92 bitop3:0xf6
  v_bitop3_b32 v39, v39, v195, s92 bitop3:0xf6
  v_bitop3_b32 v39, v39, v193, s92 bitop3:0xf6
  v_bitop3_b32 v39, v39, v191, s92 bitop3:0xf6
  v_bitop3_b32 v39, v39, v189, s92 bitop3:0xf6
  v_bitop3_b32 v39, v39, v187, s92 bitop3:0xf6
  v_bitop3_b32 v39, v39, v185, s92 bitop3:0xf6
  v_cmp_ne_u32 vcc, 0, v39
  s_nop 3
  s_cbranch_vccnz Y_poll7_lp
  s_branch Y_poll7_ret
Y_poll8_slow:
  s_mov_b32 s89, 0x40000
Y_poll8_lp:
  s_sleep 1
  s_sub_u32 s89, s89, 1
  s_cmp_eq_u32 s89, 0
  s_cbranch_scc1 Y_poll8_ret
  buffer_load_dwordx4 v[252:255], v3, s[20:23], s49 offen sc1
  s_waitcnt vmcnt(0)
  v_xor_b32 v39, s92, v255
  v_bitop3_b32 v39, v39, v254, s92 bitop3:0xf6
  v_cmp_ne_u32 vcc, 0, v39
  s_nop 3
  s_cbranch_vccnz Y_poll8_lp
  s_branch Y_poll8_ret
Y_poll9_slow:
  s_mov_b32 s89, 0x40000
Y_poll9_lp:
  s_sleep 1
  s_sub_u32 s89, s89, 1
  s_cmp_eq_u32 s89, 0
  s_cbranch_scc1 Y_poll9_ret
  buffer_load_dword v250, v248, s[20:23], s87 offen offset:128 sc1
  s_waitcnt vmcnt(0)
  v_xor_b32 v39, s92, v250
  v_cmp_ne_u32 vcc, 0, v39
  s_nop 3
  s_cbranch_vccnz Y_poll9_lp
  s_branch Y_poll9_ret
Y_poll10_slow:
  s_mov_b32 s89, 0x40000
Y_poll10_lp:
  s_sleep 1
  s_sub_u32 s89, s89, 1
  s_cmp_eq_u32 s89, 0
  s_cbranch_scc1 Y_poll10_ret
  buffer_load_dwordx4 v[40:43], v17, s[20:23], s70 offen sc1
  buffer_load_dwordx4 v[44:47], v17, s[20:23], s71 offen sc1
  buffer_load_dwordx4 v[48:51], v17, s[20:23], s72 offen sc1
  buffer_load_dwordx2 v[52:53], v16, s[20:23], s73 offen sc1
  s_waitcnt vmcnt(0)
  v_xor_b32 v39, s92, v53
  v_bitop3_b32 v39, v39, v51, s92 bitop3:0xf6
  v_bitop3_b32 v39, v39, v47, s92 bitop3:0xf6
  v_bitop3_b32 v39, v39, v43, s92 bitop3:0xf6
  v_cmp_ne_u32 vcc, 0, v39
  s_nop 3
  s_cbranch_vccnz Y_poll10_lp
  s_branch Y_poll10_ret
K_end:
  s_endpgm
.section .rodata,"a"
.p2align 6
.amdhsa_kernel parallel_sum__ssm_conv_s5__glu_gated_swiglu__prompt_kernel
  .amdhsa_next_free_vgpr 512
  .amdhsa_next_free_sgpr 102
  .amdhsa_accum_offset 256
  .amdhsa_group_segment_fixed_size 0
  .amdhsa_kernarg_size 128
  .amdhsa_user_sgpr_count 2
  .amdhsa_user_sgpr_kernarg_segment_ptr 1
  .amdhsa_system_sgpr_workgroup_id_x 1
.end_amdhsa_kernel
```
